```python
import torch

def _softmax(x, axis=-1):
    return torch.softmax(x, dim=axis)
def _gelu(x):
    return torch.nn.functional.gelu(x, approximate="tanh")
def _silu(x):
    return torch.nn.functional.silu(x)
def _sigmoid(x):
    return torch.sigmoid(x)
def _layernorm(x, axis=-1, eps=1e-5):
    m = x.mean(dim=axis, keepdim=True)
    v = x.var(dim=axis, keepdim=True, unbiased=False)
    return (x - m) / torch.sqrt(v + eps)
def _scatter_add(tgt, idx, src, axis=0):
    return tgt.clone().index_add_(axis, idx, src)
def _segment_sum(src, seg, n):
    out = torch.zeros((n,) + src.shape[1:], dtype=src.dtype)
    return out.index_add_(0, seg, src)
def _pad(x, pw):
    flat = tuple(v for pair in reversed(pw) for v in pair)
    return torch.nn.functional.pad(x, flat)

kernel_name = 'gated_mix__ssm_conv_h3__mixer_s_mlp__prompt'

def setup_inputs():

    _w = (lambda a: (lambda t: t.to(torch.bfloat16) if t.is_floating_point() else t)(torch.as_tensor(a)))
    def _A_setup():
        B, S, D = 1, 2048, 576
        ks = 4
        return {
            "q": _w((lambda *s: torch.randn(*s, dtype=torch.bfloat16) * 0.05)(B, S, D)),
            "k": _w((lambda *s: torch.randn(*s, dtype=torch.bfloat16) * 1.6)(B, S, D)),
            "v": _w((lambda *s: torch.randn(*s, dtype=torch.bfloat16) * 1.6)(B, S, D)),
            "shift_k": _w((lambda *s: torch.randn(*s, dtype=torch.bfloat16) * 1.6)(D, ks) * 0.5),
            "ssm_k": _w((lambda *s: torch.randn(*s, dtype=torch.bfloat16) * 3.2)(D, S) * (1.0 / S ** 0.5)),
            "ssm_D": _w((lambda *s: torch.randn(*s, dtype=torch.bfloat16) * 1.6)(D)),
        }
    _A_in = _A_setup()

    def _B_setup():
        B, S, D, F = 1, 2048, 576, 4608
        return {
            "x":  _w((lambda *s: torch.randn(*s, dtype=torch.bfloat16) * 0.05)(B, S, D)),
            "w1": _w((lambda *s: torch.randn(*s, dtype=torch.bfloat16) * 3.2)(D, D) * (D ** -0.5)),
            "w2": _w((lambda *s: torch.randn(*s, dtype=torch.bfloat16) * 3.2)(D, D) * (D ** -0.5)),
            "w3": _w((lambda *s: torch.randn(*s, dtype=torch.bfloat16) * 3.2)(D, F) * (D ** -0.5)),
            "w4": _w((lambda *s: torch.randn(*s, dtype=torch.bfloat16) * 1.6)(F, D) * (F ** -0.5)),
        }
    _B_in = _B_setup()

    return {
        "A_q": _A_in["q"],
        "A_k": _A_in["k"],
        "A_v": _A_in["v"],
        "A_shift_k": _A_in["shift_k"],
        "A_ssm_k": _A_in["ssm_k"],
        "A_ssm_D": _A_in["ssm_D"],
        "B_x": _B_in["x"],
        "B_w1": _B_in["w1"],
        "B_w2": _B_in["w2"],
        "B_w3": _B_in["w3"],
        "B_w4": _B_in["w4"],
        "gate_w": _w((lambda *s: torch.randn(*s, dtype=torch.bfloat16) * 0.05)(576) * 16.0),
    }

def reference(A_q, A_k, A_v, A_shift_k, A_ssm_k, A_ssm_D, B_x, B_w1, B_w2, B_w3, B_w4, gate_w):
    def _A_ref(q, k, v, shift_k, ssm_k, ssm_D):
        B, S, D = q.shape
        ks = shift_k.shape[-1]
        k_pad = _pad(k, ((0, 0), (ks - 1, 0), (0, 0)))
        k_shift = torch.zeros_like(k)
        for t in range(ks):
            k_shift = k_shift + k_pad[:, t:t + S, :] * shift_k[:, ks - 1 - t][None, None, :]
        kv = k_shift * v
        L = 2 * S
        kv_pad = _pad(kv, ((0, 0), (0, S), (0, 0)))
        kf_pad = _pad(ssm_k, ((0, 0), (0, S)))
        kv_f = (lambda x, axes=(-2,-1): torch.fft.rfft2(x.float(), dim=axes))(kv_pad[:, None, :, :], axes=(1, 2))
        kf_f = (lambda x, axes=(-2,-1): torch.fft.rfft2(x.float(), dim=axes))(kf_pad[:, None, :], axes=(1, 2))
        kf_f = (lambda x, *d: x.permute(*d))(kf_f, 1, 2, 0)
        y_f = kv_f * kf_f[None, :, :, :]
        y = (lambda x, s, axes=(-2,-1): torch.fft.irfft2(x, s=s, dim=axes).to(torch.bfloat16))(y_f, (1, L), axes=(1, 2))[:, 0, :S, :]
        y = y + kv * ssm_D[None, None, :]
        return q * y

    def _B_ref(x, w1, w2, w3, w4):
        B, S, D = x.shape
        h = _gelu(_layernorm(x, axis=-1) @ w1)
        c = D // 4
        g0 = _pad(h[:, :, 0*c:1*c], ((0, 0), (1, 0), (0, 0)))[:, :S, :]
        g1 = _pad(h[:, :, 1*c:2*c], ((0, 0), (0, 1), (0, 0)))[:, 1:, :]
        g2 = _pad(h[:, :, 2*c:3*c], ((0, 0), (2, 0), (0, 0)))[:, :S, :]
        g3 = _pad(h[:, :, 3*c:   ], ((0, 0), (0, 2), (0, 0)))[:, 2:, :]
        hs = torch.concatenate([g0, g1, g2, g3], axis=-1) @ w2
        x1 = x + hs
        h2 = _gelu(_layernorm(x1, axis=-1) @ w3) @ w4
        return x1 + h2

    x = A_q
    g = _sigmoid((x * gate_w).sum(-1, keepdims=True))
    a = _A_ref(x, A_k, A_v, A_shift_k, A_ssm_k, A_ssm_D)
    b = _B_ref(x, B_w1, B_w2, B_w3, B_w4)
    return g * a + (1 - g) * b
```

```asm
; @launch grid=(256,1,1) block=(256,1,1) lds=163840
.amdgcn_target "amdgcn-amd-amdhsa--gfx950"
.text
.globl gated_mix__ssm_conv_h3__mixer_s_mlp__prompt_kernel
.p2align 8
.type gated_mix__ssm_conv_h3__mixer_s_mlp__prompt_kernel,@function
gated_mix__ssm_conv_h3__mixer_s_mlp__prompt_kernel:
    s_cmp_ge_u32 s2, 256
    s_cbranch_scc1 gated_mix__ssm_conv_h3__mixer_s_mlp__prompt_kernel_exit
    s_load_dwordx16 s[16:31], s[0:1], 0
    s_load_dwordx8 s[32:39], s[0:1], 64
    s_load_dwordx4 s[40:43], s[0:1], 96
    s_load_dwordx2 s[44:45], s[0:1], 112
    v_and_b32 v1, 63, v0
    v_lshrrev_b32 v2, 6, v0
    s_nop 0
    v_readfirstlane_b32 s3, v2
    s_getpc_b64 s[8:9]
kx_pc:
    s_add_u32 s8, s8, gated_mix__ssm_conv_h3__mixer_s_mlp__prompt_kernel-kx_pc
    s_addc_u32 s9, s9, -1
    s_mov_b32 s10, code_end-gated_mix__ssm_conv_h3__mixer_s_mlp__prompt_kernel
    s_mov_b32 s11, 0x20000
    s_lshr_b32 s12, s2, 3
    s_lshl_b32 s12, s12, 13
    v_lshlrev_b32 v3, 7, v1
    v_lshl_add_u32 v3, v2, 20, v3
    v_add_u32 v3, s12, v3
    buffer_load_dword v255, v3, s[8:11], 0 offen
    s_waitcnt lgkmcnt(0)
    s_and_b32 s6, s2, 7
    s_lshr_b32 s7, s2, 3
    s_and_b32 s4, s6, 3
    s_mul_i32 s4, s4, 2
    s_and_b32 s8, s7, 1
    s_add_u32 s4, s4, s8
    s_lshr_b32 s5, s6, 2
    s_mul_i32 s5, s5, 16
    s_lshr_b32 s8, s7, 1
    s_add_u32 s5, s5, s8
    v_lshlrev_b32 v2, 4, v1
    s_lshr_b32 s6, s4, 1
    s_and_b32 s7, s5, 3
    s_cmp_lt_u32 s6, 3
    s_cselect_b32 s95, s6, s7
    s_cmp_eq_u32 s6, s7
    s_cselect_b32 s95, 3, s95
    s_lshl_b32 s95, s95, 1
    s_and_b32 s6, s4, 1
    s_add_u32 s95, s95, s6
    s_cmp_ge_u32 s95, 6
    s_cbranch_scc1 k3_fb
    s_mov_b32 s56, s16
    s_mov_b32 s57, s17
    s_mov_b32 s58, 2359296
    s_mov_b32 s59, 0x20000
    s_lshl_b32 s6, s5, 6
    s_lshl_b32 s7, s3, 4
    s_add_u32 s6, s6, s7
    v_lshrrev_b32 v3, 2, v1
    v_lshrrev_b32 v4, 3, v1
    v_and_b32 v4, 6, v4
    v_mov_b32 v5, 0x78
    v_lshrrev_b32 v4, v4, v5
    v_xor_b32 v4, v4, v1
    v_and_b32 v4, 3, v4
    v_add_u32 v3, s6, v3
    v_mul_u32_u24 v6, 1152, v3
    v_lshl_add_u32 v5, v4, 4, v6
    s_mul_i32 s7, s95, 192
    s_sub_u32 s9, 663552, s7
    s_bfe_u32 s46, s5, 0x20002
    s_lshl_b32 s46, s46, 1
    s_and_b32 s47, s4, 1
    s_add_u32 s46, s46, s47
    s_lshl_b32 s46, s46, 2
    s_add_u32 s46, s46, s3
    s_mul_i32 s46, s46, 20736
    s_lshr_b32 s47, s95, 1
    s_mul_i32 s47, s47, 384
    s_add_u32 s46, s46, s47
    v_min_u32 v12, 53, v1
    v_mul_u32_u24 v13, 86, v12
    v_lshrrev_b32 v13, 8, v13
    v_mul_u32_u24 v13, 768, v13
    v_lshl_add_u32 v12, v12, 7, v13
    buffer_load_dwordx4 v[48:51], v5, s[56:59], 0 offen offset:0
    buffer_load_dwordx4 v[52:55], v5, s[56:59], 0 offen offset:64
    buffer_load_dwordx4 v[56:59], v5, s[56:59], 0 offen offset:128
    buffer_load_dwordx4 v[60:63], v5, s[56:59], 0 offen offset:192
    buffer_load_dwordx4 v[64:67], v5, s[56:59], 0 offen offset:256
    buffer_load_dwordx4 v[68:71], v5, s[56:59], 0 offen offset:320
    buffer_load_dwordx4 v[72:75], v5, s[56:59], 0 offen offset:384
    buffer_load_dwordx4 v[76:79], v5, s[56:59], 0 offen offset:448
    buffer_load_dwordx4 v[80:83], v5, s[56:59], 0 offen offset:512
    buffer_load_dwordx4 v[84:87], v5, s[56:59], 0 offen offset:576
    s_add_u32 s52, s30, s7
    s_addc_u32 s53, s31, 0
    s_mov_b32 s54, s9
    s_mov_b32 s55, 0x20000
    v_add_u32 v7, 0, v1
    v_mul_u32_u24 v8, 171, v7
    v_lshrrev_b32 v8, 11, v8
    v_mul_u32_u24 v9, 12, v8
    v_sub_u32 v7, v7, v9
    v_lshrrev_b32 v9, 1, v8
    v_and_b32 v9, 2, v9
    v_xor_b32 v7, v7, v9
    v_and_b32 v9, 12, v8
    v_add_u32 v8, v8, v9
    v_mul_u32_u24 v8, 1152, v8
    v_lshl_add_u32 v150, v7, 4, v8
    v_add_u32 v7, 64, v1
    v_mul_u32_u24 v8, 171, v7
    v_lshrrev_b32 v8, 11, v8
    v_mul_u32_u24 v9, 12, v8
    v_sub_u32 v7, v7, v9
    v_lshrrev_b32 v9, 1, v8
    v_and_b32 v9, 2, v9
    v_xor_b32 v7, v7, v9
    v_and_b32 v9, 12, v8
    v_add_u32 v8, v8, v9
    v_mul_u32_u24 v8, 1152, v8
    v_lshl_add_u32 v151, v7, 4, v8
    v_subrev_u32 v151, 1024, v151
    v_add_u32 v7, 128, v1
    v_mul_u32_u24 v8, 171, v7
    v_lshrrev_b32 v8, 11, v8
    v_mul_u32_u24 v9, 12, v8
    v_sub_u32 v7, v7, v9
    v_lshrrev_b32 v9, 1, v8
    v_and_b32 v9, 2, v9
    v_xor_b32 v7, v7, v9
    v_and_b32 v9, 12, v8
    v_add_u32 v8, v8, v9
    v_mul_u32_u24 v8, 1152, v8
    v_lshl_add_u32 v152, v7, 4, v8
    v_subrev_u32 v152, 2048, v152
    s_lshr_b32 s8, s3, 1
    s_lshl_b32 s8, s8, 3
    s_and_b32 s10, s3, 1
    s_add_u32 s8, s8, s10
    s_mul_i32 s8, s8, 4608
    s_mul_i32 s14, s3, 3072
    s_mov_b32 s12, 73728
    s_add_u32 m0, s14, 73728
    s_nop 0
    buffer_load_dwordx4 v150, s[52:55], s8 offen offset:0 lds
    buffer_load_dwordx4 v151, s[52:55], s8 offen offset:1024 lds
    buffer_load_dwordx4 v152, s[52:55], s8 offen offset:2048 lds
    s_add_u32 s8, s8, s12
    s_add_u32 m0, s14, 86016
    s_nop 0
    buffer_load_dwordx4 v150, s[52:55], s8 offen offset:0 lds
    buffer_load_dwordx4 v151, s[52:55], s8 offen offset:1024 lds
    buffer_load_dwordx4 v152, s[52:55], s8 offen offset:2048 lds
    s_add_u32 s8, s8, s12
    s_add_u32 m0, s14, 98304
    s_nop 0
    buffer_load_dwordx4 v150, s[52:55], s8 offen offset:0 lds
    buffer_load_dwordx4 v151, s[52:55], s8 offen offset:1024 lds
    buffer_load_dwordx4 v152, s[52:55], s8 offen offset:2048 lds
    buffer_load_dwordx4 v[88:91], v5, s[56:59], 0 offen offset:640
    buffer_load_dwordx4 v[92:95], v5, s[56:59], 0 offen offset:704
    buffer_load_dwordx4 v[96:99], v5, s[56:59], 0 offen offset:768
    buffer_load_dwordx4 v[100:103], v5, s[56:59], 0 offen offset:832
    buffer_load_dwordx4 v[104:107], v5, s[56:59], 0 offen offset:896
    buffer_load_dwordx4 v[108:111], v5, s[56:59], 0 offen offset:960
    buffer_load_dwordx4 v[112:115], v5, s[56:59], 0 offen offset:1024
    buffer_load_dwordx4 v[116:119], v5, s[56:59], 0 offen offset:1088
    s_lshl_b32 s10, s3, 10
    s_add_u32 s15, s10, 49152
    v_add_u32 v10, s15, v2
    v_and_b32 v3, 15, v1
    v_lshrrev_b32 v4, 4, v1
    v_lshrrev_b32 v7, 1, v3
    v_and_b32 v7, 6, v7
    v_mov_b32 v8, 0x78
    v_lshrrev_b32 v7, v7, v8
    v_xor_b32 v7, v7, v4
    v_and_b32 v7, 3, v7
    v_lshlrev_b32 v7, 4, v7
    v_lshl_add_u32 v11, v3, 6, v7
    v_add_u32 v11, s15, v11
    v_add_u32 v3, s6, v3
    v_lshrrev_b32 v7, 2, v1
    v_mul_u32_u24 v8, 192, v7
    v_and_b32 v9, 3, v1
    v_lshl_add_u32 v8, v9, 3, v8
    v_and_b32 v9, 1, v4
    v_lshl_add_u32 v144, v9, 5, v8
    v_xor_b32 v9, 1, v9
    v_lshl_add_u32 v145, v9, 5, v8
    v_add_u32 v146, 0x10000, v144
    v_add_u32 v147, 0x10000, v145
    v_add_u32 v148, 0x20000, v144
    v_add_u32 v149, 0x20000, v145
    s_movk_i32 s11, 0x1000
    v_mov_b32 v248, 0x3f803f80
    v_mov_b32 v249, 0x3f803f80
    v_mov_b32 v250, 0x3f803f80
    v_mov_b32 v251, 0x3f803f80
    s_add_u32 s48, s32, s7
    s_addc_u32 s49, s33, 0
    s_mov_b32 s50, s9
    s_mov_b32 s51, 0x20000
    v_add_u32 v7, 0, v1
    v_mul_u32_u24 v8, 171, v7
    v_lshrrev_b32 v8, 11, v8
    v_mul_u32_u24 v9, 12, v8
    v_sub_u32 v7, v7, v9
    v_lshrrev_b32 v9, 1, v8
    v_and_b32 v9, 2, v9
    v_xor_b32 v7, v7, v9
    v_mul_u32_u24 v8, 1152, v8
    v_lshl_add_u32 v153, v7, 4, v8
    v_add_u32 v7, 64, v1
    v_mul_u32_u24 v8, 171, v7
    v_lshrrev_b32 v8, 11, v8
    v_mul_u32_u24 v9, 12, v8
    v_sub_u32 v7, v7, v9
    v_lshrrev_b32 v9, 1, v8
    v_and_b32 v9, 2, v9
    v_xor_b32 v7, v7, v9
    v_mul_u32_u24 v8, 1152, v8
    v_lshl_add_u32 v154, v7, 4, v8
    v_subrev_u32 v154, 1024, v154
    v_add_u32 v7, 128, v1
    v_mul_u32_u24 v8, 171, v7
    v_lshrrev_b32 v8, 11, v8
    v_mul_u32_u24 v9, 12, v8
    v_sub_u32 v7, v7, v9
    v_lshrrev_b32 v9, 1, v8
    v_and_b32 v9, 2, v9
    v_xor_b32 v7, v7, v9
    v_mul_u32_u24 v8, 1152, v8
    v_lshl_add_u32 v155, v7, 4, v8
    v_subrev_u32 v155, 2048, v155
    s_mov_b32 s60, s38
    s_mov_b32 s61, s39
    s_mov_b32 s62, 1152
    s_mov_b32 s63, 0x20000
    s_mul_i32 s99, s3, 18432
    v_and_b32 v7, 3, v1
    v_lshl_add_u32 v6, v7, 4, v6
    v_lshlrev_b32 v7, 3, v4
    v_and_b32 v156, 15, v1
    v_lshl_add_u32 v156, v156, 6, v7
    s_add_u32 s91, s14, 36864
    v_add_u32 v156, s91, v156
    s_waitcnt vmcnt(26)
    ds_write_b128 v10, v[48:51]
    ds_read_b128 v[48:51], v11
    s_add_u32 s8, s8, s12
    s_add_u32 m0, s14, 110592
    s_nop 0
    buffer_load_dwordx4 v150, s[52:55], s8 offen offset:0 lds
    buffer_load_dwordx4 v151, s[52:55], s8 offen offset:1024 lds
    buffer_load_dwordx4 v152, s[52:55], s8 offen offset:2048 lds
    s_waitcnt vmcnt(28)
    ds_write_b128 v10, v[52:55]
    ds_read_b128 v[52:55], v11
    s_add_u32 s8, s8, s12
    s_add_u32 m0, s14, 122880
    s_nop 0
    buffer_load_dwordx4 v150, s[52:55], s8 offen offset:0 lds
    buffer_load_dwordx4 v151, s[52:55], s8 offen offset:1024 lds
    buffer_load_dwordx4 v152, s[52:55], s8 offen offset:2048 lds
    s_waitcnt vmcnt(30)
    ds_write_b128 v10, v[56:59]
    ds_read_b128 v[56:59], v11
    s_add_u32 s8, s8, s12
    s_add_u32 m0, s14, 135168
    s_nop 0
    buffer_load_dwordx4 v150, s[52:55], s8 offen offset:0 lds
    buffer_load_dwordx4 v151, s[52:55], s8 offen offset:1024 lds
    buffer_load_dwordx4 v152, s[52:55], s8 offen offset:2048 lds
    s_waitcnt vmcnt(32)
    ds_write_b128 v10, v[60:63]
    ds_read_b128 v[60:63], v11
    s_add_u32 s8, s8, s12
    s_add_u32 m0, s14, 0
    s_nop 0
    buffer_load_dwordx4 v150, s[52:55], s8 offen offset:0 lds
    buffer_load_dwordx4 v151, s[52:55], s8 offen offset:1024 lds
    buffer_load_dwordx4 v152, s[52:55], s8 offen offset:2048 lds
    s_waitcnt vmcnt(34)
    ds_write_b128 v10, v[64:67]
    ds_read_b128 v[64:67], v11
    s_add_u32 s8, s8, s12
    s_add_u32 m0, s14, 12288
    s_nop 0
    buffer_load_dwordx4 v150, s[52:55], s8 offen offset:0 lds
    buffer_load_dwordx4 v151, s[52:55], s8 offen offset:1024 lds
    buffer_load_dwordx4 v152, s[52:55], s8 offen offset:2048 lds
    s_waitcnt vmcnt(36)
    ds_write_b128 v10, v[68:71]
    ds_read_b128 v[68:71], v11
    s_add_u32 s8, s8, s12
    s_add_u32 m0, s14, 24576
    s_nop 0
    buffer_load_dwordx4 v150, s[52:55], s8 offen offset:0 lds
    buffer_load_dwordx4 v151, s[52:55], s8 offen offset:1024 lds
    buffer_load_dwordx4 v152, s[52:55], s8 offen offset:2048 lds
    s_waitcnt vmcnt(38)
    ds_write_b128 v10, v[72:75]
    ds_read_b128 v[72:75], v11
    s_lshr_b32 s13, s3, 1
    s_lshl_b32 s15, s2, 1
    s_add_u32 s15, s15, s13
    s_and_b32 s96, s3, 1
    s_mul_i32 s0, s13, 4576
    s_add_u32 s0, s0, 147456
    s_lshl_b32 s46, s15, 12
    s_add_u32 s64, s24, s46
    s_addc_u32 s65, s25, 0
    s_mov_b32 s66, 4096
    s_mov_b32 s67, 0x20000
    s_lshl_b32 s47, s96, 10
    v_add_u32 v19, s47, v2
    v_subrev_u32 v19, 16, v19
    buffer_load_dwordx4 v[28:31], v19, s[64:67], 0 offen offset:0 nt
    buffer_load_dwordx4 v[32:35], v19, s[64:67], 0 offen offset:16 nt
    buffer_load_dwordx4 v[36:39], v19, s[64:67], 0 offen offset:2048 nt
    buffer_load_dwordx4 v[40:43], v19, s[64:67], 0 offen offset:2064 nt
    s_mov_b32 s64, s26
    s_mov_b32 s65, s27
    s_mov_b32 s66, 1152
    s_mov_b32 s67, 0x20000
    s_lshl_b32 s47, s15, 1
    v_mov_b32 v19, s47
    buffer_load_ushort v18, v19, s[64:67], 0 offen
    s_mul_i32 s1, s13, 33280
    s_add_u32 s1, s1, 73728
    s_lshl_b32 s97, s96, 11
    s_lshl_b32 s98, s15, 2
    s_add_u32 s98, s98, s97
    s_add_u32 s98, s98, 0x4000
    s_add_u32 s97, s97, s46
    s_waitcnt vmcnt(42)
    ds_write_b128 v10, v[76:79]
    ds_read_b128 v[76:79], v11
    s_waitcnt vmcnt(41)
    ds_write_b128 v10, v[80:83]
    ds_read_b128 v[80:83], v11
    s_waitcnt vmcnt(40)
    ds_write_b128 v10, v[84:87]
    ds_read_b128 v[84:87], v11
    s_waitcnt vmcnt(30)
    ds_write_b128 v10, v[88:91]
    ds_read_b128 v[88:91], v11
    s_waitcnt vmcnt(29)
    ds_write_b128 v10, v[92:95]
    ds_read_b128 v[92:95], v11
    s_waitcnt vmcnt(28)
    ds_write_b128 v10, v[96:99]
    ds_read_b128 v[96:99], v11
    s_waitcnt vmcnt(27)
    ds_write_b128 v10, v[100:103]
    ds_read_b128 v[100:103], v11
    s_waitcnt vmcnt(26)
    ds_write_b128 v10, v[104:107]
    ds_read_b128 v[104:107], v11
    s_waitcnt vmcnt(25)
    ds_write_b128 v10, v[108:111]
    ds_read_b128 v[108:111], v11
    s_waitcnt vmcnt(24)
    ds_write_b128 v10, v[112:115]
    ds_read_b128 v[112:115], v11
    s_waitcnt vmcnt(23)
    ds_write_b128 v10, v[116:119]
    ds_read_b128 v[116:119], v11
    s_waitcnt lgkmcnt(0)
    v_mov_b32 v252, 0
    v_mov_b32 v253, 0
    v_mov_b32 v254, 0
    v_mov_b32 v255, 0
    v_dot2c_f32_bf16 v252, v248, v48
    v_dot2c_f32_bf16 v254, v48, v48
    v_dot2c_f32_bf16 v253, v248, v49
    v_dot2c_f32_bf16 v255, v49, v49
    v_dot2c_f32_bf16 v252, v248, v50
    v_dot2c_f32_bf16 v254, v50, v50
    v_dot2c_f32_bf16 v253, v248, v51
    v_dot2c_f32_bf16 v255, v51, v51
    v_dot2c_f32_bf16 v252, v248, v52
    v_dot2c_f32_bf16 v254, v52, v52
    v_dot2c_f32_bf16 v253, v248, v53
    v_dot2c_f32_bf16 v255, v53, v53
    v_dot2c_f32_bf16 v252, v248, v54
    v_dot2c_f32_bf16 v254, v54, v54
    v_dot2c_f32_bf16 v253, v248, v55
    v_dot2c_f32_bf16 v255, v55, v55
    v_dot2c_f32_bf16 v252, v248, v56
    v_dot2c_f32_bf16 v254, v56, v56
    v_dot2c_f32_bf16 v253, v248, v57
    v_dot2c_f32_bf16 v255, v57, v57
    v_dot2c_f32_bf16 v252, v248, v58
    v_dot2c_f32_bf16 v254, v58, v58
    v_dot2c_f32_bf16 v253, v248, v59
    v_dot2c_f32_bf16 v255, v59, v59
    v_dot2c_f32_bf16 v252, v248, v60
    v_dot2c_f32_bf16 v254, v60, v60
    v_dot2c_f32_bf16 v253, v248, v61
    v_dot2c_f32_bf16 v255, v61, v61
    v_dot2c_f32_bf16 v252, v248, v62
    v_dot2c_f32_bf16 v254, v62, v62
    v_dot2c_f32_bf16 v253, v248, v63
    v_dot2c_f32_bf16 v255, v63, v63
    v_dot2c_f32_bf16 v252, v248, v64
    v_dot2c_f32_bf16 v254, v64, v64
    v_dot2c_f32_bf16 v253, v248, v65
    v_dot2c_f32_bf16 v255, v65, v65
    v_dot2c_f32_bf16 v252, v248, v66
    v_dot2c_f32_bf16 v254, v66, v66
    v_dot2c_f32_bf16 v253, v248, v67
    v_dot2c_f32_bf16 v255, v67, v67
    v_dot2c_f32_bf16 v252, v248, v68
    v_dot2c_f32_bf16 v254, v68, v68
    v_dot2c_f32_bf16 v253, v248, v69
    v_dot2c_f32_bf16 v255, v69, v69
    v_dot2c_f32_bf16 v252, v248, v70
    v_dot2c_f32_bf16 v254, v70, v70
    v_dot2c_f32_bf16 v253, v248, v71
    v_dot2c_f32_bf16 v255, v71, v71
    v_dot2c_f32_bf16 v252, v248, v72
    v_dot2c_f32_bf16 v254, v72, v72
    v_dot2c_f32_bf16 v253, v248, v73
    v_dot2c_f32_bf16 v255, v73, v73
    v_dot2c_f32_bf16 v252, v248, v74
    v_dot2c_f32_bf16 v254, v74, v74
    v_dot2c_f32_bf16 v253, v248, v75
    v_dot2c_f32_bf16 v255, v75, v75
    v_dot2c_f32_bf16 v252, v248, v76
    v_dot2c_f32_bf16 v254, v76, v76
    v_dot2c_f32_bf16 v253, v248, v77
    v_dot2c_f32_bf16 v255, v77, v77
    v_dot2c_f32_bf16 v252, v248, v78
    v_dot2c_f32_bf16 v254, v78, v78
    v_dot2c_f32_bf16 v253, v248, v79
    v_dot2c_f32_bf16 v255, v79, v79
    v_dot2c_f32_bf16 v252, v248, v80
    v_dot2c_f32_bf16 v254, v80, v80
    v_dot2c_f32_bf16 v253, v248, v81
    v_dot2c_f32_bf16 v255, v81, v81
    v_dot2c_f32_bf16 v252, v248, v82
    v_dot2c_f32_bf16 v254, v82, v82
    v_dot2c_f32_bf16 v253, v248, v83
    v_dot2c_f32_bf16 v255, v83, v83
    v_dot2c_f32_bf16 v252, v248, v84
    v_dot2c_f32_bf16 v254, v84, v84
    v_dot2c_f32_bf16 v253, v248, v85
    v_dot2c_f32_bf16 v255, v85, v85
    v_dot2c_f32_bf16 v252, v248, v86
    v_dot2c_f32_bf16 v254, v86, v86
    v_dot2c_f32_bf16 v253, v248, v87
    v_dot2c_f32_bf16 v255, v87, v87
    v_dot2c_f32_bf16 v252, v248, v88
    v_dot2c_f32_bf16 v254, v88, v88
    v_dot2c_f32_bf16 v253, v248, v89
    v_dot2c_f32_bf16 v255, v89, v89
    v_dot2c_f32_bf16 v252, v248, v90
    v_dot2c_f32_bf16 v254, v90, v90
    v_dot2c_f32_bf16 v253, v248, v91
    v_dot2c_f32_bf16 v255, v91, v91
    v_dot2c_f32_bf16 v252, v248, v92
    v_dot2c_f32_bf16 v254, v92, v92
    v_dot2c_f32_bf16 v253, v248, v93
    v_dot2c_f32_bf16 v255, v93, v93
    v_dot2c_f32_bf16 v252, v248, v94
    v_dot2c_f32_bf16 v254, v94, v94
    v_dot2c_f32_bf16 v253, v248, v95
    v_dot2c_f32_bf16 v255, v95, v95
    v_dot2c_f32_bf16 v252, v248, v96
    v_dot2c_f32_bf16 v254, v96, v96
    v_dot2c_f32_bf16 v253, v248, v97
    v_dot2c_f32_bf16 v255, v97, v97
    v_dot2c_f32_bf16 v252, v248, v98
    v_dot2c_f32_bf16 v254, v98, v98
    v_dot2c_f32_bf16 v253, v248, v99
    v_dot2c_f32_bf16 v255, v99, v99
    v_dot2c_f32_bf16 v252, v248, v100
    v_dot2c_f32_bf16 v254, v100, v100
    v_dot2c_f32_bf16 v253, v248, v101
    v_dot2c_f32_bf16 v255, v101, v101
    v_dot2c_f32_bf16 v252, v248, v102
    v_dot2c_f32_bf16 v254, v102, v102
    v_dot2c_f32_bf16 v253, v248, v103
    v_dot2c_f32_bf16 v255, v103, v103
    v_dot2c_f32_bf16 v252, v248, v104
    v_dot2c_f32_bf16 v254, v104, v104
    v_dot2c_f32_bf16 v253, v248, v105
    v_dot2c_f32_bf16 v255, v105, v105
    v_dot2c_f32_bf16 v252, v248, v106
    v_dot2c_f32_bf16 v254, v106, v106
    v_dot2c_f32_bf16 v253, v248, v107
    v_dot2c_f32_bf16 v255, v107, v107
    v_dot2c_f32_bf16 v252, v248, v108
    v_dot2c_f32_bf16 v254, v108, v108
    v_dot2c_f32_bf16 v253, v248, v109
    v_dot2c_f32_bf16 v255, v109, v109
    v_dot2c_f32_bf16 v252, v248, v110
    v_dot2c_f32_bf16 v254, v110, v110
    v_dot2c_f32_bf16 v253, v248, v111
    v_dot2c_f32_bf16 v255, v111, v111
    v_dot2c_f32_bf16 v252, v248, v112
    v_dot2c_f32_bf16 v254, v112, v112
    v_dot2c_f32_bf16 v253, v248, v113
    v_dot2c_f32_bf16 v255, v113, v113
    v_dot2c_f32_bf16 v252, v248, v114
    v_dot2c_f32_bf16 v254, v114, v114
    v_dot2c_f32_bf16 v253, v248, v115
    v_dot2c_f32_bf16 v255, v115, v115
    v_dot2c_f32_bf16 v252, v248, v116
    v_dot2c_f32_bf16 v254, v116, v116
    v_dot2c_f32_bf16 v253, v248, v117
    v_dot2c_f32_bf16 v255, v117, v117
    v_dot2c_f32_bf16 v252, v248, v118
    v_dot2c_f32_bf16 v254, v118, v118
    v_dot2c_f32_bf16 v253, v248, v119
    v_dot2c_f32_bf16 v255, v119, v119
    s_nop 1
    v_add_f32 v252, v252, v253
    v_add_f32 v254, v254, v255
    s_mov_b32 s68, s42
    s_mov_b32 s69, s43
    s_mov_b32 s70, 256
    s_mov_b32 s71, 0x20000
    v_mov_b32 v13, 0
    s_barrier
    ds_read_b64_tr_b16 v[160:161], v146 offset:8192
    ds_read_b64_tr_b16 v[162:163], v146 offset:11264
    ds_read_b64_tr_b16 v[164:165], v147 offset:8192
    ds_read_b64_tr_b16 v[166:167], v147 offset:11264
    ds_read_b64_tr_b16 v[168:169], v146 offset:8256
    ds_read_b64_tr_b16 v[170:171], v146 offset:11328
    ds_read_b64_tr_b16 v[172:173], v147 offset:8256
    ds_read_b64_tr_b16 v[174:175], v147 offset:11328
    ds_read_b64_tr_b16 v[176:177], v146 offset:8320
    ds_read_b64_tr_b16 v[178:179], v146 offset:11392
    s_waitcnt lgkmcnt(6)
    v_mfma_f32_16x16x32_bf16 v[120:123], v[160:163], v[48:51], 0
    ds_read_b64_tr_b16 v[180:181], v147 offset:8320
    v_mfma_f32_16x16x32_bf16 v[224:227], v[160:163], v[248:251], 0
    ds_read_b64_tr_b16 v[182:183], v147 offset:11392
    v_mov_b32 v253, v252
    v_mfma_f32_16x16x32_bf16 v[124:127], v[164:167], v[48:51], 0
    ds_read_b64_tr_b16 v[184:185], v146 offset:14336
    v_mfma_f32_16x16x32_bf16 v[228:231], v[164:167], v[248:251], 0
    ds_read_b64_tr_b16 v[186:187], v146 offset:17408
    v_permlane32_swap_b32 v253, v252
    s_waitcnt lgkmcnt(6)
    v_mfma_f32_16x16x32_bf16 v[128:131], v[168:171], v[48:51], 0
    ds_read_b64_tr_b16 v[188:189], v147 offset:14336
    v_mfma_f32_16x16x32_bf16 v[232:235], v[168:171], v[248:251], 0
    ds_read_b64_tr_b16 v[190:191], v147 offset:17408
    v_add_f32 v252, v252, v253
    v_mfma_f32_16x16x32_bf16 v[132:135], v[172:175], v[48:51], 0
    ds_read_b64_tr_b16 v[160:161], v146 offset:14400
    v_mfma_f32_16x16x32_bf16 v[236:239], v[172:175], v[248:251], 0
    ds_read_b64_tr_b16 v[162:163], v146 offset:17472
    v_mov_b32 v253, v252
    s_waitcnt lgkmcnt(6)
    v_mfma_f32_16x16x32_bf16 v[136:139], v[176:179], v[48:51], 0
    ds_read_b64_tr_b16 v[164:165], v147 offset:14400
    v_mfma_f32_16x16x32_bf16 v[240:243], v[176:179], v[248:251], 0
    ds_read_b64_tr_b16 v[166:167], v147 offset:17472
    v_permlane16_swap_b32 v253, v252
    v_mfma_f32_16x16x32_bf16 v[140:143], v[180:183], v[48:51], 0
    ds_read_b64_tr_b16 v[168:169], v146 offset:14464
    v_mfma_f32_16x16x32_bf16 v[244:247], v[180:183], v[248:251], 0
    ds_read_b64_tr_b16 v[170:171], v146 offset:17536
    v_add_f32 v252, v252, v253
    s_waitcnt lgkmcnt(6)
    v_mfma_f32_16x16x32_bf16 v[120:123], v[184:187], v[52:55], v[120:123]
    ds_read_b64_tr_b16 v[172:173], v147 offset:14464
    v_mfma_f32_16x16x32_bf16 v[224:227], v[184:187], v[248:251], v[224:227]
    ds_read_b64_tr_b16 v[174:175], v147 offset:17536
    v_mov_b32 v255, v254
    v_mfma_f32_16x16x32_bf16 v[124:127], v[188:191], v[52:55], v[124:127]
    ds_read_b64_tr_b16 v[176:177], v146 offset:20480
    v_mfma_f32_16x16x32_bf16 v[228:231], v[188:191], v[248:251], v[228:231]
    ds_read_b64_tr_b16 v[178:179], v146 offset:23552
    v_permlane32_swap_b32 v255, v254
    s_waitcnt lgkmcnt(6)
    v_mfma_f32_16x16x32_bf16 v[128:131], v[160:163], v[52:55], v[128:131]
    ds_read_b64_tr_b16 v[180:181], v147 offset:20480
    v_mfma_f32_16x16x32_bf16 v[232:235], v[160:163], v[248:251], v[232:235]
    ds_read_b64_tr_b16 v[182:183], v147 offset:23552
    v_add_f32 v254, v254, v255
    v_mfma_f32_16x16x32_bf16 v[132:135], v[164:167], v[52:55], v[132:135]
    ds_read_b64_tr_b16 v[184:185], v146 offset:20544
    v_mfma_f32_16x16x32_bf16 v[236:239], v[164:167], v[248:251], v[236:239]
    ds_read_b64_tr_b16 v[186:187], v146 offset:23616
    v_mov_b32 v255, v254
    s_waitcnt lgkmcnt(6)
    v_mfma_f32_16x16x32_bf16 v[136:139], v[168:171], v[52:55], v[136:139]
    ds_read_b64_tr_b16 v[188:189], v147 offset:20544
    v_mfma_f32_16x16x32_bf16 v[240:243], v[168:171], v[248:251], v[240:243]
    ds_read_b64_tr_b16 v[190:191], v147 offset:23616
    v_permlane16_swap_b32 v255, v254
    v_mfma_f32_16x16x32_bf16 v[140:143], v[172:175], v[52:55], v[140:143]
    ds_read_b64_tr_b16 v[160:161], v146 offset:20608
    v_mfma_f32_16x16x32_bf16 v[244:247], v[172:175], v[248:251], v[244:247]
    ds_read_b64_tr_b16 v[162:163], v146 offset:23680
    v_add_f32 v254, v254, v255
    s_waitcnt lgkmcnt(6)
    v_mfma_f32_16x16x32_bf16 v[120:123], v[176:179], v[56:59], v[120:123]
    ds_read_b64_tr_b16 v[164:165], v147 offset:20608
    v_mfma_f32_16x16x32_bf16 v[224:227], v[176:179], v[248:251], v[224:227]
    ds_read_b64_tr_b16 v[166:167], v147 offset:23680
    v_mul_f32 v24, 0xbae38e39, v252
    v_mfma_f32_16x16x32_bf16 v[124:127], v[180:183], v[56:59], v[124:127]
    ds_read_b64_tr_b16 v[168:169], v146 offset:26624
    v_mfma_f32_16x16x32_bf16 v[228:231], v[180:183], v[248:251], v[228:231]
    ds_read_b64_tr_b16 v[170:171], v146 offset:29696
    v_mul_f32 v254, 0x3ae38e39, v254
    s_waitcnt lgkmcnt(6)
    v_mfma_f32_16x16x32_bf16 v[128:131], v[184:187], v[56:59], v[128:131]
    ds_read_b64_tr_b16 v[172:173], v147 offset:26624
    v_mfma_f32_16x16x32_bf16 v[232:235], v[184:187], v[248:251], v[232:235]
    ds_read_b64_tr_b16 v[174:175], v147 offset:29696
    v_fma_f32 v254, -v24, v24, v254
    v_mfma_f32_16x16x32_bf16 v[132:135], v[188:191], v[56:59], v[132:135]
    ds_read_b64_tr_b16 v[176:177], v146 offset:26688
    v_mfma_f32_16x16x32_bf16 v[236:239], v[188:191], v[248:251], v[236:239]
    ds_read_b64_tr_b16 v[178:179], v146 offset:29760
    v_max_f32 v254, 0, v254
    s_waitcnt lgkmcnt(6)
    v_mfma_f32_16x16x32_bf16 v[136:139], v[160:163], v[56:59], v[136:139]
    ds_read_b64_tr_b16 v[180:181], v147 offset:26688
    v_mfma_f32_16x16x32_bf16 v[240:243], v[160:163], v[248:251], v[240:243]
    ds_read_b64_tr_b16 v[182:183], v147 offset:29760
    v_add_f32 v254, 0x3727c5ac, v254
    v_mfma_f32_16x16x32_bf16 v[140:143], v[164:167], v[56:59], v[140:143]
    ds_read_b64_tr_b16 v[184:185], v146 offset:26752
    v_mfma_f32_16x16x32_bf16 v[244:247], v[164:167], v[248:251], v[244:247]
    ds_read_b64_tr_b16 v[186:187], v146 offset:29824
    v_rsq_f32 v252, v254
    s_waitcnt lgkmcnt(6)
    v_mfma_f32_16x16x32_bf16 v[120:123], v[168:171], v[60:63], v[120:123]
    ds_read_b64_tr_b16 v[188:189], v147 offset:26752
    v_mfma_f32_16x16x32_bf16 v[224:227], v[168:171], v[248:251], v[224:227]
    ds_read_b64_tr_b16 v[190:191], v147 offset:29824
    v_sqrt_f32 v27, v254
    v_mfma_f32_16x16x32_bf16 v[124:127], v[172:175], v[60:63], v[124:127]
    ds_read_b64_tr_b16 v[160:161], v146 offset:32768
    v_mfma_f32_16x16x32_bf16 v[228:231], v[172:175], v[248:251], v[228:231]
    ds_read_b64_tr_b16 v[162:163], v146 offset:35840
    v_mul_f32 v25, 0xc0135761, v252
    s_waitcnt lgkmcnt(6)
    v_mfma_f32_16x16x32_bf16 v[128:131], v[176:179], v[60:63], v[128:131]
    ds_read_b64_tr_b16 v[164:165], v147 offset:32768
    v_mfma_f32_16x16x32_bf16 v[232:235], v[176:179], v[248:251], v[232:235]
    ds_read_b64_tr_b16 v[166:167], v147 offset:35840
    v_mul_f32 v26, v252, v252
    v_mfma_f32_16x16x32_bf16 v[132:135], v[180:183], v[60:63], v[132:135]
    ds_read_b64_tr_b16 v[168:169], v146 offset:32832
    v_mfma_f32_16x16x32_bf16 v[236:239], v[180:183], v[248:251], v[236:239]
    ds_read_b64_tr_b16 v[170:171], v146 offset:35904
    v_mul_f32 v26, v26, v25
    s_waitcnt lgkmcnt(6)
    v_mfma_f32_16x16x32_bf16 v[136:139], v[184:187], v[60:63], v[136:139]
    ds_read_b64_tr_b16 v[172:173], v147 offset:32832
    v_mfma_f32_16x16x32_bf16 v[240:243], v[184:187], v[248:251], v[240:243]
    ds_read_b64_tr_b16 v[174:175], v147 offset:35904
    v_mul_f32 v26, 0x3d372713, v26
    v_mfma_f32_16x16x32_bf16 v[140:143], v[188:191], v[60:63], v[140:143]
    ds_read_b64_tr_b16 v[176:177], v146 offset:32896
    v_mfma_f32_16x16x32_bf16 v[244:247], v[188:191], v[248:251], v[244:247]
    ds_read_b64_tr_b16 v[178:179], v146 offset:35968
    s_waitcnt lgkmcnt(6)
    v_mfma_f32_16x16x32_bf16 v[120:123], v[160:163], v[64:67], v[120:123]
    ds_read_b64_tr_b16 v[180:181], v147 offset:32896
    v_mfma_f32_16x16x32_bf16 v[224:227], v[160:163], v[248:251], v[224:227]
    ds_read_b64_tr_b16 v[182:183], v147 offset:35968
    v_mfma_f32_16x16x32_bf16 v[124:127], v[164:167], v[64:67], v[124:127]
    ds_read_b64_tr_b16 v[184:185], v146 offset:38912
    v_mfma_f32_16x16x32_bf16 v[228:231], v[164:167], v[248:251], v[228:231]
    ds_read_b64_tr_b16 v[186:187], v146 offset:41984
    s_waitcnt lgkmcnt(6)
    v_mfma_f32_16x16x32_bf16 v[128:131], v[168:171], v[64:67], v[128:131]
    ds_read_b64_tr_b16 v[188:189], v147 offset:38912
    v_mfma_f32_16x16x32_bf16 v[232:235], v[168:171], v[248:251], v[232:235]
    ds_read_b64_tr_b16 v[190:191], v147 offset:41984
    v_mfma_f32_16x16x32_bf16 v[132:135], v[172:175], v[64:67], v[132:135]
    ds_read_b64_tr_b16 v[160:161], v146 offset:38976
    v_mfma_f32_16x16x32_bf16 v[236:239], v[172:175], v[248:251], v[236:239]
    ds_read_b64_tr_b16 v[162:163], v146 offset:42048
    s_waitcnt lgkmcnt(6)
    v_mfma_f32_16x16x32_bf16 v[136:139], v[176:179], v[64:67], v[136:139]
    ds_read_b64_tr_b16 v[164:165], v147 offset:38976
    v_mfma_f32_16x16x32_bf16 v[240:243], v[176:179], v[248:251], v[240:243]
    ds_read_b64_tr_b16 v[166:167], v147 offset:42048
    v_mfma_f32_16x16x32_bf16 v[140:143], v[180:183], v[64:67], v[140:143]
    ds_read_b64_tr_b16 v[168:169], v146 offset:39040
    v_mfma_f32_16x16x32_bf16 v[244:247], v[180:183], v[248:251], v[244:247]
    ds_read_b64_tr_b16 v[170:171], v146 offset:42112
    s_waitcnt lgkmcnt(6)
    v_mfma_f32_16x16x32_bf16 v[120:123], v[184:187], v[68:71], v[120:123]
    ds_read_b64_tr_b16 v[172:173], v147 offset:39040
    v_mfma_f32_16x16x32_bf16 v[224:227], v[184:187], v[248:251], v[224:227]
    ds_read_b64_tr_b16 v[174:175], v147 offset:42112
    v_mfma_f32_16x16x32_bf16 v[124:127], v[188:191], v[68:71], v[124:127]
    s_waitcnt vmcnt(17)
    s_barrier
    ds_read_b64_tr_b16 v[176:177], v146 offset:45056
    v_mfma_f32_16x16x32_bf16 v[228:231], v[188:191], v[248:251], v[228:231]
    ds_read_b64_tr_b16 v[178:179], v146 offset:48128
    s_waitcnt lgkmcnt(6)
    v_mfma_f32_16x16x32_bf16 v[128:131], v[160:163], v[68:71], v[128:131]
    ds_read_b64_tr_b16 v[180:181], v147 offset:45056
    v_mfma_f32_16x16x32_bf16 v[232:235], v[160:163], v[248:251], v[232:235]
    ds_read_b64_tr_b16 v[182:183], v147 offset:48128
    v_mfma_f32_16x16x32_bf16 v[132:135], v[164:167], v[68:71], v[132:135]
    ds_read_b64_tr_b16 v[184:185], v146 offset:45120
    v_mfma_f32_16x16x32_bf16 v[236:239], v[164:167], v[248:251], v[236:239]
    ds_read_b64_tr_b16 v[186:187], v146 offset:48192
    s_waitcnt lgkmcnt(6)
    v_mfma_f32_16x16x32_bf16 v[136:139], v[168:171], v[68:71], v[136:139]
    ds_read_b64_tr_b16 v[188:189], v147 offset:45120
    v_mfma_f32_16x16x32_bf16 v[240:243], v[168:171], v[248:251], v[240:243]
    ds_read_b64_tr_b16 v[190:191], v147 offset:48192
    v_mfma_f32_16x16x32_bf16 v[140:143], v[172:175], v[68:71], v[140:143]
    ds_read_b64_tr_b16 v[160:161], v146 offset:45184
    v_mfma_f32_16x16x32_bf16 v[244:247], v[172:175], v[248:251], v[244:247]
    ds_read_b64_tr_b16 v[162:163], v146 offset:48256
    s_waitcnt lgkmcnt(6)
    v_mfma_f32_16x16x32_bf16 v[120:123], v[176:179], v[72:75], v[120:123]
    ds_read_b64_tr_b16 v[164:165], v147 offset:45184
    v_mfma_f32_16x16x32_bf16 v[224:227], v[176:179], v[248:251], v[224:227]
    ds_read_b64_tr_b16 v[166:167], v147 offset:48256
    v_mfma_f32_16x16x32_bf16 v[124:127], v[180:183], v[72:75], v[124:127]
    ds_read_b64_tr_b16 v[168:169], v146 offset:51200
    v_mfma_f32_16x16x32_bf16 v[228:231], v[180:183], v[248:251], v[228:231]
    ds_read_b64_tr_b16 v[170:171], v146 offset:54272
    s_waitcnt lgkmcnt(6)
    v_mfma_f32_16x16x32_bf16 v[128:131], v[184:187], v[72:75], v[128:131]
    ds_read_b64_tr_b16 v[172:173], v147 offset:51200
    v_mfma_f32_16x16x32_bf16 v[232:235], v[184:187], v[248:251], v[232:235]
    ds_read_b64_tr_b16 v[174:175], v147 offset:54272
    v_mfma_f32_16x16x32_bf16 v[132:135], v[188:191], v[72:75], v[132:135]
    ds_read_b64_tr_b16 v[176:177], v146 offset:51264
    v_mfma_f32_16x16x32_bf16 v[236:239], v[188:191], v[248:251], v[236:239]
    ds_read_b64_tr_b16 v[178:179], v146 offset:54336
    s_waitcnt lgkmcnt(6)
    v_mfma_f32_16x16x32_bf16 v[136:139], v[160:163], v[72:75], v[136:139]
    ds_read_b64_tr_b16 v[180:181], v147 offset:51264
    v_mfma_f32_16x16x32_bf16 v[240:243], v[160:163], v[248:251], v[240:243]
    ds_read_b64_tr_b16 v[182:183], v147 offset:54336
    v_mfma_f32_16x16x32_bf16 v[140:143], v[164:167], v[72:75], v[140:143]
    ds_read_b64_tr_b16 v[184:185], v146 offset:51328
    v_mfma_f32_16x16x32_bf16 v[244:247], v[164:167], v[248:251], v[244:247]
    ds_read_b64_tr_b16 v[186:187], v146 offset:54400
    s_waitcnt lgkmcnt(6)
    v_mfma_f32_16x16x32_bf16 v[120:123], v[168:171], v[76:79], v[120:123]
    ds_read_b64_tr_b16 v[188:189], v147 offset:51328
    v_mfma_f32_16x16x32_bf16 v[224:227], v[168:171], v[248:251], v[224:227]
    ds_read_b64_tr_b16 v[190:191], v147 offset:54400
    buffer_load_dwordx4 a[0:3], v153, s[48:51], s99 offen offset:0
    buffer_load_dwordx4 a[4:7], v154, s[48:51], s99 offen offset:1024
    buffer_load_dwordx4 a[8:11], v155, s[48:51], s99 offen offset:2048
    v_mfma_f32_16x16x32_bf16 v[124:127], v[172:175], v[76:79], v[124:127]
    ds_read_b64_tr_b16 v[160:161], v146 offset:57344
    v_mfma_f32_16x16x32_bf16 v[228:231], v[172:175], v[248:251], v[228:231]
    ds_read_b64_tr_b16 v[162:163], v146 offset:60416
    s_waitcnt lgkmcnt(6)
    v_mfma_f32_16x16x32_bf16 v[128:131], v[176:179], v[76:79], v[128:131]
    ds_read_b64_tr_b16 v[164:165], v147 offset:57344
    v_mfma_f32_16x16x32_bf16 v[232:235], v[176:179], v[248:251], v[232:235]
    ds_read_b64_tr_b16 v[166:167], v147 offset:60416
    v_mfma_f32_16x16x32_bf16 v[132:135], v[180:183], v[76:79], v[132:135]
    ds_read_b64_tr_b16 v[168:169], v146 offset:57408
    v_mfma_f32_16x16x32_bf16 v[236:239], v[180:183], v[248:251], v[236:239]
    ds_read_b64_tr_b16 v[170:171], v146 offset:60480
    s_waitcnt lgkmcnt(6)
    v_mfma_f32_16x16x32_bf16 v[136:139], v[184:187], v[76:79], v[136:139]
    ds_read_b64_tr_b16 v[172:173], v147 offset:57408
    v_mfma_f32_16x16x32_bf16 v[240:243], v[184:187], v[248:251], v[240:243]
    ds_read_b64_tr_b16 v[174:175], v147 offset:60480
    v_mfma_f32_16x16x32_bf16 v[140:143], v[188:191], v[76:79], v[140:143]
    ds_read_b64_tr_b16 v[176:177], v146 offset:57472
    v_mfma_f32_16x16x32_bf16 v[244:247], v[188:191], v[248:251], v[244:247]
    ds_read_b64_tr_b16 v[178:179], v146 offset:60544
    s_waitcnt lgkmcnt(6)
    v_mfma_f32_16x16x32_bf16 v[120:123], v[160:163], v[80:83], v[120:123]
    ds_read_b64_tr_b16 v[180:181], v147 offset:57472
    v_mfma_f32_16x16x32_bf16 v[224:227], v[160:163], v[248:251], v[224:227]
    ds_read_b64_tr_b16 v[182:183], v147 offset:60544
    v_mfma_f32_16x16x32_bf16 v[124:127], v[164:167], v[80:83], v[124:127]
    ds_read_b64_tr_b16 v[184:185], v146 offset:63488
    v_mfma_f32_16x16x32_bf16 v[228:231], v[164:167], v[248:251], v[228:231]
    ds_read_b64_tr_b16 v[186:187], v148 offset:1024
    s_add_u32 s99, s99, s12
    buffer_load_dwordx4 a[12:15], v153, s[48:51], s99 offen offset:0
    buffer_load_dwordx4 a[16:19], v154, s[48:51], s99 offen offset:1024
    buffer_load_dwordx4 a[20:23], v155, s[48:51], s99 offen offset:2048
    s_waitcnt lgkmcnt(6)
    v_mfma_f32_16x16x32_bf16 v[128:131], v[168:171], v[80:83], v[128:131]
    ds_read_b64_tr_b16 v[188:189], v147 offset:63488
    v_mfma_f32_16x16x32_bf16 v[232:235], v[168:171], v[248:251], v[232:235]
    ds_read_b64_tr_b16 v[190:191], v149 offset:1024
    v_mfma_f32_16x16x32_bf16 v[132:135], v[172:175], v[80:83], v[132:135]
    ds_read_b64_tr_b16 v[160:161], v146 offset:63552
    v_mfma_f32_16x16x32_bf16 v[236:239], v[172:175], v[248:251], v[236:239]
    ds_read_b64_tr_b16 v[162:163], v148 offset:1088
    s_waitcnt lgkmcnt(6)
    v_mfma_f32_16x16x32_bf16 v[136:139], v[176:179], v[80:83], v[136:139]
    ds_read_b64_tr_b16 v[164:165], v147 offset:63552
    v_mfma_f32_16x16x32_bf16 v[240:243], v[176:179], v[248:251], v[240:243]
    ds_read_b64_tr_b16 v[166:167], v149 offset:1088
    v_mfma_f32_16x16x32_bf16 v[140:143], v[180:183], v[80:83], v[140:143]
    ds_read_b64_tr_b16 v[168:169], v146 offset:63616
    v_mfma_f32_16x16x32_bf16 v[244:247], v[180:183], v[248:251], v[244:247]
    ds_read_b64_tr_b16 v[170:171], v148 offset:1152
    s_waitcnt lgkmcnt(6)
    v_mfma_f32_16x16x32_bf16 v[120:123], v[184:187], v[84:87], v[120:123]
    ds_read_b64_tr_b16 v[172:173], v147 offset:63616
    v_mfma_f32_16x16x32_bf16 v[224:227], v[184:187], v[248:251], v[224:227]
    ds_read_b64_tr_b16 v[174:175], v149 offset:1152
    v_mfma_f32_16x16x32_bf16 v[124:127], v[188:191], v[84:87], v[124:127]
    s_waitcnt vmcnt(17)
    s_barrier
    ds_read_b64_tr_b16 v[176:177], v148 offset:4096
    v_mfma_f32_16x16x32_bf16 v[228:231], v[188:191], v[248:251], v[228:231]
    ds_read_b64_tr_b16 v[178:179], v148 offset:7168
    s_waitcnt lgkmcnt(6)
    v_mfma_f32_16x16x32_bf16 v[128:131], v[160:163], v[84:87], v[128:131]
    ds_read_b64_tr_b16 v[180:181], v149 offset:4096
    v_mfma_f32_16x16x32_bf16 v[232:235], v[160:163], v[248:251], v[232:235]
    ds_read_b64_tr_b16 v[182:183], v149 offset:7168
    s_add_u32 s99, s99, s12
    buffer_load_dwordx4 a[24:27], v153, s[48:51], s99 offen offset:0
    buffer_load_dwordx4 a[28:31], v154, s[48:51], s99 offen offset:1024
    buffer_load_dwordx4 a[32:35], v155, s[48:51], s99 offen offset:2048
    v_mfma_f32_16x16x32_bf16 v[132:135], v[164:167], v[84:87], v[132:135]
    ds_read_b64_tr_b16 v[184:185], v148 offset:4160
    v_mfma_f32_16x16x32_bf16 v[236:239], v[164:167], v[248:251], v[236:239]
    ds_read_b64_tr_b16 v[186:187], v148 offset:7232
    s_waitcnt lgkmcnt(6)
    v_mfma_f32_16x16x32_bf16 v[136:139], v[168:171], v[84:87], v[136:139]
    ds_read_b64_tr_b16 v[188:189], v149 offset:4160
    v_mfma_f32_16x16x32_bf16 v[240:243], v[168:171], v[248:251], v[240:243]
    ds_read_b64_tr_b16 v[190:191], v149 offset:7232
    v_mfma_f32_16x16x32_bf16 v[140:143], v[172:175], v[84:87], v[140:143]
    ds_read_b64_tr_b16 v[160:161], v148 offset:4224
    v_mfma_f32_16x16x32_bf16 v[244:247], v[172:175], v[248:251], v[244:247]
    ds_read_b64_tr_b16 v[162:163], v148 offset:7296
    s_waitcnt lgkmcnt(6)
    v_mfma_f32_16x16x32_bf16 v[120:123], v[176:179], v[88:91], v[120:123]
    ds_read_b64_tr_b16 v[164:165], v149 offset:4224
    v_mfma_f32_16x16x32_bf16 v[224:227], v[176:179], v[248:251], v[224:227]
    ds_read_b64_tr_b16 v[166:167], v149 offset:7296
    v_mfma_f32_16x16x32_bf16 v[124:127], v[180:183], v[88:91], v[124:127]
    ds_read_b64_tr_b16 v[168:169], v148 offset:10240
    v_mfma_f32_16x16x32_bf16 v[228:231], v[180:183], v[248:251], v[228:231]
    ds_read_b64_tr_b16 v[170:171], v148 offset:13312
    s_waitcnt lgkmcnt(6)
    v_mfma_f32_16x16x32_bf16 v[128:131], v[184:187], v[88:91], v[128:131]
    ds_read_b64_tr_b16 v[172:173], v149 offset:10240
    v_mfma_f32_16x16x32_bf16 v[232:235], v[184:187], v[248:251], v[232:235]
    ds_read_b64_tr_b16 v[174:175], v149 offset:13312
    v_mfma_f32_16x16x32_bf16 v[132:135], v[188:191], v[88:91], v[132:135]
    ds_read_b64_tr_b16 v[176:177], v148 offset:10304
    v_mfma_f32_16x16x32_bf16 v[236:239], v[188:191], v[248:251], v[236:239]
    ds_read_b64_tr_b16 v[178:179], v148 offset:13376
    s_add_u32 s99, s99, s12
    buffer_load_dwordx4 a[36:39], v153, s[48:51], s99 offen offset:0
    buffer_load_dwordx4 a[40:43], v154, s[48:51], s99 offen offset:1024
    buffer_load_dwordx4 a[44:47], v155, s[48:51], s99 offen offset:2048
    s_waitcnt lgkmcnt(6)
    v_mfma_f32_16x16x32_bf16 v[136:139], v[160:163], v[88:91], v[136:139]
    ds_read_b64_tr_b16 v[180:181], v149 offset:10304
    v_mfma_f32_16x16x32_bf16 v[240:243], v[160:163], v[248:251], v[240:243]
    ds_read_b64_tr_b16 v[182:183], v149 offset:13376
    v_mfma_f32_16x16x32_bf16 v[140:143], v[164:167], v[88:91], v[140:143]
    ds_read_b64_tr_b16 v[184:185], v148 offset:10368
    v_mfma_f32_16x16x32_bf16 v[244:247], v[164:167], v[248:251], v[244:247]
    ds_read_b64_tr_b16 v[186:187], v148 offset:13440
    s_waitcnt lgkmcnt(6)
    v_mfma_f32_16x16x32_bf16 v[120:123], v[168:171], v[92:95], v[120:123]
    ds_read_b64_tr_b16 v[188:189], v149 offset:10368
    v_mfma_f32_16x16x32_bf16 v[224:227], v[168:171], v[248:251], v[224:227]
    ds_read_b64_tr_b16 v[190:191], v149 offset:13440
    v_mfma_f32_16x16x32_bf16 v[124:127], v[172:175], v[92:95], v[124:127]
    ds_read_b64_tr_b16 v[160:161], v144 offset:0
    v_mfma_f32_16x16x32_bf16 v[228:231], v[172:175], v[248:251], v[228:231]
    ds_read_b64_tr_b16 v[162:163], v144 offset:3072
    s_waitcnt lgkmcnt(6)
    v_mfma_f32_16x16x32_bf16 v[128:131], v[176:179], v[92:95], v[128:131]
    ds_read_b64_tr_b16 v[164:165], v145 offset:0
    v_mfma_f32_16x16x32_bf16 v[232:235], v[176:179], v[248:251], v[232:235]
    ds_read_b64_tr_b16 v[166:167], v145 offset:3072
    v_mfma_f32_16x16x32_bf16 v[132:135], v[180:183], v[92:95], v[132:135]
    ds_read_b64_tr_b16 v[168:169], v144 offset:64
    v_mfma_f32_16x16x32_bf16 v[236:239], v[180:183], v[248:251], v[236:239]
    ds_read_b64_tr_b16 v[170:171], v144 offset:3136
    s_waitcnt lgkmcnt(6)
    v_mfma_f32_16x16x32_bf16 v[136:139], v[184:187], v[92:95], v[136:139]
    ds_read_b64_tr_b16 v[172:173], v145 offset:64
    v_mfma_f32_16x16x32_bf16 v[240:243], v[184:187], v[248:251], v[240:243]
    ds_read_b64_tr_b16 v[174:175], v145 offset:3136
    s_add_u32 s99, s99, s12
    buffer_load_dwordx4 a[48:51], v153, s[48:51], s99 offen offset:0
    buffer_load_dwordx4 a[52:55], v154, s[48:51], s99 offen offset:1024
    buffer_load_dwordx4 a[56:59], v155, s[48:51], s99 offen offset:2048
    v_mfma_f32_16x16x32_bf16 v[140:143], v[188:191], v[92:95], v[140:143]
    ds_read_b64_tr_b16 v[176:177], v144 offset:128
    v_mfma_f32_16x16x32_bf16 v[244:247], v[188:191], v[248:251], v[244:247]
    ds_read_b64_tr_b16 v[178:179], v144 offset:3200
    s_waitcnt lgkmcnt(6)
    v_mfma_f32_16x16x32_bf16 v[120:123], v[160:163], v[96:99], v[120:123]
    ds_read_b64_tr_b16 v[180:181], v145 offset:128
    v_mfma_f32_16x16x32_bf16 v[224:227], v[160:163], v[248:251], v[224:227]
    ds_read_b64_tr_b16 v[182:183], v145 offset:3200
    v_mfma_f32_16x16x32_bf16 v[124:127], v[164:167], v[96:99], v[124:127]
    ds_read_b64_tr_b16 v[184:185], v144 offset:6144
    v_mfma_f32_16x16x32_bf16 v[228:231], v[164:167], v[248:251], v[228:231]
    ds_read_b64_tr_b16 v[186:187], v144 offset:9216
    s_waitcnt lgkmcnt(6)
    v_mfma_f32_16x16x32_bf16 v[128:131], v[168:171], v[96:99], v[128:131]
    ds_read_b64_tr_b16 v[188:189], v145 offset:6144
    v_mfma_f32_16x16x32_bf16 v[232:235], v[168:171], v[248:251], v[232:235]
    ds_read_b64_tr_b16 v[190:191], v145 offset:9216
    v_mfma_f32_16x16x32_bf16 v[132:135], v[172:175], v[96:99], v[132:135]
    ds_read_b64_tr_b16 v[160:161], v144 offset:6208
    v_mfma_f32_16x16x32_bf16 v[236:239], v[172:175], v[248:251], v[236:239]
    ds_read_b64_tr_b16 v[162:163], v144 offset:9280
    s_waitcnt lgkmcnt(6)
    v_mfma_f32_16x16x32_bf16 v[136:139], v[176:179], v[96:99], v[136:139]
    ds_read_b64_tr_b16 v[164:165], v145 offset:6208
    v_mfma_f32_16x16x32_bf16 v[240:243], v[176:179], v[248:251], v[240:243]
    ds_read_b64_tr_b16 v[166:167], v145 offset:9280
    v_mfma_f32_16x16x32_bf16 v[140:143], v[180:183], v[96:99], v[140:143]
    ds_read_b64_tr_b16 v[168:169], v144 offset:6272
    v_mfma_f32_16x16x32_bf16 v[244:247], v[180:183], v[248:251], v[244:247]
    ds_read_b64_tr_b16 v[170:171], v144 offset:9344
    s_add_u32 s99, s99, s12
    buffer_load_dwordx4 a[60:63], v153, s[48:51], s99 offen offset:0
    buffer_load_dwordx4 a[64:67], v154, s[48:51], s99 offen offset:1024
    buffer_load_dwordx4 a[68:71], v155, s[48:51], s99 offen offset:2048
    s_waitcnt lgkmcnt(6)
    v_mfma_f32_16x16x32_bf16 v[120:123], v[184:187], v[100:103], v[120:123]
    ds_read_b64_tr_b16 v[172:173], v145 offset:6272
    v_mfma_f32_16x16x32_bf16 v[224:227], v[184:187], v[248:251], v[224:227]
    ds_read_b64_tr_b16 v[174:175], v145 offset:9344
    v_mfma_f32_16x16x32_bf16 v[124:127], v[188:191], v[100:103], v[124:127]
    s_waitcnt vmcnt(23)
    s_barrier
    ds_read_b64_tr_b16 v[176:177], v144 offset:12288
    v_mfma_f32_16x16x32_bf16 v[228:231], v[188:191], v[248:251], v[228:231]
    ds_read_b64_tr_b16 v[178:179], v144 offset:15360
    s_waitcnt lgkmcnt(6)
    v_mfma_f32_16x16x32_bf16 v[128:131], v[160:163], v[100:103], v[128:131]
    ds_read_b64_tr_b16 v[180:181], v145 offset:12288
    v_mfma_f32_16x16x32_bf16 v[232:235], v[160:163], v[248:251], v[232:235]
    ds_read_b64_tr_b16 v[182:183], v145 offset:15360
    v_mfma_f32_16x16x32_bf16 v[132:135], v[164:167], v[100:103], v[132:135]
    ds_read_b64_tr_b16 v[184:185], v144 offset:12352
    v_mfma_f32_16x16x32_bf16 v[236:239], v[164:167], v[248:251], v[236:239]
    ds_read_b64_tr_b16 v[186:187], v144 offset:15424
    s_waitcnt lgkmcnt(6)
    v_mfma_f32_16x16x32_bf16 v[136:139], v[168:171], v[100:103], v[136:139]
    ds_read_b64_tr_b16 v[188:189], v145 offset:12352
    v_mfma_f32_16x16x32_bf16 v[240:243], v[168:171], v[248:251], v[240:243]
    ds_read_b64_tr_b16 v[190:191], v145 offset:15424
    v_mfma_f32_16x16x32_bf16 v[140:143], v[172:175], v[100:103], v[140:143]
    ds_read_b64_tr_b16 v[160:161], v144 offset:12416
    v_mfma_f32_16x16x32_bf16 v[244:247], v[172:175], v[248:251], v[244:247]
    ds_read_b64_tr_b16 v[162:163], v144 offset:15488
    s_waitcnt lgkmcnt(6)
    v_mfma_f32_16x16x32_bf16 v[120:123], v[176:179], v[104:107], v[120:123]
    ds_read_b64_tr_b16 v[164:165], v145 offset:12416
    v_mfma_f32_16x16x32_bf16 v[224:227], v[176:179], v[248:251], v[224:227]
    ds_read_b64_tr_b16 v[166:167], v145 offset:15488
    s_add_u32 s99, s99, s12
    buffer_load_dwordx4 a[72:75], v153, s[48:51], s99 offen offset:0
    buffer_load_dwordx4 a[76:79], v154, s[48:51], s99 offen offset:1024
    buffer_load_dwordx4 a[80:83], v155, s[48:51], s99 offen offset:2048
    v_mfma_f32_16x16x32_bf16 v[124:127], v[180:183], v[104:107], v[124:127]
    ds_read_b64_tr_b16 v[168:169], v144 offset:18432
    v_mfma_f32_16x16x32_bf16 v[228:231], v[180:183], v[248:251], v[228:231]
    ds_read_b64_tr_b16 v[170:171], v144 offset:21504
    s_waitcnt lgkmcnt(6)
    v_mfma_f32_16x16x32_bf16 v[128:131], v[184:187], v[104:107], v[128:131]
    ds_read_b64_tr_b16 v[172:173], v145 offset:18432
    v_mfma_f32_16x16x32_bf16 v[232:235], v[184:187], v[248:251], v[232:235]
    ds_read_b64_tr_b16 v[174:175], v145 offset:21504
    v_mfma_f32_16x16x32_bf16 v[132:135], v[188:191], v[104:107], v[132:135]
    ds_read_b64_tr_b16 v[176:177], v144 offset:18496
    v_mfma_f32_16x16x32_bf16 v[236:239], v[188:191], v[248:251], v[236:239]
    ds_read_b64_tr_b16 v[178:179], v144 offset:21568
    s_waitcnt lgkmcnt(6)
    v_mfma_f32_16x16x32_bf16 v[136:139], v[160:163], v[104:107], v[136:139]
    ds_read_b64_tr_b16 v[180:181], v145 offset:18496
    v_mfma_f32_16x16x32_bf16 v[240:243], v[160:163], v[248:251], v[240:243]
    ds_read_b64_tr_b16 v[182:183], v145 offset:21568
    v_mfma_f32_16x16x32_bf16 v[140:143], v[164:167], v[104:107], v[140:143]
    ds_read_b64_tr_b16 v[184:185], v144 offset:18560
    v_mfma_f32_16x16x32_bf16 v[244:247], v[164:167], v[248:251], v[244:247]
    ds_read_b64_tr_b16 v[186:187], v144 offset:21632
    s_waitcnt lgkmcnt(6)
    v_mfma_f32_16x16x32_bf16 v[120:123], v[168:171], v[108:111], v[120:123]
    ds_read_b64_tr_b16 v[188:189], v145 offset:18560
    v_mfma_f32_16x16x32_bf16 v[224:227], v[168:171], v[248:251], v[224:227]
    ds_read_b64_tr_b16 v[190:191], v145 offset:21632
    v_mfma_f32_16x16x32_bf16 v[124:127], v[172:175], v[108:111], v[124:127]
    ds_read_b64_tr_b16 v[160:161], v144 offset:24576
    v_mfma_f32_16x16x32_bf16 v[228:231], v[172:175], v[248:251], v[228:231]
    ds_read_b64_tr_b16 v[162:163], v144 offset:27648
    s_add_u32 s99, s99, s12
    buffer_load_dwordx4 a[84:87], v153, s[48:51], s99 offen offset:0
    buffer_load_dwordx4 a[88:91], v154, s[48:51], s99 offen offset:1024
    buffer_load_dwordx4 a[92:95], v155, s[48:51], s99 offen offset:2048
    s_waitcnt lgkmcnt(6)
    v_mfma_f32_16x16x32_bf16 v[128:131], v[176:179], v[108:111], v[128:131]
    ds_read_b64_tr_b16 v[164:165], v145 offset:24576
    v_mfma_f32_16x16x32_bf16 v[232:235], v[176:179], v[248:251], v[232:235]
    ds_read_b64_tr_b16 v[166:167], v145 offset:27648
    v_mfma_f32_16x16x32_bf16 v[132:135], v[180:183], v[108:111], v[132:135]
    ds_read_b64_tr_b16 v[168:169], v144 offset:24640
    v_mfma_f32_16x16x32_bf16 v[236:239], v[180:183], v[248:251], v[236:239]
    ds_read_b64_tr_b16 v[170:171], v144 offset:27712
    s_waitcnt lgkmcnt(6)
    v_mfma_f32_16x16x32_bf16 v[136:139], v[184:187], v[108:111], v[136:139]
    ds_read_b64_tr_b16 v[172:173], v145 offset:24640
    v_mfma_f32_16x16x32_bf16 v[240:243], v[184:187], v[248:251], v[240:243]
    ds_read_b64_tr_b16 v[174:175], v145 offset:27712
    v_mfma_f32_16x16x32_bf16 v[140:143], v[188:191], v[108:111], v[140:143]
    ds_read_b64_tr_b16 v[176:177], v144 offset:24704
    v_mfma_f32_16x16x32_bf16 v[244:247], v[188:191], v[248:251], v[244:247]
    ds_read_b64_tr_b16 v[178:179], v144 offset:27776
    s_waitcnt lgkmcnt(6)
    v_mfma_f32_16x16x32_bf16 v[120:123], v[160:163], v[112:115], v[120:123]
    ds_read_b64_tr_b16 v[180:181], v145 offset:24704
    v_mfma_f32_16x16x32_bf16 v[224:227], v[160:163], v[248:251], v[224:227]
    ds_read_b64_tr_b16 v[182:183], v145 offset:27776
    v_mfma_f32_16x16x32_bf16 v[124:127], v[164:167], v[112:115], v[124:127]
    ds_read_b64_tr_b16 v[184:185], v144 offset:30720
    v_mfma_f32_16x16x32_bf16 v[228:231], v[164:167], v[248:251], v[228:231]
    ds_read_b64_tr_b16 v[186:187], v144 offset:33792
    s_waitcnt lgkmcnt(6)
    v_mfma_f32_16x16x32_bf16 v[128:131], v[168:171], v[112:115], v[128:131]
    ds_read_b64_tr_b16 v[188:189], v145 offset:30720
    v_mfma_f32_16x16x32_bf16 v[232:235], v[168:171], v[248:251], v[232:235]
    ds_read_b64_tr_b16 v[190:191], v145 offset:33792
    s_add_u32 s99, s99, s12
    buffer_load_dwordx4 a[96:99], v153, s[48:51], s99 offen offset:0
    buffer_load_dwordx4 a[100:103], v154, s[48:51], s99 offen offset:1024
    buffer_load_dwordx4 a[104:107], v155, s[48:51], s99 offen offset:2048
    v_mfma_f32_16x16x32_bf16 v[132:135], v[172:175], v[112:115], v[132:135]
    ds_read_b64_tr_b16 v[160:161], v144 offset:30784
    v_mfma_f32_16x16x32_bf16 v[236:239], v[172:175], v[248:251], v[236:239]
    ds_read_b64_tr_b16 v[162:163], v144 offset:33856
    s_waitcnt lgkmcnt(6)
    v_mfma_f32_16x16x32_bf16 v[136:139], v[176:179], v[112:115], v[136:139]
    ds_read_b64_tr_b16 v[164:165], v145 offset:30784
    v_mfma_f32_16x16x32_bf16 v[240:243], v[176:179], v[248:251], v[240:243]
    ds_read_b64_tr_b16 v[166:167], v145 offset:33856
    v_mfma_f32_16x16x32_bf16 v[140:143], v[180:183], v[112:115], v[140:143]
    ds_read_b64_tr_b16 v[168:169], v144 offset:30848
    v_mfma_f32_16x16x32_bf16 v[244:247], v[180:183], v[248:251], v[244:247]
    ds_read_b64_tr_b16 v[170:171], v144 offset:33920
    s_waitcnt lgkmcnt(6)
    v_mfma_f32_16x16x32_bf16 v[120:123], v[184:187], v[116:119], v[120:123]
    ds_read_b64_tr_b16 v[172:173], v145 offset:30848
    v_mfma_f32_16x16x32_bf16 v[224:227], v[184:187], v[248:251], v[224:227]
    ds_read_b64_tr_b16 v[174:175], v145 offset:33920
    v_mfma_f32_16x16x32_bf16 v[124:127], v[188:191], v[116:119], v[124:127]
    v_mfma_f32_16x16x32_bf16 v[228:231], v[188:191], v[248:251], v[228:231]
    s_waitcnt lgkmcnt(4)
    v_mfma_f32_16x16x32_bf16 v[128:131], v[160:163], v[116:119], v[128:131]
    v_mfma_f32_16x16x32_bf16 v[232:235], v[160:163], v[248:251], v[232:235]
    v_mfma_f32_16x16x32_bf16 v[132:135], v[164:167], v[116:119], v[132:135]
    v_mfma_f32_16x16x32_bf16 v[236:239], v[164:167], v[248:251], v[236:239]
    s_add_u32 m0, s91, 0
    s_nop 0
    buffer_load_dwordx4 v6, s[56:59], s7 offen offset:0 lds
    s_add_u32 m0, s91, 960
    s_nop 0
    buffer_load_dwordx4 v6, s[56:59], s7 offen offset:64 lds
    s_add_u32 m0, s91, 1920
    s_nop 0
    buffer_load_dwordx4 v6, s[56:59], s7 offen offset:128 lds
    buffer_load_dwordx2 v[204:205], v7, s[60:63], s7 offen offset:0
    buffer_load_dwordx2 v[206:207], v7, s[60:63], s7 offen offset:32
    buffer_load_dwordx2 v[208:209], v7, s[60:63], s7 offen offset:64
    buffer_load_dwordx2 v[210:211], v7, s[60:63], s7 offen offset:96
    buffer_load_dwordx2 v[212:213], v7, s[60:63], s7 offen offset:128
    buffer_load_dwordx2 v[214:215], v7, s[60:63], s7 offen offset:160
    s_waitcnt lgkmcnt(0)
    v_mfma_f32_16x16x32_bf16 v[136:139], v[168:171], v[116:119], v[136:139]
    v_mfma_f32_16x16x32_bf16 v[240:243], v[168:171], v[248:251], v[240:243]
    v_mfma_f32_16x16x32_bf16 v[140:143], v[172:175], v[116:119], v[140:143]
    v_mfma_f32_16x16x32_bf16 v[244:247], v[172:175], v[248:251], v[244:247]
    buffer_load_dword v12, v13, s[68:71], 0 offen sc1
    s_mov_b32 s48, s44
    s_mov_b32 s49, s45
    s_mov_b32 s50, 2377728
    s_mov_b32 s51, 0x20000
    v_mul_u32_u24 v5, 33024, v4
    s_mul_i32 s8, s95, 396288
    s_mul_i32 s46, s95, 6
    s_add_u32 s46, s46, 0
    s_cmp_lt_u32 s46, 27
    s_cselect_b32 s60, 2, -2
    s_cmp_lt_u32 s46, 18
    s_cselect_b32 s60, -1, s60
    s_cmp_lt_u32 s46, 9
    s_cselect_b32 s60, 1, s60
    v_fmac_f32 v120, v24, v224
    v_fmac_f32 v121, v24, v225
    v_fmac_f32 v122, v24, v226
    v_fmac_f32 v123, v24, v227
    v_mul_f32 v160, v120, v120
    v_mul_f32 v161, v121, v121
    v_mul_f32 v162, v122, v122
    v_mul_f32 v163, v123, v123
    v_fma_f32 v160, v160, v26, v25
    v_fma_f32 v161, v161, v26, v25
    v_fma_f32 v162, v162, v26, v25
    v_fma_f32 v163, v163, v26, v25
    v_mul_f32 v160, v120, v160
    v_mul_f32 v161, v121, v161
    v_mul_f32 v162, v122, v162
    v_mul_f32 v163, v123, v163
    v_exp_f32 v160, v160
    v_exp_f32 v161, v161
    v_exp_f32 v162, v162
    v_exp_f32 v163, v163
    v_add_u32 v6, s60, v3
    v_cmp_gt_u32 vcc, 0x800, v6
    v_and_b32 v6, 0x7ff, v6
    v_lshl_add_u32 v6, v6, 4, v5
    v_fma_f32 v160, v160, v27, v27
    v_fma_f32 v161, v161, v27, v27
    v_fma_f32 v162, v162, v27, v27
    v_fma_f32 v163, v163, v27, v27
    v_rcp_f32 v160, v160
    v_rcp_f32 v161, v161
    v_rcp_f32 v162, v162
    v_rcp_f32 v163, v163
    v_mul_f32 v160, v120, v160
    v_mul_f32 v161, v121, v161
    v_mul_f32 v162, v122, v162
    v_mul_f32 v163, v123, v163
    v_cvt_pk_bf16_f32 v48, v160, v161
    v_cvt_pk_bf16_f32 v49, v162, v163
    v_cndmask_b32 v48, 0, v48, vcc
    v_cndmask_b32 v49, 0, v49, vcc
    s_mul_i32 s46, s95, 6
    s_add_u32 s46, s46, 1
    s_cmp_lt_u32 s46, 27
    s_cselect_b32 s61, 2, -2
    s_cmp_lt_u32 s46, 18
    s_cselect_b32 s61, -1, s61
    s_cmp_lt_u32 s46, 9
    s_cselect_b32 s61, 1, s61
    v_fmac_f32 v124, v24, v228
    v_fmac_f32 v125, v24, v229
    v_fmac_f32 v126, v24, v230
    v_fmac_f32 v127, v24, v231
    v_mul_f32 v160, v124, v124
    v_mul_f32 v161, v125, v125
    v_mul_f32 v162, v126, v126
    v_mul_f32 v163, v127, v127
    v_fma_f32 v160, v160, v26, v25
    v_fma_f32 v161, v161, v26, v25
    v_fma_f32 v162, v162, v26, v25
    v_fma_f32 v163, v163, v26, v25
    v_mul_f32 v160, v124, v160
    v_mul_f32 v161, v125, v161
    v_mul_f32 v162, v126, v162
    v_mul_f32 v163, v127, v163
    v_exp_f32 v160, v160
    v_exp_f32 v161, v161
    v_exp_f32 v162, v162
    v_exp_f32 v163, v163
    v_add_u32 v7, s61, v3
    v_cmp_gt_u32 vcc, 0x800, v7
    v_and_b32 v7, 0x7ff, v7
    v_lshl_add_u32 v7, v7, 4, v5
    v_fma_f32 v160, v160, v27, v27
    v_fma_f32 v161, v161, v27, v27
    v_fma_f32 v162, v162, v27, v27
    v_fma_f32 v163, v163, v27, v27
    v_rcp_f32 v160, v160
    v_rcp_f32 v161, v161
    v_rcp_f32 v162, v162
    v_rcp_f32 v163, v163
    v_mul_f32 v160, v124, v160
    v_mul_f32 v161, v125, v161
    v_mul_f32 v162, v126, v162
    v_mul_f32 v163, v127, v163
    v_cvt_pk_bf16_f32 v50, v160, v161
    v_cvt_pk_bf16_f32 v51, v162, v163
    v_cndmask_b32 v50, 0, v50, vcc
    v_cndmask_b32 v51, 0, v51, vcc
    s_cmp_eq_u32 s60, s61
    s_cbranch_scc1 k1_st16_0
    buffer_store_dwordx2 v[48:49], v6, s[48:51], s8 offen offset:128 sc1
    buffer_store_dwordx2 v[50:51], v7, s[48:51], s8 offen offset:136 sc1
    s_branch k1_std_0
k1_st16_0:
    buffer_store_dwordx4 v[48:51], v6, s[48:51], s8 offen offset:128 sc1
k1_std_0:
    s_add_u32 s8, s8, 132096
    s_mul_i32 s46, s95, 6
    s_add_u32 s46, s46, 2
    s_cmp_lt_u32 s46, 27
    s_cselect_b32 s60, 2, -2
    s_cmp_lt_u32 s46, 18
    s_cselect_b32 s60, -1, s60
    s_cmp_lt_u32 s46, 9
    s_cselect_b32 s60, 1, s60
    v_fmac_f32 v128, v24, v232
    v_fmac_f32 v129, v24, v233
    v_fmac_f32 v130, v24, v234
    v_fmac_f32 v131, v24, v235
    v_mul_f32 v160, v128, v128
    v_mul_f32 v161, v129, v129
    v_mul_f32 v162, v130, v130
    v_mul_f32 v163, v131, v131
    v_fma_f32 v160, v160, v26, v25
    v_fma_f32 v161, v161, v26, v25
    v_fma_f32 v162, v162, v26, v25
    v_fma_f32 v163, v163, v26, v25
    v_mul_f32 v160, v128, v160
    v_mul_f32 v161, v129, v161
    v_mul_f32 v162, v130, v162
    v_mul_f32 v163, v131, v163
    v_exp_f32 v160, v160
    v_exp_f32 v161, v161
    v_exp_f32 v162, v162
    v_exp_f32 v163, v163
    v_add_u32 v6, s60, v3
    v_cmp_gt_u32 vcc, 0x800, v6
    v_and_b32 v6, 0x7ff, v6
    v_lshl_add_u32 v6, v6, 4, v5
    v_fma_f32 v160, v160, v27, v27
    v_fma_f32 v161, v161, v27, v27
    v_fma_f32 v162, v162, v27, v27
    v_fma_f32 v163, v163, v27, v27
    v_rcp_f32 v160, v160
    v_rcp_f32 v161, v161
    v_rcp_f32 v162, v162
    v_rcp_f32 v163, v163
    v_mul_f32 v160, v128, v160
    v_mul_f32 v161, v129, v161
    v_mul_f32 v162, v130, v162
    v_mul_f32 v163, v131, v163
    v_cvt_pk_bf16_f32 v52, v160, v161
    v_cvt_pk_bf16_f32 v53, v162, v163
    v_cndmask_b32 v52, 0, v52, vcc
    v_cndmask_b32 v53, 0, v53, vcc
    s_mul_i32 s46, s95, 6
    s_add_u32 s46, s46, 3
    s_cmp_lt_u32 s46, 27
    s_cselect_b32 s61, 2, -2
    s_cmp_lt_u32 s46, 18
    s_cselect_b32 s61, -1, s61
    s_cmp_lt_u32 s46, 9
    s_cselect_b32 s61, 1, s61
    v_fmac_f32 v132, v24, v236
    v_fmac_f32 v133, v24, v237
    v_fmac_f32 v134, v24, v238
    v_fmac_f32 v135, v24, v239
    v_mul_f32 v160, v132, v132
    v_mul_f32 v161, v133, v133
    v_mul_f32 v162, v134, v134
    v_mul_f32 v163, v135, v135
    v_fma_f32 v160, v160, v26, v25
    v_fma_f32 v161, v161, v26, v25
    v_fma_f32 v162, v162, v26, v25
    v_fma_f32 v163, v163, v26, v25
    v_mul_f32 v160, v132, v160
    v_mul_f32 v161, v133, v161
    v_mul_f32 v162, v134, v162
    v_mul_f32 v163, v135, v163
    v_exp_f32 v160, v160
    v_exp_f32 v161, v161
    v_exp_f32 v162, v162
    v_exp_f32 v163, v163
    v_add_u32 v7, s61, v3
    v_cmp_gt_u32 vcc, 0x800, v7
    v_and_b32 v7, 0x7ff, v7
    v_lshl_add_u32 v7, v7, 4, v5
    v_fma_f32 v160, v160, v27, v27
    v_fma_f32 v161, v161, v27, v27
    v_fma_f32 v162, v162, v27, v27
    v_fma_f32 v163, v163, v27, v27
    v_rcp_f32 v160, v160
    v_rcp_f32 v161, v161
    v_rcp_f32 v162, v162
    v_rcp_f32 v163, v163
    v_mul_f32 v160, v132, v160
    v_mul_f32 v161, v133, v161
    v_mul_f32 v162, v134, v162
    v_mul_f32 v163, v135, v163
    v_cvt_pk_bf16_f32 v54, v160, v161
    v_cvt_pk_bf16_f32 v55, v162, v163
    v_cndmask_b32 v54, 0, v54, vcc
    v_cndmask_b32 v55, 0, v55, vcc
    s_cmp_eq_u32 s60, s61
    s_cbranch_scc1 k1_st16_1
    buffer_store_dwordx2 v[52:53], v6, s[48:51], s8 offen offset:128 sc1
    buffer_store_dwordx2 v[54:55], v7, s[48:51], s8 offen offset:136 sc1
    s_branch k1_std_1
k1_st16_1:
    buffer_store_dwordx4 v[52:55], v6, s[48:51], s8 offen offset:128 sc1
k1_std_1:
    s_add_u32 s8, s8, 132096
    s_mul_i32 s46, s95, 6
    s_add_u32 s46, s46, 4
    s_cmp_lt_u32 s46, 27
    s_cselect_b32 s60, 2, -2
    s_cmp_lt_u32 s46, 18
    s_cselect_b32 s60, -1, s60
    s_cmp_lt_u32 s46, 9
    s_cselect_b32 s60, 1, s60
    v_fmac_f32 v136, v24, v240
    v_fmac_f32 v137, v24, v241
    v_fmac_f32 v138, v24, v242
    v_fmac_f32 v139, v24, v243
    v_mul_f32 v160, v136, v136
    v_mul_f32 v161, v137, v137
    v_mul_f32 v162, v138, v138
    v_mul_f32 v163, v139, v139
    v_fma_f32 v160, v160, v26, v25
    v_fma_f32 v161, v161, v26, v25
    v_fma_f32 v162, v162, v26, v25
    v_fma_f32 v163, v163, v26, v25
    v_mul_f32 v160, v136, v160
    v_mul_f32 v161, v137, v161
    v_mul_f32 v162, v138, v162
    v_mul_f32 v163, v139, v163
    v_exp_f32 v160, v160
    v_exp_f32 v161, v161
    v_exp_f32 v162, v162
    v_exp_f32 v163, v163
    v_add_u32 v6, s60, v3
    v_cmp_gt_u32 vcc, 0x800, v6
    v_and_b32 v6, 0x7ff, v6
    v_lshl_add_u32 v6, v6, 4, v5
    v_fma_f32 v160, v160, v27, v27
    v_fma_f32 v161, v161, v27, v27
    v_fma_f32 v162, v162, v27, v27
    v_fma_f32 v163, v163, v27, v27
    v_rcp_f32 v160, v160
    v_rcp_f32 v161, v161
    v_rcp_f32 v162, v162
    v_rcp_f32 v163, v163
    v_mul_f32 v160, v136, v160
    v_mul_f32 v161, v137, v161
    v_mul_f32 v162, v138, v162
    v_mul_f32 v163, v139, v163
    v_cvt_pk_bf16_f32 v56, v160, v161
    v_cvt_pk_bf16_f32 v57, v162, v163
    v_cndmask_b32 v56, 0, v56, vcc
    v_cndmask_b32 v57, 0, v57, vcc
    s_mul_i32 s46, s95, 6
    s_add_u32 s46, s46, 5
    s_cmp_lt_u32 s46, 27
    s_cselect_b32 s61, 2, -2
    s_cmp_lt_u32 s46, 18
    s_cselect_b32 s61, -1, s61
    s_cmp_lt_u32 s46, 9
    s_cselect_b32 s61, 1, s61
    v_fmac_f32 v140, v24, v244
    v_fmac_f32 v141, v24, v245
    v_fmac_f32 v142, v24, v246
    v_fmac_f32 v143, v24, v247
    v_mul_f32 v160, v140, v140
    v_mul_f32 v161, v141, v141
    v_mul_f32 v162, v142, v142
    v_mul_f32 v163, v143, v143
    v_fma_f32 v160, v160, v26, v25
    v_fma_f32 v161, v161, v26, v25
    v_fma_f32 v162, v162, v26, v25
    v_fma_f32 v163, v163, v26, v25
    v_mul_f32 v160, v140, v160
    v_mul_f32 v161, v141, v161
    v_mul_f32 v162, v142, v162
    v_mul_f32 v163, v143, v163
    v_exp_f32 v160, v160
    v_exp_f32 v161, v161
    v_exp_f32 v162, v162
    v_exp_f32 v163, v163
    v_add_u32 v7, s61, v3
    v_cmp_gt_u32 vcc, 0x800, v7
    v_and_b32 v7, 0x7ff, v7
    v_lshl_add_u32 v7, v7, 4, v5
    v_fma_f32 v160, v160, v27, v27
    v_fma_f32 v161, v161, v27, v27
    v_fma_f32 v162, v162, v27, v27
    v_fma_f32 v163, v163, v27, v27
    v_rcp_f32 v160, v160
    v_rcp_f32 v161, v161
    v_rcp_f32 v162, v162
    v_rcp_f32 v163, v163
    v_mul_f32 v160, v140, v160
    v_mul_f32 v161, v141, v161
    v_mul_f32 v162, v142, v162
    v_mul_f32 v163, v143, v163
    v_cvt_pk_bf16_f32 v58, v160, v161
    v_cvt_pk_bf16_f32 v59, v162, v163
    v_cndmask_b32 v58, 0, v58, vcc
    v_cndmask_b32 v59, 0, v59, vcc
    s_cmp_eq_u32 s60, s61
    s_cbranch_scc1 k1_st16_2
    buffer_store_dwordx2 v[56:57], v6, s[48:51], s8 offen offset:128 sc1
    buffer_store_dwordx2 v[58:59], v7, s[48:51], s8 offen offset:136 sc1
    s_branch k1_std_2
k1_st16_2:
    buffer_store_dwordx4 v[56:59], v6, s[48:51], s8 offen offset:128 sc1
k1_std_2:
    v_add_u32 v157, s14, v2
    v_add_u32 v158, 0x10000, v157
    v_add_u32 v159, 0x20000, v157
    s_barrier
    s_waitcnt vmcnt(4)
    ds_write_b128 v158, a[0:3] offset:8192
    ds_write_b128 v158, a[4:7] offset:9216
    ds_write_b128 v158, a[8:11] offset:10240
    ds_write_b128 v158, a[12:15] offset:20480
    ds_write_b128 v158, a[16:19] offset:21504
    ds_write_b128 v158, a[20:23] offset:22528
    ds_write_b128 v158, a[24:27] offset:32768
    ds_write_b128 v158, a[28:31] offset:33792
    ds_write_b128 v158, a[32:35] offset:34816
    ds_write_b128 v158, a[36:39] offset:45056
    ds_write_b128 v158, a[40:43] offset:46080
    ds_write_b128 v158, a[44:47] offset:47104
    ds_write_b128 v158, a[48:51] offset:57344
    ds_write_b128 v158, a[52:55] offset:58368
    ds_write_b128 v158, a[56:59] offset:59392
    ds_write_b128 v159, a[60:63] offset:4096
    ds_write_b128 v159, a[64:67] offset:5120
    ds_write_b128 v159, a[68:71] offset:6144
    ds_write_b128 v157, a[72:75] offset:0
    ds_write_b128 v157, a[76:79] offset:1024
    ds_write_b128 v157, a[80:83] offset:2048
    ds_write_b128 v157, a[84:87] offset:12288
    ds_write_b128 v157, a[88:91] offset:13312
    ds_write_b128 v157, a[92:95] offset:14336
    ds_write_b128 v157, a[96:99] offset:24576
    ds_write_b128 v157, a[100:103] offset:25600
    ds_write_b128 v157, a[104:107] offset:26624
    s_lshl_b32 s13, s5, 2
    s_add_u32 s13, s13, s3
    s_lshl_b32 s46, s13, 3
    s_add_u32 s46, s46, s95
    s_lshl_b32 s46, s46, 7
    s_add_u32 s46, s46, 32768
    v_min_u32 v6, 17, v1
    v_mul_u32_u24 v7, 43, v6
    v_lshrrev_b32 v7, 8, v7
    v_mul_u32_u24 v8, 6, v7
    v_sub_u32 v6, v6, v8
    s_add_u32 s13, s13, 127
    v_add_u32 v7, s13, v7
    v_and_b32 v7, 127, v7
    v_lshl_add_u32 v6, v7, 3, v6
    v_lshlrev_b32 v9, 7, v6
    v_add_u32 v9, 32768, v9
    s_waitcnt vmcnt(0)
    v_readfirstlane_b32 s90, v12
    s_nop 0
    s_cmp_lg_u32 s90, 0
    s_cbranch_scc1 k3_nok
    s_mov_b32 s68, s42
    s_mov_b32 s69, s43
    s_mov_b32 s70, 256
    s_mov_b32 s71, 0x20000
    v_mov_b32 v13, 0
    s_mov_b32 s91, 20000
nz0:
    buffer_load_dword v12, v13, s[68:71], 0 offen sc1
    s_sub_u32 s91, s91, 1
    s_cbranch_scc1 nk0
    s_waitcnt vmcnt(0)
    v_readfirstlane_b32 s90, v12
    s_nop 0
    s_cmp_eq_u32 s90, 0
    s_cbranch_scc1 nz0
nk0:
    s_waitcnt vmcnt(0)
    s_and_b32 s90, s90, 0xffffffe0
    s_add_u32 s68, s44, 21168128
    s_addc_u32 s69, s45, 0
    s_mov_b32 s70, 163840
    s_mov_b32 s71, 0x20000
k3_nok:
    s_and_b32 s90, s90, 0xffffffe0
    s_add_u32 s68, s44, 21168128
    s_addc_u32 s69, s45, 0
    s_mov_b32 s70, 163840
    s_mov_b32 s71, 0x20000
    v_lshlrev_b32 v13, 20, v1
    v_mov_b32 v12, s90
    buffer_store_dword v12, v13, s[68:71], s46 offen sc1
    v_lshl_add_u32 v5, v3, 4, v5
    s_waitcnt lgkmcnt(0)
    s_barrier
    ds_read_b64_tr_b16 a[0:1], v146 offset:8192
    ds_read_b64_tr_b16 a[2:3], v146 offset:11264
    ds_read_b64_tr_b16 a[4:5], v147 offset:8192
    ds_read_b64_tr_b16 a[6:7], v147 offset:11264
    ds_read_b64_tr_b16 a[8:9], v146 offset:8256
    ds_read_b64_tr_b16 a[10:11], v146 offset:11328
    ds_read_b64_tr_b16 a[12:13], v147 offset:8256
    ds_read_b64_tr_b16 a[14:15], v147 offset:11328
    ds_read_b64_tr_b16 a[16:17], v146 offset:8320
    ds_read_b64_tr_b16 a[18:19], v146 offset:11392
    ds_read_b64_tr_b16 a[20:21], v147 offset:8320
    ds_read_b64_tr_b16 a[22:23], v147 offset:11392
    ds_read_b64_tr_b16 a[24:25], v146 offset:14336
    ds_read_b64_tr_b16 a[26:27], v146 offset:17408
    ds_read_b64_tr_b16 a[28:29], v147 offset:14336
    ds_read_b64_tr_b16 a[30:31], v147 offset:17408
    ds_read_b64_tr_b16 a[32:33], v146 offset:14400
    ds_read_b64_tr_b16 a[34:35], v146 offset:17472
    ds_read_b64_tr_b16 a[36:37], v147 offset:14400
    ds_read_b64_tr_b16 a[38:39], v147 offset:17472
    ds_read_b64_tr_b16 a[40:41], v146 offset:14464
    ds_read_b64_tr_b16 a[42:43], v146 offset:17536
    ds_read_b64_tr_b16 a[44:45], v147 offset:14464
    ds_read_b64_tr_b16 a[46:47], v147 offset:17536
    ds_read_b64_tr_b16 a[48:49], v146 offset:20480
    ds_read_b64_tr_b16 a[50:51], v146 offset:23552
    ds_read_b64_tr_b16 a[52:53], v147 offset:20480
    ds_read_b64_tr_b16 a[54:55], v147 offset:23552
    ds_read_b64_tr_b16 a[56:57], v146 offset:20544
    ds_read_b64_tr_b16 a[58:59], v146 offset:23616
    ds_read_b64_tr_b16 a[60:61], v147 offset:20544
    ds_read_b64_tr_b16 a[62:63], v147 offset:23616
    ds_read_b64_tr_b16 a[64:65], v146 offset:20608
    ds_read_b64_tr_b16 a[66:67], v146 offset:23680
    ds_read_b64_tr_b16 a[68:69], v147 offset:20608
    ds_read_b64_tr_b16 a[70:71], v147 offset:23680
    ds_read_b64_tr_b16 a[72:73], v146 offset:26624
    ds_read_b64_tr_b16 a[74:75], v146 offset:29696
    ds_read_b64_tr_b16 a[76:77], v147 offset:26624
    ds_read_b64_tr_b16 a[78:79], v147 offset:29696
    ds_read_b64_tr_b16 a[80:81], v146 offset:26688
    ds_read_b64_tr_b16 a[82:83], v146 offset:29760
    ds_read_b64_tr_b16 a[84:85], v147 offset:26688
    ds_read_b64_tr_b16 a[86:87], v147 offset:29760
    ds_read_b64_tr_b16 a[88:89], v146 offset:26752
    ds_read_b64_tr_b16 a[90:91], v146 offset:29824
    ds_read_b64_tr_b16 a[92:93], v147 offset:26752
    ds_read_b64_tr_b16 a[94:95], v147 offset:29824
    ds_read_b64_tr_b16 a[96:97], v146 offset:32768
    ds_read_b64_tr_b16 a[98:99], v146 offset:35840
    ds_read_b64_tr_b16 a[100:101], v147 offset:32768
    ds_read_b64_tr_b16 a[102:103], v147 offset:35840
    ds_read_b64_tr_b16 a[104:105], v146 offset:32832
    ds_read_b64_tr_b16 a[106:107], v146 offset:35904
    ds_read_b64_tr_b16 a[108:109], v147 offset:32832
    ds_read_b64_tr_b16 a[110:111], v147 offset:35904
    ds_read_b64_tr_b16 a[112:113], v146 offset:32896
    ds_read_b64_tr_b16 a[114:115], v146 offset:35968
    ds_read_b64_tr_b16 a[116:117], v147 offset:32896
    ds_read_b64_tr_b16 a[118:119], v147 offset:35968
    ds_read_b64_tr_b16 a[120:121], v146 offset:38912
    ds_read_b64_tr_b16 a[122:123], v146 offset:41984
    ds_read_b64_tr_b16 a[124:125], v147 offset:38912
    ds_read_b64_tr_b16 a[126:127], v147 offset:41984
    ds_read_b64_tr_b16 a[128:129], v146 offset:38976
    ds_read_b64_tr_b16 a[130:131], v146 offset:42048
    ds_read_b64_tr_b16 a[132:133], v147 offset:38976
    ds_read_b64_tr_b16 a[134:135], v147 offset:42048
    ds_read_b64_tr_b16 a[136:137], v146 offset:39040
    ds_read_b64_tr_b16 a[138:139], v146 offset:42112
    ds_read_b64_tr_b16 a[140:141], v147 offset:39040
    ds_read_b64_tr_b16 a[142:143], v147 offset:42112
    ds_read_b64_tr_b16 a[144:145], v146 offset:45056
    ds_read_b64_tr_b16 a[146:147], v146 offset:48128
    ds_read_b64_tr_b16 a[148:149], v147 offset:45056
    ds_read_b64_tr_b16 a[150:151], v147 offset:48128
    ds_read_b64_tr_b16 a[152:153], v146 offset:45120
    ds_read_b64_tr_b16 a[154:155], v146 offset:48192
    ds_read_b64_tr_b16 a[156:157], v147 offset:45120
    ds_read_b64_tr_b16 a[158:159], v147 offset:48192
    ds_read_b64_tr_b16 a[160:161], v146 offset:45184
    ds_read_b64_tr_b16 a[162:163], v146 offset:48256
    ds_read_b64_tr_b16 a[164:165], v147 offset:45184
    ds_read_b64_tr_b16 a[166:167], v147 offset:48256
    ds_read_b64_tr_b16 a[168:169], v146 offset:51200
    ds_read_b64_tr_b16 a[170:171], v146 offset:54272
    ds_read_b64_tr_b16 a[172:173], v147 offset:51200
    ds_read_b64_tr_b16 a[174:175], v147 offset:54272
    ds_read_b64_tr_b16 a[176:177], v146 offset:51264
    ds_read_b64_tr_b16 a[178:179], v146 offset:54336
    ds_read_b64_tr_b16 a[180:181], v147 offset:51264
    ds_read_b64_tr_b16 a[182:183], v147 offset:54336
    ds_read_b64_tr_b16 a[184:185], v146 offset:51328
    ds_read_b64_tr_b16 a[186:187], v146 offset:54400
    ds_read_b64_tr_b16 a[188:189], v147 offset:51328
    ds_read_b64_tr_b16 a[190:191], v147 offset:54400
    ds_read_b64_tr_b16 a[192:193], v146 offset:57344
    ds_read_b64_tr_b16 a[194:195], v146 offset:60416
    ds_read_b64_tr_b16 a[196:197], v147 offset:57344
    ds_read_b64_tr_b16 a[198:199], v147 offset:60416
    ds_read_b64_tr_b16 a[200:201], v146 offset:57408
    ds_read_b64_tr_b16 a[202:203], v146 offset:60480
    ds_read_b64_tr_b16 a[204:205], v147 offset:57408
    ds_read_b64_tr_b16 a[206:207], v147 offset:60480
    ds_read_b64_tr_b16 a[208:209], v146 offset:57472
    ds_read_b64_tr_b16 a[210:211], v146 offset:60544
    ds_read_b64_tr_b16 a[212:213], v147 offset:57472
    ds_read_b64_tr_b16 a[214:215], v147 offset:60544
    ds_read_b64_tr_b16 a[216:217], v146 offset:63488
    ds_read_b64_tr_b16 a[218:219], v148 offset:1024
    ds_read_b64_tr_b16 a[220:221], v147 offset:63488
    ds_read_b64_tr_b16 a[222:223], v149 offset:1024
    ds_read_b64_tr_b16 a[224:225], v146 offset:63552
    ds_read_b64_tr_b16 a[226:227], v148 offset:1088
    ds_read_b64_tr_b16 a[228:229], v147 offset:63552
    ds_read_b64_tr_b16 a[230:231], v149 offset:1088
    ds_read_b64_tr_b16 a[232:233], v146 offset:63616
    ds_read_b64_tr_b16 a[234:235], v148 offset:1152
    ds_read_b64_tr_b16 a[236:237], v147 offset:63616
    ds_read_b64_tr_b16 a[238:239], v149 offset:1152
    ds_read_b64_tr_b16 a[240:241], v148 offset:4096
    ds_read_b64_tr_b16 a[242:243], v148 offset:7168
    ds_read_b64_tr_b16 a[244:245], v149 offset:4096
    ds_read_b64_tr_b16 a[246:247], v149 offset:7168
    ds_read_b64_tr_b16 a[248:249], v148 offset:4160
    ds_read_b64_tr_b16 a[250:251], v148 offset:7232
    ds_read_b64_tr_b16 a[252:253], v149 offset:4160
    ds_read_b64_tr_b16 a[254:255], v149 offset:7232
    ds_read_b64_tr_b16 v[240:241], v148 offset:4224
    ds_read_b64_tr_b16 v[242:243], v148 offset:7296
    ds_read_b64_tr_b16 v[244:245], v149 offset:4224
    ds_read_b64_tr_b16 v[246:247], v149 offset:7296
    buffer_load_dword v12, v9, s[68:71], 0 offen sc1
    s_waitcnt lgkmcnt(0)
    s_barrier
    v_mov_b32 v216, 0
    v_mov_b32 v217, 0
    v_mov_b32 v218, 0
    v_mov_b32 v219, 0
    v_min_u32 v20, 464, v2
    v_add_u32 v20, s0, v20
    v_and_b32 v21, 7, v1
    v_mul_u32_u24 v14, 4160, v21
    v_add_u32 v14, s1, v14
    ds_write_b128 v20, v[216:219] offset:4096
    ds_write_b128 v14, v[216:219]
    s_lshl_b32 s99, s96, 10
    s_add_u32 s99, s99, s1
    v_add_u32 v20, s99, v2
    ds_write_b128 v20, v[30:33] offset:12496
    ds_write_b128 v20, v[32:35] offset:29136
    v_mov_b32 v220, v29
    v_mov_b32 v221, v30
    v_mov_b32 v222, v31
    v_mov_b32 v223, v32
    v_mov_b32 v224, v33
    v_mov_b32 v225, v34
    v_alignbit_b32 v226, v29, v28, 16
    v_alignbit_b32 v227, v30, v29, 16
    v_alignbit_b32 v228, v31, v30, 16
    v_alignbit_b32 v229, v32, v31, 16
    v_alignbit_b32 v230, v33, v32, 16
    v_alignbit_b32 v231, v34, v33, 16
    v_alignbit_b32 v232, v35, v34, 16
    v_alignbit_b32 v234, v30, v29, 16
    v_alignbit_b32 v235, v31, v30, 16
    v_alignbit_b32 v236, v32, v31, 16
    v_alignbit_b32 v237, v33, v32, 16
    v_alignbit_b32 v238, v34, v33, 16
    v_alignbit_b32 v239, v35, v34, 16
    ds_write_b128 v20, v[226:229] offset:16
    ds_write_b128 v20, v[220:223] offset:4176
    ds_write_b128 v20, v[234:237] offset:8336
    ds_write_b128 v20, v[228:231] offset:16656
    ds_write_b128 v20, v[222:225] offset:20816
    ds_write_b128 v20, v[236:239] offset:24976
    ds_write_b128 v20, v[38:41] offset:14544
    ds_write_b128 v20, v[40:43] offset:31184
    v_mov_b32 v220, v37
    v_mov_b32 v221, v38
    v_mov_b32 v222, v39
    v_mov_b32 v223, v40
    v_mov_b32 v224, v41
    v_mov_b32 v225, v42
    v_alignbit_b32 v226, v37, v36, 16
    v_alignbit_b32 v227, v38, v37, 16
    v_alignbit_b32 v228, v39, v38, 16
    v_alignbit_b32 v229, v40, v39, 16
    v_alignbit_b32 v230, v41, v40, 16
    v_alignbit_b32 v231, v42, v41, 16
    v_alignbit_b32 v232, v43, v42, 16
    v_alignbit_b32 v234, v38, v37, 16
    v_alignbit_b32 v235, v39, v38, 16
    v_alignbit_b32 v236, v40, v39, 16
    v_alignbit_b32 v237, v41, v40, 16
    v_alignbit_b32 v238, v42, v41, 16
    v_alignbit_b32 v239, v43, v42, 16
    ds_write_b128 v20, v[226:229] offset:2064
    ds_write_b128 v20, v[220:223] offset:6224
    ds_write_b128 v20, v[234:237] offset:10384
    ds_write_b128 v20, v[228:231] offset:18704
    ds_write_b128 v20, v[222:225] offset:22864
    ds_write_b128 v20, v[236:239] offset:27024
    s_waitcnt vmcnt(0)
    v_subrev_u32 v12, s90, v12
    v_cmp_lt_u32 vcc, 0, v12
    s_mov_b32 s91, 20000
    s_nop 0
    s_cbranch_vccz ck1
cr1:
    s_sleep 2
    buffer_load_dword v12, v9, s[68:71], 0 offen sc1
    s_sub_u32 s91, s91, 1
    s_waitcnt vmcnt(0)
    v_subrev_u32 v12, s90, v12
    v_cmp_lt_u32 vcc, 0, v12
    s_cbranch_scc1 ck1
    s_nop 0
    s_cbranch_vccnz cr1
ck1:
    s_mov_b32 s8, 0
    s_mov_b32 s12, 132096
    buffer_load_dwordx4 v[48:51], v5, s[48:51], s8 offen offset:128 sc1
    s_add_u32 s8, s8, s12
    buffer_load_dwordx4 v[52:55], v5, s[48:51], s8 offen offset:128 sc1
    s_add_u32 s8, s8, s12
    buffer_load_dwordx4 v[56:59], v5, s[48:51], s8 offen offset:128 sc1
    s_add_u32 s8, s8, s12
    buffer_load_dwordx4 v[60:63], v5, s[48:51], s8 offen offset:128 sc1
    s_add_u32 s8, s8, s12
    buffer_load_dwordx4 v[64:67], v5, s[48:51], s8 offen offset:128 sc1
    s_add_u32 s8, s8, s12
    buffer_load_dwordx4 v[68:71], v5, s[48:51], s8 offen offset:128 sc1
    s_add_u32 s8, s8, s12
    buffer_load_dwordx4 v[72:75], v5, s[48:51], s8 offen offset:128 sc1
    s_add_u32 s8, s8, s12
    buffer_load_dwordx4 v[76:79], v5, s[48:51], s8 offen offset:128 sc1
    v_and_b32 v13, 31, v1
    v_lshlrev_b32 v13, 2, v13
    s_lshr_b32 s13, s2, 5
    s_lshl_b32 s13, s13, 7
    s_add_u32 s13, s13, 26624
    s_waitcnt vmcnt(7)
    v_mfma_f32_16x16x32_bf16 v[120:123], a[0:3], v[48:51], 0
    s_add_u32 s8, s8, s12
    buffer_load_dwordx4 v[80:83], v5, s[48:51], s8 offen offset:128 sc1
    v_mfma_f32_16x16x32_bf16 v[124:127], a[4:7], v[48:51], 0
    v_mfma_f32_16x16x32_bf16 v[128:131], a[8:11], v[48:51], 0
    s_add_u32 s8, s8, s12
    buffer_load_dwordx4 v[84:87], v5, s[48:51], s8 offen offset:128 sc1
    v_mfma_f32_16x16x32_bf16 v[132:135], a[12:15], v[48:51], 0
    v_mfma_f32_16x16x32_bf16 v[136:139], a[16:19], v[48:51], 0
    s_add_u32 s8, s8, s12
    buffer_load_dwordx4 v[88:91], v5, s[48:51], s8 offen offset:128 sc1
    v_mfma_f32_16x16x32_bf16 v[140:143], a[20:23], v[48:51], 0
    s_waitcnt vmcnt(9)
    v_mfma_f32_16x16x32_bf16 v[120:123], a[24:27], v[52:55], v[120:123]
    s_add_u32 s8, s8, s12
    buffer_load_dwordx4 v[92:95], v5, s[48:51], s8 offen offset:128 sc1
    v_mfma_f32_16x16x32_bf16 v[124:127], a[28:31], v[52:55], v[124:127]
    v_mfma_f32_16x16x32_bf16 v[128:131], a[32:35], v[52:55], v[128:131]
    s_add_u32 s8, s8, s12
    buffer_load_dwordx4 v[96:99], v5, s[48:51], s8 offen offset:128 sc1
    v_mfma_f32_16x16x32_bf16 v[132:135], a[36:39], v[52:55], v[132:135]
    v_mfma_f32_16x16x32_bf16 v[136:139], a[40:43], v[52:55], v[136:139]
    s_add_u32 s8, s8, s12
    buffer_load_dwordx4 v[100:103], v5, s[48:51], s8 offen offset:128 sc1
    v_mfma_f32_16x16x32_bf16 v[140:143], a[44:47], v[52:55], v[140:143]
    s_waitcnt vmcnt(11)
    v_mfma_f32_16x16x32_bf16 v[120:123], a[48:51], v[56:59], v[120:123]
    s_add_u32 s8, s8, s12
    buffer_load_dwordx4 v[104:107], v5, s[48:51], s8 offen offset:128 sc1
    v_mfma_f32_16x16x32_bf16 v[124:127], a[52:55], v[56:59], v[124:127]
    v_mfma_f32_16x16x32_bf16 v[128:131], a[56:59], v[56:59], v[128:131]
    s_add_u32 s8, s8, s12
    buffer_load_dwordx4 v[108:111], v5, s[48:51], s8 offen offset:128 sc1
    v_mfma_f32_16x16x32_bf16 v[132:135], a[60:63], v[56:59], v[132:135]
    v_mfma_f32_16x16x32_bf16 v[136:139], a[64:67], v[56:59], v[136:139]
    s_add_u32 s8, s8, s12
    buffer_load_dwordx4 v[112:115], v5, s[48:51], s8 offen offset:128 sc1
    v_mfma_f32_16x16x32_bf16 v[140:143], a[68:71], v[56:59], v[140:143]
    s_waitcnt vmcnt(13)
    v_mfma_f32_16x16x32_bf16 v[120:123], a[72:75], v[60:63], v[120:123]
    s_add_u32 s8, s8, s12
    buffer_load_dwordx4 v[116:119], v5, s[48:51], s8 offen offset:128 sc1
    v_mfma_f32_16x16x32_bf16 v[124:127], a[76:79], v[60:63], v[124:127]
    buffer_load_dword v12, v13, s[68:71], s13 offen sc1
    s_mov_b32 s94, s13
    s_mul_i32 s47, s4, 663552
    s_add_u32 s64, s36, s47
    s_addc_u32 s65, s37, 0
    s_mov_b32 s66, 663552
    s_mov_b32 s67, 0x20000
    v_lshrrev_b32 v20, 3, v1
    v_and_b32 v21, 6, v20
    v_and_b32 v22, 7, v1
    v_xor_b32 v21, v21, v22
    v_lshlrev_b32 v21, 4, v21
    v_mul_u32_u24 v20, 1152, v20
    v_add_u32 v19, v20, v21
    s_lshl_b32 s13, s5, 2
    s_add_u32 s13, s13, s3
    s_mul_i32 s15, s13, 57
    s_lshr_b32 s15, s15, 9
    s_mul_i32 s46, s15, 9
    s_sub_u32 s46, s13, s46
    s_mul_i32 s15, s15, 36864
    s_lshl_b32 s46, s46, 7
    s_add_u32 s15, s15, s46
    s_lshl_b32 s47, s3, 10
    s_add_u32 m0, s47, 53248
    s_nop 0
    buffer_load_dwordx4 v19, s[64:67], s15 offen nt lds
    s_add_u32 m0, m0, 0x1000
    s_add_u32 s15, s15, 9216
    buffer_load_dwordx4 v19, s[64:67], s15 offen nt lds
    s_add_u32 m0, m0, 0x1000
    s_add_u32 s15, s15, 9216
    buffer_load_dwordx4 v19, s[64:67], s15 offen nt lds
    s_add_u32 m0, m0, 0x1000
    s_add_u32 s15, s15, 9216
    buffer_load_dwordx4 v19, s[64:67], s15 offen nt lds
    s_mov_b32 s13, s94
    v_mfma_f32_16x16x32_bf16 v[128:131], a[80:83], v[60:63], v[128:131]
    v_mfma_f32_16x16x32_bf16 v[132:135], a[84:87], v[60:63], v[132:135]
    v_mfma_f32_16x16x32_bf16 v[136:139], a[88:91], v[60:63], v[136:139]
    v_mfma_f32_16x16x32_bf16 v[140:143], a[92:95], v[60:63], v[140:143]
    s_waitcnt vmcnt(18)
    v_mfma_f32_16x16x32_bf16 v[120:123], a[96:99], v[64:67], v[120:123]
    v_mfma_f32_16x16x32_bf16 v[124:127], a[100:103], v[64:67], v[124:127]
    v_mfma_f32_16x16x32_bf16 v[128:131], a[104:107], v[64:67], v[128:131]
    v_mfma_f32_16x16x32_bf16 v[132:135], a[108:111], v[64:67], v[132:135]
    v_mfma_f32_16x16x32_bf16 v[136:139], a[112:115], v[64:67], v[136:139]
    v_mfma_f32_16x16x32_bf16 v[140:143], a[116:119], v[64:67], v[140:143]
    s_waitcnt vmcnt(17)
    v_mfma_f32_16x16x32_bf16 v[120:123], a[120:123], v[68:71], v[120:123]
    v_mfma_f32_16x16x32_bf16 v[124:127], a[124:127], v[68:71], v[124:127]
    v_mfma_f32_16x16x32_bf16 v[128:131], a[128:131], v[68:71], v[128:131]
    v_mfma_f32_16x16x32_bf16 v[132:135], a[132:135], v[68:71], v[132:135]
    v_mfma_f32_16x16x32_bf16 v[136:139], a[136:139], v[68:71], v[136:139]
    v_mfma_f32_16x16x32_bf16 v[140:143], a[140:143], v[68:71], v[140:143]
    s_waitcnt vmcnt(16)
    v_mfma_f32_16x16x32_bf16 v[120:123], a[144:147], v[72:75], v[120:123]
    v_mfma_f32_16x16x32_bf16 v[124:127], a[148:151], v[72:75], v[124:127]
    v_mfma_f32_16x16x32_bf16 v[128:131], a[152:155], v[72:75], v[128:131]
    v_mfma_f32_16x16x32_bf16 v[132:135], a[156:159], v[72:75], v[132:135]
    v_mfma_f32_16x16x32_bf16 v[136:139], a[160:163], v[72:75], v[136:139]
    v_mfma_f32_16x16x32_bf16 v[140:143], a[164:167], v[72:75], v[140:143]
    s_waitcnt vmcnt(15)
    v_mfma_f32_16x16x32_bf16 v[120:123], a[168:171], v[76:79], v[120:123]
    v_mfma_f32_16x16x32_bf16 v[124:127], a[172:175], v[76:79], v[124:127]
    v_mfma_f32_16x16x32_bf16 v[128:131], a[176:179], v[76:79], v[128:131]
    v_mfma_f32_16x16x32_bf16 v[132:135], a[180:183], v[76:79], v[132:135]
    v_mfma_f32_16x16x32_bf16 v[136:139], a[184:187], v[76:79], v[136:139]
    v_mfma_f32_16x16x32_bf16 v[140:143], a[188:191], v[76:79], v[140:143]
    s_waitcnt vmcnt(14)
    v_mfma_f32_16x16x32_bf16 v[120:123], a[192:195], v[80:83], v[120:123]
    v_mfma_f32_16x16x32_bf16 v[124:127], a[196:199], v[80:83], v[124:127]
    v_mfma_f32_16x16x32_bf16 v[128:131], a[200:203], v[80:83], v[128:131]
    v_mfma_f32_16x16x32_bf16 v[132:135], a[204:207], v[80:83], v[132:135]
    v_mfma_f32_16x16x32_bf16 v[136:139], a[208:211], v[80:83], v[136:139]
    v_mfma_f32_16x16x32_bf16 v[140:143], a[212:215], v[80:83], v[140:143]
    s_waitcnt vmcnt(13)
    v_mfma_f32_16x16x32_bf16 v[120:123], a[216:219], v[84:87], v[120:123]
    v_mfma_f32_16x16x32_bf16 v[124:127], a[220:223], v[84:87], v[124:127]
    v_mfma_f32_16x16x32_bf16 v[128:131], a[224:227], v[84:87], v[128:131]
    v_mfma_f32_16x16x32_bf16 v[132:135], a[228:231], v[84:87], v[132:135]
    v_mfma_f32_16x16x32_bf16 v[136:139], a[232:235], v[84:87], v[136:139]
    v_mfma_f32_16x16x32_bf16 v[140:143], a[236:239], v[84:87], v[140:143]
    s_waitcnt vmcnt(12)
    v_mfma_f32_16x16x32_bf16 v[120:123], a[240:243], v[88:91], v[120:123]
    v_mfma_f32_16x16x32_bf16 v[124:127], a[244:247], v[88:91], v[124:127]
    ds_read_b64_tr_b16 v[168:169], v148 offset:10240
    ds_read_b64_tr_b16 v[170:171], v148 offset:13312
    v_mfma_f32_16x16x32_bf16 v[128:131], a[248:251], v[88:91], v[128:131]
    ds_read_b64_tr_b16 v[172:173], v149 offset:10240
    ds_read_b64_tr_b16 v[174:175], v149 offset:13312
    v_mfma_f32_16x16x32_bf16 v[132:135], a[252:255], v[88:91], v[132:135]
    ds_read_b64_tr_b16 v[176:177], v148 offset:10304
    ds_read_b64_tr_b16 v[178:179], v148 offset:13376
    v_mfma_f32_16x16x32_bf16 v[136:139], v[240:243], v[88:91], v[136:139]
    ds_read_b64_tr_b16 v[180:181], v149 offset:10304
    ds_read_b64_tr_b16 v[182:183], v149 offset:13376
    v_mfma_f32_16x16x32_bf16 v[140:143], v[244:247], v[88:91], v[140:143]
    ds_read_b64_tr_b16 v[184:185], v148 offset:10368
    ds_read_b64_tr_b16 v[186:187], v148 offset:13440
    s_waitcnt lgkmcnt(6)
    s_waitcnt vmcnt(11)
    v_mfma_f32_16x16x32_bf16 v[120:123], v[168:171], v[92:95], v[120:123]
    ds_read_b64_tr_b16 v[188:189], v149 offset:10368
    ds_read_b64_tr_b16 v[190:191], v149 offset:13440
    v_mfma_f32_16x16x32_bf16 v[124:127], v[172:175], v[92:95], v[124:127]
    ds_read_b64_tr_b16 v[160:161], v144 offset:0
    ds_read_b64_tr_b16 v[162:163], v144 offset:3072
    s_waitcnt lgkmcnt(6)
    v_mfma_f32_16x16x32_bf16 v[128:131], v[176:179], v[92:95], v[128:131]
    ds_read_b64_tr_b16 v[164:165], v145 offset:0
    ds_read_b64_tr_b16 v[166:167], v145 offset:3072
    v_mfma_f32_16x16x32_bf16 v[132:135], v[180:183], v[92:95], v[132:135]
    ds_read_b64_tr_b16 v[168:169], v144 offset:64
    ds_read_b64_tr_b16 v[170:171], v144 offset:3136
    s_waitcnt lgkmcnt(6)
    v_mfma_f32_16x16x32_bf16 v[136:139], v[184:187], v[92:95], v[136:139]
    ds_read_b64_tr_b16 v[172:173], v145 offset:64
    ds_read_b64_tr_b16 v[174:175], v145 offset:3136
    v_mfma_f32_16x16x32_bf16 v[140:143], v[188:191], v[92:95], v[140:143]
    ds_read_b64_tr_b16 v[176:177], v144 offset:128
    ds_read_b64_tr_b16 v[178:179], v144 offset:3200
    s_waitcnt lgkmcnt(6)
    s_waitcnt vmcnt(10)
    v_mfma_f32_16x16x32_bf16 v[120:123], v[160:163], v[96:99], v[120:123]
    ds_read_b64_tr_b16 v[180:181], v145 offset:128
    ds_read_b64_tr_b16 v[182:183], v145 offset:3200
    v_mfma_f32_16x16x32_bf16 v[124:127], v[164:167], v[96:99], v[124:127]
    ds_read_b64_tr_b16 v[184:185], v144 offset:6144
    ds_read_b64_tr_b16 v[186:187], v144 offset:9216
    s_waitcnt lgkmcnt(6)
    v_mfma_f32_16x16x32_bf16 v[128:131], v[168:171], v[96:99], v[128:131]
    ds_read_b64_tr_b16 v[188:189], v145 offset:6144
    ds_read_b64_tr_b16 v[190:191], v145 offset:9216
    v_mfma_f32_16x16x32_bf16 v[132:135], v[172:175], v[96:99], v[132:135]
    ds_read_b64_tr_b16 v[160:161], v144 offset:6208
    ds_read_b64_tr_b16 v[162:163], v144 offset:9280
    s_waitcnt lgkmcnt(6)
    v_mfma_f32_16x16x32_bf16 v[136:139], v[176:179], v[96:99], v[136:139]
    ds_read_b64_tr_b16 v[164:165], v145 offset:6208
    ds_read_b64_tr_b16 v[166:167], v145 offset:9280
    v_mfma_f32_16x16x32_bf16 v[140:143], v[180:183], v[96:99], v[140:143]
    ds_read_b64_tr_b16 v[168:169], v144 offset:6272
    ds_read_b64_tr_b16 v[170:171], v144 offset:9344
    s_waitcnt lgkmcnt(6)
    s_waitcnt vmcnt(9)
    v_mfma_f32_16x16x32_bf16 v[120:123], v[184:187], v[100:103], v[120:123]
    ds_read_b64_tr_b16 v[172:173], v145 offset:6272
    ds_read_b64_tr_b16 v[174:175], v145 offset:9344
    v_mfma_f32_16x16x32_bf16 v[124:127], v[188:191], v[100:103], v[124:127]
    ds_read_b64_tr_b16 v[176:177], v144 offset:12288
    ds_read_b64_tr_b16 v[178:179], v144 offset:15360
    s_waitcnt lgkmcnt(6)
    v_mfma_f32_16x16x32_bf16 v[128:131], v[160:163], v[100:103], v[128:131]
    ds_read_b64_tr_b16 v[180:181], v145 offset:12288
    ds_read_b64_tr_b16 v[182:183], v145 offset:15360
    v_mfma_f32_16x16x32_bf16 v[132:135], v[164:167], v[100:103], v[132:135]
    ds_read_b64_tr_b16 v[184:185], v144 offset:12352
    ds_read_b64_tr_b16 v[186:187], v144 offset:15424
    s_waitcnt lgkmcnt(6)
    v_mfma_f32_16x16x32_bf16 v[136:139], v[168:171], v[100:103], v[136:139]
    ds_read_b64_tr_b16 v[188:189], v145 offset:12352
    ds_read_b64_tr_b16 v[190:191], v145 offset:15424
    v_mfma_f32_16x16x32_bf16 v[140:143], v[172:175], v[100:103], v[140:143]
    ds_read_b64_tr_b16 v[160:161], v144 offset:12416
    ds_read_b64_tr_b16 v[162:163], v144 offset:15488
    s_waitcnt lgkmcnt(6)
    s_waitcnt vmcnt(8)
    v_mfma_f32_16x16x32_bf16 v[120:123], v[176:179], v[104:107], v[120:123]
    ds_read_b64_tr_b16 v[164:165], v145 offset:12416
    ds_read_b64_tr_b16 v[166:167], v145 offset:15488
    v_mfma_f32_16x16x32_bf16 v[124:127], v[180:183], v[104:107], v[124:127]
    ds_read_b64_tr_b16 v[168:169], v144 offset:18432
    ds_read_b64_tr_b16 v[170:171], v144 offset:21504
    s_waitcnt lgkmcnt(6)
    v_mfma_f32_16x16x32_bf16 v[128:131], v[184:187], v[104:107], v[128:131]
    ds_read_b64_tr_b16 v[172:173], v145 offset:18432
    ds_read_b64_tr_b16 v[174:175], v145 offset:21504
    v_mfma_f32_16x16x32_bf16 v[132:135], v[188:191], v[104:107], v[132:135]
    ds_read_b64_tr_b16 v[176:177], v144 offset:18496
    ds_read_b64_tr_b16 v[178:179], v144 offset:21568
    s_waitcnt lgkmcnt(6)
    v_mfma_f32_16x16x32_bf16 v[136:139], v[160:163], v[104:107], v[136:139]
    ds_read_b64_tr_b16 v[180:181], v145 offset:18496
    ds_read_b64_tr_b16 v[182:183], v145 offset:21568
    v_mfma_f32_16x16x32_bf16 v[140:143], v[164:167], v[104:107], v[140:143]
    ds_read_b64_tr_b16 v[184:185], v144 offset:18560
    ds_read_b64_tr_b16 v[186:187], v144 offset:21632
    s_waitcnt lgkmcnt(6)
    s_waitcnt vmcnt(7)
    v_mfma_f32_16x16x32_bf16 v[120:123], v[168:171], v[108:111], v[120:123]
    ds_read_b64_tr_b16 v[188:189], v145 offset:18560
    ds_read_b64_tr_b16 v[190:191], v145 offset:21632
    v_mfma_f32_16x16x32_bf16 v[124:127], v[172:175], v[108:111], v[124:127]
    ds_read_b64_tr_b16 v[160:161], v144 offset:24576
    ds_read_b64_tr_b16 v[162:163], v144 offset:27648
    s_waitcnt lgkmcnt(6)
    v_mfma_f32_16x16x32_bf16 v[128:131], v[176:179], v[108:111], v[128:131]
    ds_read_b64_tr_b16 v[164:165], v145 offset:24576
    ds_read_b64_tr_b16 v[166:167], v145 offset:27648
    v_mfma_f32_16x16x32_bf16 v[132:135], v[180:183], v[108:111], v[132:135]
    ds_read_b64_tr_b16 v[168:169], v144 offset:24640
    ds_read_b64_tr_b16 v[170:171], v144 offset:27712
    s_waitcnt lgkmcnt(6)
    v_mfma_f32_16x16x32_bf16 v[136:139], v[184:187], v[108:111], v[136:139]
    ds_read_b64_tr_b16 v[172:173], v145 offset:24640
    ds_read_b64_tr_b16 v[174:175], v145 offset:27712
    v_mfma_f32_16x16x32_bf16 v[140:143], v[188:191], v[108:111], v[140:143]
    ds_read_b64_tr_b16 v[176:177], v144 offset:24704
    ds_read_b64_tr_b16 v[178:179], v144 offset:27776
    s_waitcnt lgkmcnt(6)
    s_waitcnt vmcnt(6)
    v_mfma_f32_16x16x32_bf16 v[120:123], v[160:163], v[112:115], v[120:123]
    ds_read_b64_tr_b16 v[180:181], v145 offset:24704
    ds_read_b64_tr_b16 v[182:183], v145 offset:27776
    v_mfma_f32_16x16x32_bf16 v[124:127], v[164:167], v[112:115], v[124:127]
    ds_read_b64_tr_b16 v[184:185], v144 offset:30720
    ds_read_b64_tr_b16 v[186:187], v144 offset:33792
    s_waitcnt lgkmcnt(6)
    v_mfma_f32_16x16x32_bf16 v[128:131], v[168:171], v[112:115], v[128:131]
    ds_read_b64_tr_b16 v[188:189], v145 offset:30720
    ds_read_b64_tr_b16 v[190:191], v145 offset:33792
    v_mfma_f32_16x16x32_bf16 v[132:135], v[172:175], v[112:115], v[132:135]
    ds_read_b64_tr_b16 v[160:161], v144 offset:30784
    ds_read_b64_tr_b16 v[162:163], v144 offset:33856
    s_waitcnt lgkmcnt(6)
    v_mfma_f32_16x16x32_bf16 v[136:139], v[176:179], v[112:115], v[136:139]
    ds_read_b64_tr_b16 v[164:165], v145 offset:30784
    ds_read_b64_tr_b16 v[166:167], v145 offset:33856
    v_mfma_f32_16x16x32_bf16 v[140:143], v[180:183], v[112:115], v[140:143]
    ds_read_b64_tr_b16 v[168:169], v144 offset:30848
    ds_read_b64_tr_b16 v[170:171], v144 offset:33920
    s_waitcnt lgkmcnt(6)
    s_waitcnt vmcnt(5)
    v_mfma_f32_16x16x32_bf16 v[120:123], v[184:187], v[116:119], v[120:123]
    ds_read_b64_tr_b16 v[172:173], v145 offset:30848
    ds_read_b64_tr_b16 v[174:175], v145 offset:33920
    v_mfma_f32_16x16x32_bf16 v[124:127], v[188:191], v[116:119], v[124:127]
    s_waitcnt lgkmcnt(4)
    v_mfma_f32_16x16x32_bf16 v[128:131], v[160:163], v[116:119], v[128:131]
    v_mfma_f32_16x16x32_bf16 v[132:135], v[164:167], v[116:119], v[132:135]
    s_waitcnt lgkmcnt(0)
    v_mfma_f32_16x16x32_bf16 v[136:139], v[168:171], v[116:119], v[136:139]
    v_mfma_f32_16x16x32_bf16 v[140:143], v[172:175], v[116:119], v[140:143]
    s_waitcnt vmcnt(4)
    v_subrev_u32 v12, s90, v12
    v_cmp_lt_u32 vcc, 0, v12
    s_mov_b32 s91, 20000
    s_nop 0
    s_cbranch_vccz ck2
cr2:
    s_sleep 2
    buffer_load_dword v12, v13, s[68:71], s13 offen sc1
    s_sub_u32 s91, s91, 1
    s_waitcnt vmcnt(0)
    v_subrev_u32 v12, s90, v12
    v_cmp_lt_u32 vcc, 0, v12
    s_cbranch_scc1 ck2
    s_nop 0
    s_cbranch_vccnz cr2
ck2:
    s_and_b32 s47, s97, 0xfffff000
    s_add_u32 s47, s47, 4980736
    s_add_u32 s64, s44, s47
    s_addc_u32 s65, s45, 0
    s_mov_b32 s66, 4096
    s_mov_b32 s67, 0x20000
    s_lshl_b32 s47, s96, 10
    v_add_u32 v19, s47, v2
    s_add_u32 m0, s0, s47
    s_nop 0
    buffer_load_dwordx4 v19, s[64:67], 0 offen offset:0 sc1 lds
    buffer_load_dwordx4 v19, s[64:67], 0 offen offset:2048 sc1 lds
    ds_read_b64 v[192:193], v156 offset:0
    ds_read_b64 v[194:195], v156 offset:32
    ds_read_b64 v[196:197], v156 offset:1024
    ds_read_b64 v[198:199], v156 offset:1056
    ds_read_b64 v[200:201], v156 offset:2048
    ds_read_b64 v[202:203], v156 offset:2080
    s_add_u32 s56, s44, 2621440
    s_addc_u32 s57, s45, 0
    s_mov_b32 s58, 2359296
    s_mov_b32 s59, 0x20000
    s_add_u32 s60, s44, 9699328
    s_addc_u32 s61, s45, 0
    s_mov_b32 s62, 196608
    s_mov_b32 s63, 0x20000
    s_mul_i32 s6, s5, 73728
    s_add_u32 s6, s6, s10
    s_mul_i32 s7, s95, 12288
    s_add_u32 s6, s6, s7
    v_mov_b32 v160, 0
    v_mov_b32 v161, 0
    v_mov_b32 v162, 0
    v_mov_b32 v163, 0
    v_mov_b32 v10, 0x3f803f80
    s_lshl_b32 s92, s5, 2
    s_add_u32 s92, s92, s3
    s_lshl_b32 s92, s92, 7
    s_lshl_b32 s7, s95, 2
    s_add_u32 s92, s92, s7
    s_add_u32 s92, s92, 32
    s_waitcnt lgkmcnt(0)
    v_lshlrev_b32 v5, 16, v192
    v_and_b32 v6, 0xffff0000, v192
    v_lshlrev_b32 v7, 16, v193
    v_and_b32 v8, 0xffff0000, v193
    v_add_f32 v5, v5, v120
    v_add_f32 v6, v6, v121
    v_add_f32 v7, v7, v122
    v_add_f32 v8, v8, v123
    v_cvt_pk_bf16_f32 v48, v5, v6
    v_cvt_pk_bf16_f32 v49, v7, v8
    v_lshlrev_b32 v5, 16, v194
    v_and_b32 v6, 0xffff0000, v194
    v_lshlrev_b32 v7, 16, v195
    v_and_b32 v8, 0xffff0000, v195
    v_add_f32 v5, v5, v124
    v_add_f32 v6, v6, v125
    v_add_f32 v7, v7, v126
    v_add_f32 v8, v8, v127
    v_cvt_pk_bf16_f32 v50, v5, v6
    v_cvt_pk_bf16_f32 v51, v7, v8
    buffer_store_dwordx4 v[48:51], v2, s[56:59], s6 offen sc1
    s_add_u32 s6, s6, s11
    v_lshlrev_b32 v5, 16, v196
    v_and_b32 v6, 0xffff0000, v196
    v_lshlrev_b32 v7, 16, v197
    v_and_b32 v8, 0xffff0000, v197
    v_add_f32 v5, v5, v128
    v_add_f32 v6, v6, v129
    v_add_f32 v7, v7, v130
    v_add_f32 v8, v8, v131
    v_cvt_pk_bf16_f32 v52, v5, v6
    v_cvt_pk_bf16_f32 v53, v7, v8
    v_lshlrev_b32 v5, 16, v198
    v_and_b32 v6, 0xffff0000, v198
    v_lshlrev_b32 v7, 16, v199
    v_and_b32 v8, 0xffff0000, v199
    v_add_f32 v5, v5, v132
    v_add_f32 v6, v6, v133
    v_add_f32 v7, v7, v134
    v_add_f32 v8, v8, v135
    v_cvt_pk_bf16_f32 v54, v5, v6
    v_cvt_pk_bf16_f32 v55, v7, v8
    buffer_store_dwordx4 v[52:55], v2, s[56:59], s6 offen sc1
    s_add_u32 s6, s6, s11
    v_lshlrev_b32 v5, 16, v200
    v_and_b32 v6, 0xffff0000, v200
    v_lshlrev_b32 v7, 16, v201
    v_and_b32 v8, 0xffff0000, v201
    v_add_f32 v5, v5, v136
    v_add_f32 v6, v6, v137
    v_add_f32 v7, v7, v138
    v_add_f32 v8, v8, v139
    v_cvt_pk_bf16_f32 v56, v5, v6
    v_cvt_pk_bf16_f32 v57, v7, v8
    v_lshlrev_b32 v5, 16, v202
    v_and_b32 v6, 0xffff0000, v202
    v_lshlrev_b32 v7, 16, v203
    v_and_b32 v8, 0xffff0000, v203
    v_add_f32 v5, v5, v140
    v_add_f32 v6, v6, v141
    v_add_f32 v7, v7, v142
    v_add_f32 v8, v8, v143
    v_cvt_pk_bf16_f32 v58, v5, v6
    v_cvt_pk_bf16_f32 v59, v7, v8
    buffer_store_dwordx4 v[56:59], v2, s[56:59], s6 offen sc1
    v_dot2c_f32_bf16 v160, v10, v48
    v_dot2c_f32_bf16 v161, v48, v48
    v_dot2c_f32_bf16 v162, v192, v204
    v_dot2c_f32_bf16 v160, v10, v49
    v_dot2c_f32_bf16 v161, v49, v49
    v_dot2c_f32_bf16 v162, v193, v205
    v_dot2c_f32_bf16 v160, v10, v50
    v_dot2c_f32_bf16 v161, v50, v50
    v_dot2c_f32_bf16 v162, v194, v206
    v_dot2c_f32_bf16 v160, v10, v51
    v_dot2c_f32_bf16 v161, v51, v51
    v_dot2c_f32_bf16 v162, v195, v207
    v_dot2c_f32_bf16 v160, v10, v52
    v_dot2c_f32_bf16 v161, v52, v52
    v_dot2c_f32_bf16 v162, v196, v208
    v_dot2c_f32_bf16 v160, v10, v53
    v_dot2c_f32_bf16 v161, v53, v53
    v_dot2c_f32_bf16 v162, v197, v209
    v_dot2c_f32_bf16 v160, v10, v54
    v_dot2c_f32_bf16 v161, v54, v54
    v_dot2c_f32_bf16 v162, v198, v210
    v_dot2c_f32_bf16 v160, v10, v55
    v_dot2c_f32_bf16 v161, v55, v55
    v_dot2c_f32_bf16 v162, v199, v211
    v_dot2c_f32_bf16 v160, v10, v56
    v_dot2c_f32_bf16 v161, v56, v56
    v_dot2c_f32_bf16 v162, v200, v212
    v_dot2c_f32_bf16 v160, v10, v57
    v_dot2c_f32_bf16 v161, v57, v57
    v_dot2c_f32_bf16 v162, v201, v213
    v_dot2c_f32_bf16 v160, v10, v58
    v_dot2c_f32_bf16 v161, v58, v58
    v_dot2c_f32_bf16 v162, v202, v214
    v_dot2c_f32_bf16 v160, v10, v59
    v_dot2c_f32_bf16 v161, v59, v59
    v_dot2c_f32_bf16 v162, v203, v215
    v_lshlrev_b32 v3, 4, v3
    v_lshl_add_u32 v3, v4, 24, v3
    s_lshl_b32 s7, s95, 15
    v_mov_b32 v5, v160
    s_nop 1
    v_permlane32_swap_b32 v5, v160
    v_add_f32 v160, v160, v5
    v_mov_b32 v5, v160
    s_nop 1
    v_permlane16_swap_b32 v5, v160
    v_add_f32 v160, v160, v5
    v_mov_b32 v6, v161
    s_nop 1
    v_permlane32_swap_b32 v6, v161
    v_add_f32 v161, v161, v6
    v_mov_b32 v6, v161
    s_nop 1
    v_permlane16_swap_b32 v6, v161
    v_add_f32 v161, v161, v6
    v_mov_b32 v7, v162
    s_nop 1
    v_permlane32_swap_b32 v7, v162
    v_add_f32 v162, v162, v7
    v_mov_b32 v7, v162
    s_nop 1
    v_permlane16_swap_b32 v7, v162
    v_add_f32 v162, v162, v7
    buffer_store_dwordx4 v[160:163], v3, s[60:63], s7 offen sc1
    s_waitcnt vmcnt(4)
    s_branch k3_fj
k3_fb:
    s_mov_b32 s93, s4
    s_mov_b32 s94, s5
    s_and_b32 s92, s5, 28
    s_add_u32 s92, s92, s3
    s_lshl_b32 s4, s4, 5
    s_add_u32 s4, s4, s92
    s_mov_b32 s96, 0
    s_cmp_lt_u32 s92, 28
    s_cselect_b32 s97, s92, 64
    s_mul_i32 s14, s3, 24576
    s_add_u32 s14, s14, 40960
    s_cmp_lg_u32 s4, 27
    s_cbranch_scc1 kb_nn
    s_add_u32 s64, s44, 21168128
    s_addc_u32 s65, s45, 0
    s_mov_b32 s66, 163840
    s_mov_b32 s67, 0x20000
    s_mov_b32 s60, s42
    s_mov_b32 s61, s43
    s_mov_b32 s62, 256
    s_mov_b32 s63, 0x20000
    v_lshlrev_b32 v3, 20, v1
    s_movk_i32 s8, 28672
    buffer_load_dword v4, v3, s[64:67], s8 offen sc1
    s_waitcnt vmcnt(0)
    v_add_u32 v4, 32, v4
    v_or_b32 v4, 31, v4
    buffer_store_dword v4, v3, s[60:63], 0 offen sc1
    buffer_store_dword v4, v3, s[64:67], s8 offen sc1
kb_nn:
kb_pw:
    s_mov_b32 s56, s32
    s_mov_b32 s57, s33
    s_mov_b32 s58, 663552
    s_mov_b32 s59, 0x20000
    s_bfe_u32 s46, s94, 0x20002
    s_lshl_b32 s46, s46, 1
    s_and_b32 s47, s93, 1
    s_add_u32 s46, s46, s47
    s_lshl_b32 s46, s46, 2
    s_add_u32 s46, s46, s3
    s_mul_i32 s46, s46, 20736
    v_min_u32 v12, 53, v1
    v_mul_u32_u24 v13, 86, v12
    v_lshrrev_b32 v13, 8, v13
    v_mul_u32_u24 v13, 768, v13
    v_lshl_add_u32 v12, v12, 7, v13
    s_lshr_b32 s47, s93, 1
    s_cmp_eq_u32 s47, 0
    s_cselect_b32 s6, 0, 0x40000000
    s_cmp_eq_u32 s47, 3
    s_cselect_b32 s6, 0, s6
    v_add_u32 v13, s6, v12
    buffer_load_dword v148, v13, s[56:59], s46 offen offset:0
    s_cmp_eq_u32 s47, 1
    s_cselect_b32 s6, 0, 0x40000000
    s_cmp_eq_u32 s47, 3
    s_cselect_b32 s6, 0, s6
    v_add_u32 v13, s6, v12
    buffer_load_dword v149, v13, s[56:59], s46 offen offset:384
    s_cmp_eq_u32 s47, 2
    s_cselect_b32 s6, 0, 0x40000000
    s_cmp_eq_u32 s47, 3
    s_cselect_b32 s6, 0, s6
    v_add_u32 v13, s6, v12
    buffer_load_dword v150, v13, s[56:59], s46 offen offset:768
    s_mov_b32 s48, s18
    s_mov_b32 s49, s19
    s_mov_b32 s50, 2359296
    s_mov_b32 s51, 0x20000
    s_mov_b32 s52, s20
    s_mov_b32 s53, s21
    s_mov_b32 s54, 2359296
    s_mov_b32 s55, 0x20000
    s_mov_b32 s56, s22
    s_mov_b32 s57, s23
    s_mov_b32 s58, 4608
    s_mov_b32 s59, 0x20000
    s_add_u32 s60, s44, 4980736
    s_addc_u32 s61, s45, 0
    s_mov_b32 s62, 2359296
    s_mov_b32 s63, 0x20000
    s_mul_i32 s5, s4, 57
    s_lshr_b32 s5, s5, 9
    s_mul_i32 s6, s5, 9
    s_sub_u32 s6, s4, s6
    v_lshrrev_b32 v2, 3, v1
    v_lshlrev_b32 v2, 3, v2
    s_lshl_b32 s7, s5, 6
    v_add_u32 v2, s7, v2
    v_and_b32 v3, 7, v1
    s_lshl_b32 s7, s6, 3
    v_add_u32 v3, s7, v3
    v_mul_u32_u24 v4, 1152, v2
    v_lshl_add_u32 v4, v3, 4, v4
    v_subrev_u32 v5, 3456, v4
    v_add_u32 v6, 4608, v4
    v_lshlrev_b32 v7, 6, v3
    buffer_load_dwordx4 v[92:95], v7, s[56:59], 0 offen offset:0
    buffer_load_dwordx4 v[96:99], v7, s[56:59], 0 offen offset:16
    buffer_load_dwordx4 v[100:103], v7, s[56:59], 0 offen offset:32
    buffer_load_dwordx4 v[104:107], v7, s[56:59], 0 offen offset:48
    buffer_load_dwordx4 v[28:31], v4, s[48:51], 0 offen offset:0 nt
    buffer_load_dwordx4 v[32:35], v4, s[48:51], 0 offen offset:1152 nt
    buffer_load_dwordx4 v[36:39], v4, s[48:51], 0 offen offset:2304 nt
    buffer_load_dwordx4 v[40:43], v4, s[48:51], 0 offen offset:3456 nt
    buffer_load_dwordx4 v[44:47], v6, s[48:51], 0 offen offset:0 nt
    buffer_load_dwordx4 v[48:51], v6, s[48:51], 0 offen offset:1152 nt
    buffer_load_dwordx4 v[52:55], v6, s[48:51], 0 offen offset:2304 nt
    buffer_load_dwordx4 v[56:59], v6, s[48:51], 0 offen offset:3456 nt
    buffer_load_dwordx4 v[16:19], v5, s[48:51], 0 offen offset:0 nt
    buffer_load_dwordx4 v[20:23], v5, s[48:51], 0 offen offset:1152 nt
    buffer_load_dwordx4 v[24:27], v5, s[48:51], 0 offen offset:2304 nt
    buffer_load_dwordx4 v[60:63], v4, s[52:55], 0 offen offset:0 nt
    buffer_load_dwordx4 v[64:67], v4, s[52:55], 0 offen offset:1152 nt
    buffer_load_dwordx4 v[68:71], v4, s[52:55], 0 offen offset:2304 nt
    buffer_load_dwordx4 v[72:75], v4, s[52:55], 0 offen offset:3456 nt
    buffer_load_dwordx4 v[76:79], v6, s[52:55], 0 offen offset:0 nt
    buffer_load_dwordx4 v[80:83], v6, s[52:55], 0 offen offset:1152 nt
    buffer_load_dwordx4 v[84:87], v6, s[52:55], 0 offen offset:2304 nt
    buffer_load_dwordx4 v[88:91], v6, s[52:55], 0 offen offset:3456 nt
    s_cmp_ge_u32 s92, 28
    s_cbranch_scc1 kb_w0
    s_mov_b32 s64, s34
    s_mov_b32 s65, s35
    s_mov_b32 s66, 5308416
    s_mov_b32 s67, 0x20000
    v_lshrrev_b32 v129, 3, v1
    v_and_b32 v130, 6, v129
    v_and_b32 v131, 7, v1
    v_xor_b32 v130, v130, v131
    v_lshlrev_b32 v130, 4, v130
    v_mul_u32_u24 v129, 9216, v129
    v_add_u32 v128, v129, v130
    s_add_u32 s13, s97, 0
    s_mul_i32 s15, s13, 43
    s_lshr_b32 s15, s15, 8
    s_mul_i32 s46, s15, 6
    s_sub_u32 s46, s13, s46
    s_mul_i32 s47, s93, 9
    s_add_u32 s47, s47, s15
    s_lshl_b32 s47, s47, 7
    s_mul_i32 s46, s46, 884736
    s_add_u32 s47, s47, s46
    s_cmp_lt_u32 s13, 54
    s_cselect_b32 s47, s47, 0x40000000
    v_add_u32 v129, s47, v128
    s_add_u32 m0, s14, 0
    s_mov_b32 s47, 0
    buffer_load_dwordx4 v129, s[64:67], s47 offen nt lds
    s_add_u32 m0, m0, 0x400
    s_add_u32 s47, s47, 73728
    buffer_load_dwordx4 v129, s[64:67], s47 offen nt lds
    s_add_u32 m0, m0, 0x400
    s_add_u32 s47, s47, 73728
    buffer_load_dwordx4 v129, s[64:67], s47 offen nt lds
    s_add_u32 m0, m0, 0x400
    s_add_u32 s47, s47, 73728
    buffer_load_dwordx4 v129, s[64:67], s47 offen nt lds
    s_add_u32 m0, m0, 0x400
    s_add_u32 s47, s47, 73728
    buffer_load_dwordx4 v129, s[64:67], s47 offen nt lds
    s_add_u32 m0, m0, 0x400
    s_add_u32 s47, s47, 73728
    buffer_load_dwordx4 v129, s[64:67], s47 offen nt lds
    s_add_u32 m0, m0, 0x400
    s_add_u32 s47, s47, 73728
    buffer_load_dwordx4 v129, s[64:67], s47 offen nt lds
    s_add_u32 m0, m0, 0x400
    s_add_u32 s47, s47, 73728
    buffer_load_dwordx4 v129, s[64:67], s47 offen nt lds
    s_add_u32 m0, m0, 0x400
    s_add_u32 s47, s47, 73728
    buffer_load_dwordx4 v129, s[64:67], s47 offen nt lds
    s_add_u32 m0, m0, 0x400
    s_add_u32 s47, s47, 73728
    buffer_load_dwordx4 v129, s[64:67], s47 offen nt lds
    s_add_u32 m0, m0, 0x400
    s_add_u32 s47, s47, 73728
    buffer_load_dwordx4 v129, s[64:67], s47 offen nt lds
    s_add_u32 m0, m0, 0x400
    s_add_u32 s47, s47, 73728
    buffer_load_dwordx4 v129, s[64:67], s47 offen nt lds
    s_add_u32 s13, s97, 28
    s_mul_i32 s15, s13, 43
    s_lshr_b32 s15, s15, 8
    s_mul_i32 s46, s15, 6
    s_sub_u32 s46, s13, s46
    s_mul_i32 s47, s93, 9
    s_add_u32 s47, s47, s15
    s_lshl_b32 s47, s47, 7
    s_mul_i32 s46, s46, 884736
    s_add_u32 s47, s47, s46
    s_cmp_lt_u32 s13, 54
    s_cselect_b32 s47, s47, 0x40000000
    v_add_u32 v129, s47, v128
    s_add_u32 m0, s14, 12288
    s_mov_b32 s47, 0
    buffer_load_dwordx4 v129, s[64:67], s47 offen nt lds
    s_add_u32 m0, m0, 0x400
    s_add_u32 s47, s47, 73728
    buffer_load_dwordx4 v129, s[64:67], s47 offen nt lds
    s_add_u32 m0, m0, 0x400
    s_add_u32 s47, s47, 73728
    buffer_load_dwordx4 v129, s[64:67], s47 offen nt lds
    s_add_u32 m0, m0, 0x400
    s_add_u32 s47, s47, 73728
    buffer_load_dwordx4 v129, s[64:67], s47 offen nt lds
    s_add_u32 m0, m0, 0x400
    s_add_u32 s47, s47, 73728
    buffer_load_dwordx4 v129, s[64:67], s47 offen nt lds
    s_add_u32 m0, m0, 0x400
    s_add_u32 s47, s47, 73728
    buffer_load_dwordx4 v129, s[64:67], s47 offen nt lds
    s_add_u32 m0, m0, 0x400
    s_add_u32 s47, s47, 73728
    buffer_load_dwordx4 v129, s[64:67], s47 offen nt lds
    s_add_u32 m0, m0, 0x400
    s_add_u32 s47, s47, 73728
    buffer_load_dwordx4 v129, s[64:67], s47 offen nt lds
    s_add_u32 m0, m0, 0x400
    s_add_u32 s47, s47, 73728
    buffer_load_dwordx4 v129, s[64:67], s47 offen nt lds
    s_add_u32 m0, m0, 0x400
    s_add_u32 s47, s47, 73728
    buffer_load_dwordx4 v129, s[64:67], s47 offen nt lds
    s_add_u32 m0, m0, 0x400
    s_add_u32 s47, s47, 73728
    buffer_load_dwordx4 v129, s[64:67], s47 offen nt lds
    s_add_u32 m0, m0, 0x400
    s_add_u32 s47, s47, 73728
    buffer_load_dwordx4 v129, s[64:67], s47 offen nt lds
    s_branch kb_w1
kb_w0:
    s_lshl_b32 s98, s93, 2
    s_add_u32 s98, s98, s3
    s_add_u32 s98, s98, 256
    s_mul_i32 s5, s98, 57
    s_lshr_b32 s5, s5, 9
    s_mul_i32 s6, s5, 9
    s_sub_u32 s6, s98, s6
    v_lshrrev_b32 v2, 3, v1
    v_lshlrev_b32 v2, 3, v2
    s_lshl_b32 s7, s5, 6
    v_add_u32 v2, s7, v2
    v_and_b32 v3, 7, v1
    s_lshl_b32 s7, s6, 3
    v_add_u32 v3, s7, v3
    v_mul_u32_u24 v4, 1152, v2
    v_lshl_add_u32 v4, v3, 4, v4
    v_subrev_u32 v5, 3456, v4
    v_add_u32 v6, 4608, v4
    v_lshlrev_b32 v7, 6, v3
    buffer_load_dwordx4 v[228:231], v7, s[56:59], 0 offen offset:0
    buffer_load_dwordx4 v[232:235], v7, s[56:59], 0 offen offset:16
    buffer_load_dwordx4 v[236:239], v7, s[56:59], 0 offen offset:32
    buffer_load_dwordx4 v[240:243], v7, s[56:59], 0 offen offset:48
    buffer_load_dwordx4 v[164:167], v4, s[48:51], 0 offen offset:0 nt
    buffer_load_dwordx4 v[168:171], v4, s[48:51], 0 offen offset:1152 nt
    buffer_load_dwordx4 v[172:175], v4, s[48:51], 0 offen offset:2304 nt
    buffer_load_dwordx4 v[176:179], v4, s[48:51], 0 offen offset:3456 nt
    buffer_load_dwordx4 v[180:183], v6, s[48:51], 0 offen offset:0 nt
    buffer_load_dwordx4 v[184:187], v6, s[48:51], 0 offen offset:1152 nt
    buffer_load_dwordx4 v[188:191], v6, s[48:51], 0 offen offset:2304 nt
    buffer_load_dwordx4 v[192:195], v6, s[48:51], 0 offen offset:3456 nt
    buffer_load_dwordx4 v[152:155], v5, s[48:51], 0 offen offset:0 nt
    buffer_load_dwordx4 v[156:159], v5, s[48:51], 0 offen offset:1152 nt
    buffer_load_dwordx4 v[160:163], v5, s[48:51], 0 offen offset:2304 nt
    buffer_load_dwordx4 v[196:199], v4, s[52:55], 0 offen offset:0 nt
    buffer_load_dwordx4 v[200:203], v4, s[52:55], 0 offen offset:1152 nt
    buffer_load_dwordx4 v[204:207], v4, s[52:55], 0 offen offset:2304 nt
    buffer_load_dwordx4 v[208:211], v4, s[52:55], 0 offen offset:3456 nt
    buffer_load_dwordx4 v[212:215], v6, s[52:55], 0 offen offset:0 nt
    buffer_load_dwordx4 v[216:219], v6, s[52:55], 0 offen offset:1152 nt
    buffer_load_dwordx4 v[220:223], v6, s[52:55], 0 offen offset:2304 nt
    buffer_load_dwordx4 v[224:227], v6, s[52:55], 0 offen offset:3456 nt
kb_w1:
    s_waitcnt vmcnt(23)
kb_ut:
    s_mul_i32 s5, s4, 57
    s_lshr_b32 s5, s5, 9
    s_mul_i32 s6, s5, 9
    s_sub_u32 s6, s4, s6
    v_lshrrev_b32 v2, 3, v1
    v_and_b32 v3, 7, v1
    s_lshl_b32 s7, s3, 10
    s_add_u32 s7, s7, 139264
    v_sub_u32 v9, 7, v2
    v_xor_b32 v9, v9, v3
    v_lshlrev_b32 v9, 4, v9
    v_lshl_add_u32 v9, v3, 7, v9
    v_add_u32 v9, s7, v9
    v_xor_b32 v10, v2, v3
    v_lshlrev_b32 v10, 4, v10
    v_lshl_add_u32 v10, v2, 7, v10
    v_add_u32 v10, s7, v10
    v_lshlrev_b32 v8, 15, v2
    v_lshl_add_u32 v8, v3, 4, v8
    s_lshl_b32 s8, s6, 18
    s_lshl_b32 s7, s5, 7
    s_sub_u32 s8, s8, s7
    s_add_u32 s8, s8, 3968
    v_lshlrev_b32 v2, 16, v92
    v_and_b32 v3, 0xffff0000, v92
    v_lshlrev_b32 v4, 16, v93
    v_and_b32 v5, 0xffff0000, v93
    v_lshlrev_b32 v108, 16, v16
    v_lshlrev_b32 v109, 16, v20
    v_lshlrev_b32 v110, 16, v24
    v_lshlrev_b32 v111, 16, v28
    v_lshlrev_b32 v112, 16, v32
    v_lshlrev_b32 v113, 16, v36
    v_lshlrev_b32 v114, 16, v40
    v_lshlrev_b32 v115, 16, v44
    v_lshlrev_b32 v116, 16, v48
    v_lshlrev_b32 v117, 16, v52
    v_lshlrev_b32 v118, 16, v56
    v_mul_f32 v119, v111, v2
    v_mul_f32 v120, v112, v2
    v_mul_f32 v121, v113, v2
    v_mul_f32 v122, v114, v2
    v_mul_f32 v123, v115, v2
    v_mul_f32 v124, v116, v2
    v_mul_f32 v125, v117, v2
    v_mul_f32 v126, v118, v2
    v_fmac_f32 v119, v110, v3
    v_fmac_f32 v120, v111, v3
    v_fmac_f32 v121, v112, v3
    v_fmac_f32 v122, v113, v3
    v_fmac_f32 v123, v114, v3
    v_fmac_f32 v124, v115, v3
    v_fmac_f32 v125, v116, v3
    v_fmac_f32 v126, v117, v3
    v_fmac_f32 v119, v109, v4
    v_fmac_f32 v120, v110, v4
    v_fmac_f32 v121, v111, v4
    v_fmac_f32 v122, v112, v4
    v_fmac_f32 v123, v113, v4
    v_fmac_f32 v124, v114, v4
    v_fmac_f32 v125, v115, v4
    v_fmac_f32 v126, v116, v4
    v_fmac_f32 v119, v108, v5
    v_fmac_f32 v120, v109, v5
    v_fmac_f32 v121, v110, v5
    v_fmac_f32 v122, v111, v5
    v_fmac_f32 v123, v112, v5
    v_fmac_f32 v124, v113, v5
    v_fmac_f32 v125, v114, v5
    v_fmac_f32 v126, v115, v5
    v_lshlrev_b32 v108, 16, v60
    v_lshlrev_b32 v109, 16, v64
    v_lshlrev_b32 v110, 16, v68
    v_lshlrev_b32 v111, 16, v72
    v_lshlrev_b32 v112, 16, v76
    v_lshlrev_b32 v113, 16, v80
    v_lshlrev_b32 v114, 16, v84
    v_lshlrev_b32 v115, 16, v88
    v_mul_f32 v119, v119, v108
    v_mul_f32 v120, v120, v109
    v_mul_f32 v121, v121, v110
    v_mul_f32 v122, v122, v111
    v_mul_f32 v123, v123, v112
    v_mul_f32 v124, v124, v113
    v_mul_f32 v125, v125, v114
    v_mul_f32 v126, v126, v115
    v_cvt_pk_bf16_f32 v108, v126, v125
    v_cvt_pk_bf16_f32 v109, v124, v123
    v_cvt_pk_bf16_f32 v110, v122, v121
    v_cvt_pk_bf16_f32 v111, v120, v119
    ds_write_b128 v9, v[108:111]
    ds_read_b128 v[12:15], v10
    v_lshlrev_b32 v2, 16, v94
    v_and_b32 v3, 0xffff0000, v94
    v_lshlrev_b32 v4, 16, v95
    v_and_b32 v5, 0xffff0000, v95
    v_and_b32 v108, 0xffff0000, v16
    v_and_b32 v109, 0xffff0000, v20
    v_and_b32 v110, 0xffff0000, v24
    v_and_b32 v111, 0xffff0000, v28
    v_and_b32 v112, 0xffff0000, v32
    v_and_b32 v113, 0xffff0000, v36
    v_and_b32 v114, 0xffff0000, v40
    v_and_b32 v115, 0xffff0000, v44
    v_and_b32 v116, 0xffff0000, v48
    v_and_b32 v117, 0xffff0000, v52
    v_and_b32 v118, 0xffff0000, v56
    v_mul_f32 v119, v111, v2
    v_mul_f32 v120, v112, v2
    v_mul_f32 v121, v113, v2
    v_mul_f32 v122, v114, v2
    v_mul_f32 v123, v115, v2
    v_mul_f32 v124, v116, v2
    v_mul_f32 v125, v117, v2
    v_mul_f32 v126, v118, v2
    v_fmac_f32 v119, v110, v3
    v_fmac_f32 v120, v111, v3
    v_fmac_f32 v121, v112, v3
    v_fmac_f32 v122, v113, v3
    v_fmac_f32 v123, v114, v3
    v_fmac_f32 v124, v115, v3
    v_fmac_f32 v125, v116, v3
    v_fmac_f32 v126, v117, v3
    v_fmac_f32 v119, v109, v4
    v_fmac_f32 v120, v110, v4
    v_fmac_f32 v121, v111, v4
    v_fmac_f32 v122, v112, v4
    v_fmac_f32 v123, v113, v4
    v_fmac_f32 v124, v114, v4
    v_fmac_f32 v125, v115, v4
    v_fmac_f32 v126, v116, v4
    v_fmac_f32 v119, v108, v5
    v_fmac_f32 v120, v109, v5
    v_fmac_f32 v121, v110, v5
    v_fmac_f32 v122, v111, v5
    v_fmac_f32 v123, v112, v5
    v_fmac_f32 v124, v113, v5
    v_fmac_f32 v125, v114, v5
    v_fmac_f32 v126, v115, v5
    v_and_b32 v108, 0xffff0000, v60
    v_and_b32 v109, 0xffff0000, v64
    v_and_b32 v110, 0xffff0000, v68
    v_and_b32 v111, 0xffff0000, v72
    v_and_b32 v112, 0xffff0000, v76
    v_and_b32 v113, 0xffff0000, v80
    v_and_b32 v114, 0xffff0000, v84
    v_and_b32 v115, 0xffff0000, v88
    v_mul_f32 v119, v119, v108
    v_mul_f32 v120, v120, v109
    v_mul_f32 v121, v121, v110
    v_mul_f32 v122, v122, v111
    v_mul_f32 v123, v123, v112
    v_mul_f32 v124, v124, v113
    v_mul_f32 v125, v125, v114
    v_mul_f32 v126, v126, v115
    v_cvt_pk_bf16_f32 v108, v126, v125
    v_cvt_pk_bf16_f32 v109, v124, v123
    v_cvt_pk_bf16_f32 v110, v122, v121
    v_cvt_pk_bf16_f32 v111, v120, v119
    s_waitcnt lgkmcnt(0)
    buffer_store_dwordx4 v[12:15], v8, s[60:63], s8 offen sc1
    s_add_u32 s8, s8, 0x1000
    ds_write_b128 v9, v[108:111]
    ds_read_b128 v[12:15], v10
    v_lshlrev_b32 v2, 16, v96
    v_and_b32 v3, 0xffff0000, v96
    v_lshlrev_b32 v4, 16, v97
    v_and_b32 v5, 0xffff0000, v97
    v_lshlrev_b32 v108, 16, v17
    v_lshlrev_b32 v109, 16, v21
    v_lshlrev_b32 v110, 16, v25
    v_lshlrev_b32 v111, 16, v29
    v_lshlrev_b32 v112, 16, v33
    v_lshlrev_b32 v113, 16, v37
    v_lshlrev_b32 v114, 16, v41
    v_lshlrev_b32 v115, 16, v45
    v_lshlrev_b32 v116, 16, v49
    v_lshlrev_b32 v117, 16, v53
    v_lshlrev_b32 v118, 16, v57
    v_mul_f32 v119, v111, v2
    v_mul_f32 v120, v112, v2
    v_mul_f32 v121, v113, v2
    v_mul_f32 v122, v114, v2
    v_mul_f32 v123, v115, v2
    v_mul_f32 v124, v116, v2
    v_mul_f32 v125, v117, v2
    v_mul_f32 v126, v118, v2
    v_fmac_f32 v119, v110, v3
    v_fmac_f32 v120, v111, v3
    v_fmac_f32 v121, v112, v3
    v_fmac_f32 v122, v113, v3
    v_fmac_f32 v123, v114, v3
    v_fmac_f32 v124, v115, v3
    v_fmac_f32 v125, v116, v3
    v_fmac_f32 v126, v117, v3
    v_fmac_f32 v119, v109, v4
    v_fmac_f32 v120, v110, v4
    v_fmac_f32 v121, v111, v4
    v_fmac_f32 v122, v112, v4
    v_fmac_f32 v123, v113, v4
    v_fmac_f32 v124, v114, v4
    v_fmac_f32 v125, v115, v4
    v_fmac_f32 v126, v116, v4
    v_fmac_f32 v119, v108, v5
    v_fmac_f32 v120, v109, v5
    v_fmac_f32 v121, v110, v5
    v_fmac_f32 v122, v111, v5
    v_fmac_f32 v123, v112, v5
    v_fmac_f32 v124, v113, v5
    v_fmac_f32 v125, v114, v5
    v_fmac_f32 v126, v115, v5
    v_lshlrev_b32 v108, 16, v61
    v_lshlrev_b32 v109, 16, v65
    v_lshlrev_b32 v110, 16, v69
    v_lshlrev_b32 v111, 16, v73
    v_lshlrev_b32 v112, 16, v77
    v_lshlrev_b32 v113, 16, v81
    v_lshlrev_b32 v114, 16, v85
    v_lshlrev_b32 v115, 16, v89
    v_mul_f32 v119, v119, v108
    v_mul_f32 v120, v120, v109
    v_mul_f32 v121, v121, v110
    v_mul_f32 v122, v122, v111
    v_mul_f32 v123, v123, v112
    v_mul_f32 v124, v124, v113
    v_mul_f32 v125, v125, v114
    v_mul_f32 v126, v126, v115
    v_cvt_pk_bf16_f32 v108, v126, v125
    v_cvt_pk_bf16_f32 v109, v124, v123
    v_cvt_pk_bf16_f32 v110, v122, v121
    v_cvt_pk_bf16_f32 v111, v120, v119
    s_waitcnt lgkmcnt(0)
    buffer_store_dwordx4 v[12:15], v8, s[60:63], s8 offen sc1
    s_add_u32 s8, s8, 0x1000
    ds_write_b128 v9, v[108:111]
    ds_read_b128 v[12:15], v10
    v_lshlrev_b32 v2, 16, v98
    v_and_b32 v3, 0xffff0000, v98
    v_lshlrev_b32 v4, 16, v99
    v_and_b32 v5, 0xffff0000, v99
    v_and_b32 v108, 0xffff0000, v17
    v_and_b32 v109, 0xffff0000, v21
    v_and_b32 v110, 0xffff0000, v25
    v_and_b32 v111, 0xffff0000, v29
    v_and_b32 v112, 0xffff0000, v33
    v_and_b32 v113, 0xffff0000, v37
    v_and_b32 v114, 0xffff0000, v41
    v_and_b32 v115, 0xffff0000, v45
    v_and_b32 v116, 0xffff0000, v49
    v_and_b32 v117, 0xffff0000, v53
    v_and_b32 v118, 0xffff0000, v57
    v_mul_f32 v119, v111, v2
    v_mul_f32 v120, v112, v2
    v_mul_f32 v121, v113, v2
    v_mul_f32 v122, v114, v2
    v_mul_f32 v123, v115, v2
    v_mul_f32 v124, v116, v2
    v_mul_f32 v125, v117, v2
    v_mul_f32 v126, v118, v2
    v_fmac_f32 v119, v110, v3
    v_fmac_f32 v120, v111, v3
    v_fmac_f32 v121, v112, v3
    v_fmac_f32 v122, v113, v3
    v_fmac_f32 v123, v114, v3
    v_fmac_f32 v124, v115, v3
    v_fmac_f32 v125, v116, v3
    v_fmac_f32 v126, v117, v3
    v_fmac_f32 v119, v109, v4
    v_fmac_f32 v120, v110, v4
    v_fmac_f32 v121, v111, v4
    v_fmac_f32 v122, v112, v4
    v_fmac_f32 v123, v113, v4
    v_fmac_f32 v124, v114, v4
    v_fmac_f32 v125, v115, v4
    v_fmac_f32 v126, v116, v4
    v_fmac_f32 v119, v108, v5
    v_fmac_f32 v120, v109, v5
    v_fmac_f32 v121, v110, v5
    v_fmac_f32 v122, v111, v5
    v_fmac_f32 v123, v112, v5
    v_fmac_f32 v124, v113, v5
    v_fmac_f32 v125, v114, v5
    v_fmac_f32 v126, v115, v5
    v_and_b32 v108, 0xffff0000, v61
    v_and_b32 v109, 0xffff0000, v65
    v_and_b32 v110, 0xffff0000, v69
    v_and_b32 v111, 0xffff0000, v73
    v_and_b32 v112, 0xffff0000, v77
    v_and_b32 v113, 0xffff0000, v81
    v_and_b32 v114, 0xffff0000, v85
    v_and_b32 v115, 0xffff0000, v89
    v_mul_f32 v119, v119, v108
    v_mul_f32 v120, v120, v109
    v_mul_f32 v121, v121, v110
    v_mul_f32 v122, v122, v111
    v_mul_f32 v123, v123, v112
    v_mul_f32 v124, v124, v113
    v_mul_f32 v125, v125, v114
    v_mul_f32 v126, v126, v115
    v_cvt_pk_bf16_f32 v108, v126, v125
    v_cvt_pk_bf16_f32 v109, v124, v123
    v_cvt_pk_bf16_f32 v110, v122, v121
    v_cvt_pk_bf16_f32 v111, v120, v119
    s_waitcnt lgkmcnt(0)
    buffer_store_dwordx4 v[12:15], v8, s[60:63], s8 offen sc1
    s_add_u32 s8, s8, 0x1000
    ds_write_b128 v9, v[108:111]
    ds_read_b128 v[12:15], v10
    v_lshlrev_b32 v2, 16, v100
    v_and_b32 v3, 0xffff0000, v100
    v_lshlrev_b32 v4, 16, v101
    v_and_b32 v5, 0xffff0000, v101
    v_lshlrev_b32 v108, 16, v18
    v_lshlrev_b32 v109, 16, v22
    v_lshlrev_b32 v110, 16, v26
    v_lshlrev_b32 v111, 16, v30
    v_lshlrev_b32 v112, 16, v34
    v_lshlrev_b32 v113, 16, v38
    v_lshlrev_b32 v114, 16, v42
    v_lshlrev_b32 v115, 16, v46
    v_lshlrev_b32 v116, 16, v50
    v_lshlrev_b32 v117, 16, v54
    v_lshlrev_b32 v118, 16, v58
    v_mul_f32 v119, v111, v2
    v_mul_f32 v120, v112, v2
    v_mul_f32 v121, v113, v2
    v_mul_f32 v122, v114, v2
    v_mul_f32 v123, v115, v2
    v_mul_f32 v124, v116, v2
    v_mul_f32 v125, v117, v2
    v_mul_f32 v126, v118, v2
    v_fmac_f32 v119, v110, v3
    v_fmac_f32 v120, v111, v3
    v_fmac_f32 v121, v112, v3
    v_fmac_f32 v122, v113, v3
    v_fmac_f32 v123, v114, v3
    v_fmac_f32 v124, v115, v3
    v_fmac_f32 v125, v116, v3
    v_fmac_f32 v126, v117, v3
    v_fmac_f32 v119, v109, v4
    v_fmac_f32 v120, v110, v4
    v_fmac_f32 v121, v111, v4
    v_fmac_f32 v122, v112, v4
    v_fmac_f32 v123, v113, v4
    v_fmac_f32 v124, v114, v4
    v_fmac_f32 v125, v115, v4
    v_fmac_f32 v126, v116, v4
    v_fmac_f32 v119, v108, v5
    v_fmac_f32 v120, v109, v5
    v_fmac_f32 v121, v110, v5
    v_fmac_f32 v122, v111, v5
    v_fmac_f32 v123, v112, v5
    v_fmac_f32 v124, v113, v5
    v_fmac_f32 v125, v114, v5
    v_fmac_f32 v126, v115, v5
    v_lshlrev_b32 v108, 16, v62
    v_lshlrev_b32 v109, 16, v66
    v_lshlrev_b32 v110, 16, v70
    v_lshlrev_b32 v111, 16, v74
    v_lshlrev_b32 v112, 16, v78
    v_lshlrev_b32 v113, 16, v82
    v_lshlrev_b32 v114, 16, v86
    v_lshlrev_b32 v115, 16, v90
    v_mul_f32 v119, v119, v108
    v_mul_f32 v120, v120, v109
    v_mul_f32 v121, v121, v110
    v_mul_f32 v122, v122, v111
    v_mul_f32 v123, v123, v112
    v_mul_f32 v124, v124, v113
    v_mul_f32 v125, v125, v114
    v_mul_f32 v126, v126, v115
    v_cvt_pk_bf16_f32 v108, v126, v125
    v_cvt_pk_bf16_f32 v109, v124, v123
    v_cvt_pk_bf16_f32 v110, v122, v121
    v_cvt_pk_bf16_f32 v111, v120, v119
    s_waitcnt lgkmcnt(0)
    buffer_store_dwordx4 v[12:15], v8, s[60:63], s8 offen sc1
    s_add_u32 s8, s8, 0x1000
    ds_write_b128 v9, v[108:111]
    ds_read_b128 v[12:15], v10
    v_lshlrev_b32 v2, 16, v102
    v_and_b32 v3, 0xffff0000, v102
    v_lshlrev_b32 v4, 16, v103
    v_and_b32 v5, 0xffff0000, v103
    v_and_b32 v108, 0xffff0000, v18
    v_and_b32 v109, 0xffff0000, v22
    v_and_b32 v110, 0xffff0000, v26
    v_and_b32 v111, 0xffff0000, v30
    v_and_b32 v112, 0xffff0000, v34
    v_and_b32 v113, 0xffff0000, v38
    v_and_b32 v114, 0xffff0000, v42
    v_and_b32 v115, 0xffff0000, v46
    v_and_b32 v116, 0xffff0000, v50
    v_and_b32 v117, 0xffff0000, v54
    v_and_b32 v118, 0xffff0000, v58
    v_mul_f32 v119, v111, v2
    v_mul_f32 v120, v112, v2
    v_mul_f32 v121, v113, v2
    v_mul_f32 v122, v114, v2
    v_mul_f32 v123, v115, v2
    v_mul_f32 v124, v116, v2
    v_mul_f32 v125, v117, v2
    v_mul_f32 v126, v118, v2
    v_fmac_f32 v119, v110, v3
    v_fmac_f32 v120, v111, v3
    v_fmac_f32 v121, v112, v3
    v_fmac_f32 v122, v113, v3
    v_fmac_f32 v123, v114, v3
    v_fmac_f32 v124, v115, v3
    v_fmac_f32 v125, v116, v3
    v_fmac_f32 v126, v117, v3
    v_fmac_f32 v119, v109, v4
    v_fmac_f32 v120, v110, v4
    v_fmac_f32 v121, v111, v4
    v_fmac_f32 v122, v112, v4
    v_fmac_f32 v123, v113, v4
    v_fmac_f32 v124, v114, v4
    v_fmac_f32 v125, v115, v4
    v_fmac_f32 v126, v116, v4
    v_fmac_f32 v119, v108, v5
    v_fmac_f32 v120, v109, v5
    v_fmac_f32 v121, v110, v5
    v_fmac_f32 v122, v111, v5
    v_fmac_f32 v123, v112, v5
    v_fmac_f32 v124, v113, v5
    v_fmac_f32 v125, v114, v5
    v_fmac_f32 v126, v115, v5
    v_and_b32 v108, 0xffff0000, v62
    v_and_b32 v109, 0xffff0000, v66
    v_and_b32 v110, 0xffff0000, v70
    v_and_b32 v111, 0xffff0000, v74
    v_and_b32 v112, 0xffff0000, v78
    v_and_b32 v113, 0xffff0000, v82
    v_and_b32 v114, 0xffff0000, v86
    v_and_b32 v115, 0xffff0000, v90
    v_mul_f32 v119, v119, v108
    v_mul_f32 v120, v120, v109
    v_mul_f32 v121, v121, v110
    v_mul_f32 v122, v122, v111
    v_mul_f32 v123, v123, v112
    v_mul_f32 v124, v124, v113
    v_mul_f32 v125, v125, v114
    v_mul_f32 v126, v126, v115
    v_cvt_pk_bf16_f32 v108, v126, v125
    v_cvt_pk_bf16_f32 v109, v124, v123
    v_cvt_pk_bf16_f32 v110, v122, v121
    v_cvt_pk_bf16_f32 v111, v120, v119
    s_waitcnt lgkmcnt(0)
    buffer_store_dwordx4 v[12:15], v8, s[60:63], s8 offen sc1
    s_add_u32 s8, s8, 0x1000
    ds_write_b128 v9, v[108:111]
    ds_read_b128 v[12:15], v10
    v_lshlrev_b32 v2, 16, v104
    v_and_b32 v3, 0xffff0000, v104
    v_lshlrev_b32 v4, 16, v105
    v_and_b32 v5, 0xffff0000, v105
    v_lshlrev_b32 v108, 16, v19
    v_lshlrev_b32 v109, 16, v23
    v_lshlrev_b32 v110, 16, v27
    v_lshlrev_b32 v111, 16, v31
    v_lshlrev_b32 v112, 16, v35
    v_lshlrev_b32 v113, 16, v39
    v_lshlrev_b32 v114, 16, v43
    v_lshlrev_b32 v115, 16, v47
    v_lshlrev_b32 v116, 16, v51
    v_lshlrev_b32 v117, 16, v55
    v_lshlrev_b32 v118, 16, v59
    v_mul_f32 v119, v111, v2
    v_mul_f32 v120, v112, v2
    v_mul_f32 v121, v113, v2
    v_mul_f32 v122, v114, v2
    v_mul_f32 v123, v115, v2
    v_mul_f32 v124, v116, v2
    v_mul_f32 v125, v117, v2
    v_mul_f32 v126, v118, v2
    v_fmac_f32 v119, v110, v3
    v_fmac_f32 v120, v111, v3
    v_fmac_f32 v121, v112, v3
    v_fmac_f32 v122, v113, v3
    v_fmac_f32 v123, v114, v3
    v_fmac_f32 v124, v115, v3
    v_fmac_f32 v125, v116, v3
    v_fmac_f32 v126, v117, v3
    v_fmac_f32 v119, v109, v4
    v_fmac_f32 v120, v110, v4
    v_fmac_f32 v121, v111, v4
    v_fmac_f32 v122, v112, v4
    v_fmac_f32 v123, v113, v4
    v_fmac_f32 v124, v114, v4
    v_fmac_f32 v125, v115, v4
    v_fmac_f32 v126, v116, v4
    v_fmac_f32 v119, v108, v5
    v_fmac_f32 v120, v109, v5
    v_fmac_f32 v121, v110, v5
    v_fmac_f32 v122, v111, v5
    v_fmac_f32 v123, v112, v5
    v_fmac_f32 v124, v113, v5
    v_fmac_f32 v125, v114, v5
    v_fmac_f32 v126, v115, v5
    v_lshlrev_b32 v108, 16, v63
    v_lshlrev_b32 v109, 16, v67
    v_lshlrev_b32 v110, 16, v71
    v_lshlrev_b32 v111, 16, v75
    v_lshlrev_b32 v112, 16, v79
    v_lshlrev_b32 v113, 16, v83
    v_lshlrev_b32 v114, 16, v87
    v_lshlrev_b32 v115, 16, v91
    v_mul_f32 v119, v119, v108
    v_mul_f32 v120, v120, v109
    v_mul_f32 v121, v121, v110
    v_mul_f32 v122, v122, v111
    v_mul_f32 v123, v123, v112
    v_mul_f32 v124, v124, v113
    v_mul_f32 v125, v125, v114
    v_mul_f32 v126, v126, v115
    v_cvt_pk_bf16_f32 v108, v126, v125
    v_cvt_pk_bf16_f32 v109, v124, v123
    v_cvt_pk_bf16_f32 v110, v122, v121
    v_cvt_pk_bf16_f32 v111, v120, v119
    s_waitcnt lgkmcnt(0)
    buffer_store_dwordx4 v[12:15], v8, s[60:63], s8 offen sc1
    s_add_u32 s8, s8, 0x1000
    ds_write_b128 v9, v[108:111]
    ds_read_b128 v[12:15], v10
    v_lshlrev_b32 v2, 16, v106
    v_and_b32 v3, 0xffff0000, v106
    v_lshlrev_b32 v4, 16, v107
    v_and_b32 v5, 0xffff0000, v107
    v_and_b32 v108, 0xffff0000, v19
    v_and_b32 v109, 0xffff0000, v23
    v_and_b32 v110, 0xffff0000, v27
    v_and_b32 v111, 0xffff0000, v31
    v_and_b32 v112, 0xffff0000, v35
    v_and_b32 v113, 0xffff0000, v39
    v_and_b32 v114, 0xffff0000, v43
    v_and_b32 v115, 0xffff0000, v47
    v_and_b32 v116, 0xffff0000, v51
    v_and_b32 v117, 0xffff0000, v55
    v_and_b32 v118, 0xffff0000, v59
    v_mul_f32 v119, v111, v2
    v_mul_f32 v120, v112, v2
    v_mul_f32 v121, v113, v2
    v_mul_f32 v122, v114, v2
    v_mul_f32 v123, v115, v2
    v_mul_f32 v124, v116, v2
    v_mul_f32 v125, v117, v2
    v_mul_f32 v126, v118, v2
    v_fmac_f32 v119, v110, v3
    v_fmac_f32 v120, v111, v3
    v_fmac_f32 v121, v112, v3
    v_fmac_f32 v122, v113, v3
    v_fmac_f32 v123, v114, v3
    v_fmac_f32 v124, v115, v3
    v_fmac_f32 v125, v116, v3
    v_fmac_f32 v126, v117, v3
    v_fmac_f32 v119, v109, v4
    v_fmac_f32 v120, v110, v4
    v_fmac_f32 v121, v111, v4
    v_fmac_f32 v122, v112, v4
    v_fmac_f32 v123, v113, v4
    v_fmac_f32 v124, v114, v4
    v_fmac_f32 v125, v115, v4
    v_fmac_f32 v126, v116, v4
    v_fmac_f32 v119, v108, v5
    v_fmac_f32 v120, v109, v5
    v_fmac_f32 v121, v110, v5
    v_fmac_f32 v122, v111, v5
    v_fmac_f32 v123, v112, v5
    v_fmac_f32 v124, v113, v5
    v_fmac_f32 v125, v114, v5
    v_fmac_f32 v126, v115, v5
    v_and_b32 v108, 0xffff0000, v63
    v_and_b32 v109, 0xffff0000, v67
    v_and_b32 v110, 0xffff0000, v71
    v_and_b32 v111, 0xffff0000, v75
    v_and_b32 v112, 0xffff0000, v79
    v_and_b32 v113, 0xffff0000, v83
    v_and_b32 v114, 0xffff0000, v87
    v_and_b32 v115, 0xffff0000, v91
    v_mul_f32 v119, v119, v108
    v_mul_f32 v120, v120, v109
    v_mul_f32 v121, v121, v110
    v_mul_f32 v122, v122, v111
    v_mul_f32 v123, v123, v112
    v_mul_f32 v124, v124, v113
    v_mul_f32 v125, v125, v114
    v_mul_f32 v126, v126, v115
    v_cvt_pk_bf16_f32 v108, v126, v125
    v_cvt_pk_bf16_f32 v109, v124, v123
    v_cvt_pk_bf16_f32 v110, v122, v121
    v_cvt_pk_bf16_f32 v111, v120, v119
    s_waitcnt lgkmcnt(0)
    buffer_store_dwordx4 v[12:15], v8, s[60:63], s8 offen sc1
    s_add_u32 s8, s8, 0x1000
    ds_write_b128 v9, v[108:111]
    ds_read_b128 v[12:15], v10
    s_waitcnt lgkmcnt(0)
    buffer_store_dwordx4 v[12:15], v8, s[60:63], s8 offen sc1
    s_add_u32 s8, s8, 0x1000
    s_mov_b32 s68, s42
    s_mov_b32 s69, s43
    s_mov_b32 s70, 256
    s_mov_b32 s71, 0x20000
    v_mov_b32 v3, 0
    s_mov_b32 s91, 20000
nz3:
    buffer_load_dword v2, v3, s[68:71], 0 offen sc1
    s_sub_u32 s91, s91, 1
    s_cbranch_scc1 nk3
    s_waitcnt vmcnt(0)
    v_readfirstlane_b32 s90, v2
    s_nop 0
    s_cmp_eq_u32 s90, 0
    s_cbranch_scc1 nz3
nk3:
    s_waitcnt vmcnt(0)
    s_and_b32 s90, s90, 0xffffffe0
    s_add_u32 s68, s44, 21168128
    s_addc_u32 s69, s45, 0
    s_mov_b32 s70, 163840
    s_mov_b32 s71, 0x20000
    s_lshl_b32 s6, s6, 7
    s_lshl_b32 s5, s5, 2
    s_add_u32 s6, s6, s5
    s_add_u32 s6, s6, 26624
    v_lshlrev_b32 v3, 20, v1
    v_mov_b32 v2, s90
    buffer_store_dword v2, v3, s[68:71], s6 offen sc1
    s_cmp_lg_u32 s96, 0
    s_cbranch_scc1 kb_u2
    s_cmp_lt_u32 s92, 28
    s_cbranch_scc1 kb_u2
    s_mov_b32 s4, s98
    s_mov_b32 s96, 1
    v_mov_b32 v16, v152
    v_mov_b32 v17, v153
    v_mov_b32 v18, v154
    v_mov_b32 v19, v155
    v_mov_b32 v20, v156
    v_mov_b32 v21, v157
    v_mov_b32 v22, v158
    v_mov_b32 v23, v159
    v_mov_b32 v24, v160
    v_mov_b32 v25, v161
    v_mov_b32 v26, v162
    v_mov_b32 v27, v163
    v_mov_b32 v28, v164
    v_mov_b32 v29, v165
    v_mov_b32 v30, v166
    v_mov_b32 v31, v167
    v_mov_b32 v32, v168
    v_mov_b32 v33, v169
    v_mov_b32 v34, v170
    v_mov_b32 v35, v171
    v_mov_b32 v36, v172
    v_mov_b32 v37, v173
    v_mov_b32 v38, v174
    v_mov_b32 v39, v175
    v_mov_b32 v40, v176
    v_mov_b32 v41, v177
    v_mov_b32 v42, v178
    v_mov_b32 v43, v179
    v_mov_b32 v44, v180
    v_mov_b32 v45, v181
    v_mov_b32 v46, v182
    v_mov_b32 v47, v183
    v_mov_b32 v48, v184
    v_mov_b32 v49, v185
    v_mov_b32 v50, v186
    v_mov_b32 v51, v187
    v_mov_b32 v52, v188
    v_mov_b32 v53, v189
    v_mov_b32 v54, v190
    v_mov_b32 v55, v191
    v_mov_b32 v56, v192
    v_mov_b32 v57, v193
    v_mov_b32 v58, v194
    v_mov_b32 v59, v195
    v_mov_b32 v60, v196
    v_mov_b32 v61, v197
    v_mov_b32 v62, v198
    v_mov_b32 v63, v199
    v_mov_b32 v64, v200
    v_mov_b32 v65, v201
    v_mov_b32 v66, v202
    v_mov_b32 v67, v203
    v_mov_b32 v68, v204
    v_mov_b32 v69, v205
    v_mov_b32 v70, v206
    v_mov_b32 v71, v207
    v_mov_b32 v72, v208
    v_mov_b32 v73, v209
    v_mov_b32 v74, v210
    v_mov_b32 v75, v211
    v_mov_b32 v76, v212
    v_mov_b32 v77, v213
    v_mov_b32 v78, v214
    v_mov_b32 v79, v215
    v_mov_b32 v80, v216
    v_mov_b32 v81, v217
    v_mov_b32 v82, v218
    v_mov_b32 v83, v219
    v_mov_b32 v84, v220
    v_mov_b32 v85, v221
    v_mov_b32 v86, v222
    v_mov_b32 v87, v223
    v_mov_b32 v88, v224
    v_mov_b32 v89, v225
    v_mov_b32 v90, v226
    v_mov_b32 v91, v227
    v_mov_b32 v92, v228
    v_mov_b32 v93, v229
    v_mov_b32 v94, v230
    v_mov_b32 v95, v231
    v_mov_b32 v96, v232
    v_mov_b32 v97, v233
    v_mov_b32 v98, v234
    v_mov_b32 v99, v235
    v_mov_b32 v100, v236
    v_mov_b32 v101, v237
    v_mov_b32 v102, v238
    v_mov_b32 v103, v239
    v_mov_b32 v104, v240
    v_mov_b32 v105, v241
    v_mov_b32 v106, v242
    v_mov_b32 v107, v243
    s_branch kb_ut
kb_u2:
    s_add_u32 s56, s44, 10485760
    s_addc_u32 s57, s45, 0
    s_mov_b32 s58, 10616832
    s_mov_b32 s59, 0x20000
    s_add_u32 s60, s44, 10289152
    s_addc_u32 s61, s45, 0
    s_mov_b32 s62, 110592
    s_mov_b32 s63, 0x20000
    v_lshrrev_b32 v5, 2, v1
    v_and_b32 v6, 6, v5
    v_bfe_u32 v7, v1, 1, 1
    v_xor_b32 v6, v6, v7
    v_lshlrev_b32 v6, 4, v6
    v_lshl_add_u32 v6, v5, 7, v6
    v_and_b32 v7, 1, v1
    v_lshl_add_u32 v8, v7, 3, v6
    v_xor_b32 v9, 32, v8
    v_xor_b32 v10, 64, v8
    v_xor_b32 v11, 96, v8
    v_add_u32 v8, s14, v8
    v_add_u32 v9, s14, v9
    v_add_u32 v10, s14, v10
    v_add_u32 v11, s14, v11
    s_mul_i32 s47, s93, 663552
    s_add_u32 s64, s36, s47
    s_addc_u32 s65, s37, 0
    s_mov_b32 s66, 663552
    s_mov_b32 s67, 0x20000
    v_lshrrev_b32 v201, 3, v1
    v_and_b32 v202, 6, v201
    v_and_b32 v203, 7, v1
    v_xor_b32 v202, v202, v203
    v_lshlrev_b32 v202, 4, v202
    v_mul_u32_u24 v201, 1152, v201
    v_add_u32 v200, v201, v202
    s_add_u32 s13, s97, 0
    s_mul_i32 s8, s13, 43
    s_lshr_b32 s8, s8, 8
    s_mul_i32 s6, s8, 6
    s_sub_u32 s6, s13, s6
    s_lshr_b32 s10, s8, 1
    s_lshl_b32 s10, s10, 1
    s_and_b32 s11, s8, 1
    s_mul_i32 s11, s11, 36
    s_add_u32 s10, s10, s11
    s_cmp_lt_u32 s8, 8
    s_cselect_b32 s10, s10, 8
    s_cselect_b32 s11, 1, 18
    s_cselect_b32 s12, 18, 36
    s_mul_i32 s5, s11, 18432
    s_mul_i32 s7, s12, 18432
    s_add_u32 s9, s5, s7
    s_mul_i32 s15, s93, 72
    s_add_u32 s10, s10, s15
    s_mul_i32 s10, s10, 18432
    s_mul_i32 s15, s6, 3072
    s_add_u32 s10, s10, s15
    s_mul_i32 s15, s93, 9
    s_add_u32 s15, s15, s8
    s_lshl_b32 s15, s15, 8
    s_mul_i32 s6, s6, 18432
    s_add_u32 s15, s15, s6
    s_cmp_lt_u32 s13, 54
    s_cselect_b32 s10, s10, 0x40000000
    s_cselect_b32 s15, s15, 0x40000000
    v_lshlrev_b32 v12, 4, v1
    v_add_u32 v12, s10, v12
    v_mov_b32 v13, 0x3f803f80
    v_mov_b32 v64, 0
    v_mov_b32 v65, 0
    v_mov_b32 v66, 0
    v_mov_b32 v67, 0
    ds_read_b64_tr_b16 v[16:17], v8 offset:0
    ds_read_b64_tr_b16 v[18:19], v8 offset:2048
    ds_read_b64_tr_b16 v[20:21], v9 offset:0
    ds_read_b64_tr_b16 v[22:23], v9 offset:2048
    ds_read_b64_tr_b16 v[24:25], v10 offset:0
    ds_read_b64_tr_b16 v[26:27], v10 offset:2048
    ds_read_b64_tr_b16 v[28:29], v11 offset:0
    ds_read_b64_tr_b16 v[30:31], v11 offset:2048
    s_waitcnt lgkmcnt(6)
    buffer_store_dwordx4 v[16:19], v12, s[56:59], 0 offen offset:0 sc1
    v_dot2c_f32_bf16 v64, v13, v16
    v_dot2c_f32_bf16 v64, v13, v17
    v_dot2c_f32_bf16 v64, v13, v18
    v_dot2c_f32_bf16 v64, v13, v19
    s_waitcnt lgkmcnt(4)
    buffer_store_dwordx4 v[20:23], v12, s[56:59], s5 offen offset:0 sc1
    v_dot2c_f32_bf16 v65, v13, v20
    v_dot2c_f32_bf16 v65, v13, v21
    v_dot2c_f32_bf16 v65, v13, v22
    v_dot2c_f32_bf16 v65, v13, v23
    s_waitcnt lgkmcnt(2)
    buffer_store_dwordx4 v[24:27], v12, s[56:59], s7 offen offset:0 sc1
    v_dot2c_f32_bf16 v66, v13, v24
    v_dot2c_f32_bf16 v66, v13, v25
    v_dot2c_f32_bf16 v66, v13, v26
    v_dot2c_f32_bf16 v66, v13, v27
    s_waitcnt lgkmcnt(0)
    buffer_store_dwordx4 v[28:31], v12, s[56:59], s9 offen offset:0 sc1
    v_dot2c_f32_bf16 v67, v13, v28
    v_dot2c_f32_bf16 v67, v13, v29
    v_dot2c_f32_bf16 v67, v13, v30
    v_dot2c_f32_bf16 v67, v13, v31
    ds_read_b64_tr_b16 v[32:33], v8 offset:4096
    ds_read_b64_tr_b16 v[34:35], v8 offset:6144
    ds_read_b64_tr_b16 v[36:37], v9 offset:4096
    ds_read_b64_tr_b16 v[38:39], v9 offset:6144
    ds_read_b64_tr_b16 v[40:41], v10 offset:4096
    ds_read_b64_tr_b16 v[42:43], v10 offset:6144
    ds_read_b64_tr_b16 v[44:45], v11 offset:4096
    ds_read_b64_tr_b16 v[46:47], v11 offset:6144
    s_waitcnt lgkmcnt(6)
    buffer_store_dwordx4 v[32:35], v12, s[56:59], 0 offen offset:1024 sc1
    v_dot2c_f32_bf16 v64, v13, v32
    v_dot2c_f32_bf16 v64, v13, v33
    v_dot2c_f32_bf16 v64, v13, v34
    v_dot2c_f32_bf16 v64, v13, v35
    s_waitcnt lgkmcnt(4)
    buffer_store_dwordx4 v[36:39], v12, s[56:59], s5 offen offset:1024 sc1
    v_dot2c_f32_bf16 v65, v13, v36
    v_dot2c_f32_bf16 v65, v13, v37
    v_dot2c_f32_bf16 v65, v13, v38
    v_dot2c_f32_bf16 v65, v13, v39
    s_waitcnt lgkmcnt(2)
    buffer_store_dwordx4 v[40:43], v12, s[56:59], s7 offen offset:1024 sc1
    v_dot2c_f32_bf16 v66, v13, v40
    v_dot2c_f32_bf16 v66, v13, v41
    v_dot2c_f32_bf16 v66, v13, v42
    v_dot2c_f32_bf16 v66, v13, v43
    s_waitcnt lgkmcnt(0)
    buffer_store_dwordx4 v[44:47], v12, s[56:59], s9 offen offset:1024 sc1
    v_dot2c_f32_bf16 v67, v13, v44
    v_dot2c_f32_bf16 v67, v13, v45
    v_dot2c_f32_bf16 v67, v13, v46
    v_dot2c_f32_bf16 v67, v13, v47
    ds_read_b64_tr_b16 v[48:49], v8 offset:8192
    ds_read_b64_tr_b16 v[50:51], v8 offset:10240
    ds_read_b64_tr_b16 v[52:53], v9 offset:8192
    ds_read_b64_tr_b16 v[54:55], v9 offset:10240
    ds_read_b64_tr_b16 v[56:57], v10 offset:8192
    ds_read_b64_tr_b16 v[58:59], v10 offset:10240
    ds_read_b64_tr_b16 v[60:61], v11 offset:8192
    ds_read_b64_tr_b16 v[62:63], v11 offset:10240
    s_waitcnt lgkmcnt(6)
    buffer_store_dwordx4 v[48:51], v12, s[56:59], 0 offen offset:2048 sc1
    v_dot2c_f32_bf16 v64, v13, v48
    v_dot2c_f32_bf16 v64, v13, v49
    v_dot2c_f32_bf16 v64, v13, v50
    v_dot2c_f32_bf16 v64, v13, v51
    s_waitcnt lgkmcnt(4)
    buffer_store_dwordx4 v[52:55], v12, s[56:59], s5 offen offset:2048 sc1
    v_dot2c_f32_bf16 v65, v13, v52
    v_dot2c_f32_bf16 v65, v13, v53
    v_dot2c_f32_bf16 v65, v13, v54
    v_dot2c_f32_bf16 v65, v13, v55
    s_waitcnt lgkmcnt(2)
    buffer_store_dwordx4 v[56:59], v12, s[56:59], s7 offen offset:2048 sc1
    v_dot2c_f32_bf16 v66, v13, v56
    v_dot2c_f32_bf16 v66, v13, v57
    v_dot2c_f32_bf16 v66, v13, v58
    v_dot2c_f32_bf16 v66, v13, v59
    s_waitcnt lgkmcnt(0)
    buffer_store_dwordx4 v[60:63], v12, s[56:59], s9 offen offset:2048 sc1
    v_dot2c_f32_bf16 v67, v13, v60
    v_dot2c_f32_bf16 v67, v13, v61
    v_dot2c_f32_bf16 v67, v13, v62
    v_dot2c_f32_bf16 v67, v13, v63
    v_mov_b32 v68, v64
    s_nop 1
    v_permlane32_swap_b32 v68, v64
    v_add_f32 v64, v64, v68
    v_mov_b32 v68, v64
    s_nop 1
    v_permlane16_swap_b32 v68, v64
    v_add_f32 v64, v64, v68
    v_mov_b32 v69, v65
    s_nop 1
    v_permlane32_swap_b32 v69, v65
    v_add_f32 v65, v65, v69
    v_mov_b32 v69, v65
    s_nop 1
    v_permlane16_swap_b32 v69, v65
    v_add_f32 v65, v65, v69
    v_mov_b32 v70, v66
    s_nop 1
    v_permlane32_swap_b32 v70, v66
    v_add_f32 v66, v66, v70
    v_mov_b32 v70, v66
    s_nop 1
    v_permlane16_swap_b32 v70, v66
    v_add_f32 v66, v66, v70
    v_mov_b32 v71, v67
    s_nop 1
    v_permlane32_swap_b32 v71, v67
    v_add_f32 v67, v67, v71
    v_mov_b32 v71, v67
    s_nop 1
    v_permlane16_swap_b32 v71, v67
    v_add_f32 v67, v67, v71
    v_lshrrev_b32 v5, 4, v1
    v_cmp_eq_u32 vcc, 1, v5
    s_nop 1
    v_cndmask_b32 v64, v64, v65, vcc
    v_cmp_eq_u32 vcc, 2, v5
    s_nop 1
    v_cndmask_b32 v64, v64, v66, vcc
    v_cmp_eq_u32 vcc, 3, v5
    s_nop 1
    v_cndmask_b32 v64, v64, v67, vcc
    v_lshlrev_b32 v5, 2, v1
    v_add_u32 v5, s15, v5
    buffer_store_dword v64, v5, s[60:63], 0 offen sc1
    s_add_u32 s13, s97, 28
    s_mul_i32 s8, s13, 43
    s_lshr_b32 s8, s8, 8
    s_mul_i32 s6, s8, 6
    s_sub_u32 s6, s13, s6
    s_lshr_b32 s10, s8, 1
    s_lshl_b32 s10, s10, 1
    s_and_b32 s11, s8, 1
    s_mul_i32 s11, s11, 36
    s_add_u32 s10, s10, s11
    s_cmp_lt_u32 s8, 8
    s_cselect_b32 s10, s10, 8
    s_cselect_b32 s11, 1, 18
    s_cselect_b32 s12, 18, 36
    s_mul_i32 s5, s11, 18432
    s_mul_i32 s7, s12, 18432
    s_add_u32 s9, s5, s7
    s_mul_i32 s15, s93, 72
    s_add_u32 s10, s10, s15
    s_mul_i32 s10, s10, 18432
    s_mul_i32 s15, s6, 3072
    s_add_u32 s10, s10, s15
    s_mul_i32 s15, s93, 9
    s_add_u32 s15, s15, s8
    s_lshl_b32 s15, s15, 8
    s_mul_i32 s6, s6, 18432
    s_add_u32 s15, s15, s6
    s_cmp_lt_u32 s13, 54
    s_cselect_b32 s10, s10, 0x40000000
    s_cselect_b32 s15, s15, 0x40000000
    v_lshlrev_b32 v12, 4, v1
    v_add_u32 v12, s10, v12
    v_mov_b32 v13, 0x3f803f80
    v_mov_b32 v64, 0
    v_mov_b32 v65, 0
    v_mov_b32 v66, 0
    v_mov_b32 v67, 0
    ds_read_b64_tr_b16 v[16:17], v8 offset:12288
    ds_read_b64_tr_b16 v[18:19], v8 offset:14336
    ds_read_b64_tr_b16 v[20:21], v9 offset:12288
    ds_read_b64_tr_b16 v[22:23], v9 offset:14336
    ds_read_b64_tr_b16 v[24:25], v10 offset:12288
    ds_read_b64_tr_b16 v[26:27], v10 offset:14336
    ds_read_b64_tr_b16 v[28:29], v11 offset:12288
    ds_read_b64_tr_b16 v[30:31], v11 offset:14336
    s_waitcnt lgkmcnt(6)
    buffer_store_dwordx4 v[16:19], v12, s[56:59], 0 offen offset:0 sc1
    v_dot2c_f32_bf16 v64, v13, v16
    v_dot2c_f32_bf16 v64, v13, v17
    v_dot2c_f32_bf16 v64, v13, v18
    v_dot2c_f32_bf16 v64, v13, v19
    s_waitcnt lgkmcnt(4)
    buffer_store_dwordx4 v[20:23], v12, s[56:59], s5 offen offset:0 sc1
    v_dot2c_f32_bf16 v65, v13, v20
    v_dot2c_f32_bf16 v65, v13, v21
    v_dot2c_f32_bf16 v65, v13, v22
    v_dot2c_f32_bf16 v65, v13, v23
    s_waitcnt lgkmcnt(2)
    buffer_store_dwordx4 v[24:27], v12, s[56:59], s7 offen offset:0 sc1
    v_dot2c_f32_bf16 v66, v13, v24
    v_dot2c_f32_bf16 v66, v13, v25
    v_dot2c_f32_bf16 v66, v13, v26
    v_dot2c_f32_bf16 v66, v13, v27
    s_waitcnt lgkmcnt(0)
    buffer_store_dwordx4 v[28:31], v12, s[56:59], s9 offen offset:0 sc1
    v_dot2c_f32_bf16 v67, v13, v28
    v_dot2c_f32_bf16 v67, v13, v29
    v_dot2c_f32_bf16 v67, v13, v30
    v_dot2c_f32_bf16 v67, v13, v31
    ds_read_b64_tr_b16 v[32:33], v8 offset:16384
    ds_read_b64_tr_b16 v[34:35], v8 offset:18432
    ds_read_b64_tr_b16 v[36:37], v9 offset:16384
    ds_read_b64_tr_b16 v[38:39], v9 offset:18432
    ds_read_b64_tr_b16 v[40:41], v10 offset:16384
    ds_read_b64_tr_b16 v[42:43], v10 offset:18432
    ds_read_b64_tr_b16 v[44:45], v11 offset:16384
    ds_read_b64_tr_b16 v[46:47], v11 offset:18432
    s_waitcnt lgkmcnt(6)
    buffer_store_dwordx4 v[32:35], v12, s[56:59], 0 offen offset:1024 sc1
    v_dot2c_f32_bf16 v64, v13, v32
    v_dot2c_f32_bf16 v64, v13, v33
    v_dot2c_f32_bf16 v64, v13, v34
    v_dot2c_f32_bf16 v64, v13, v35
    s_waitcnt lgkmcnt(4)
    buffer_store_dwordx4 v[36:39], v12, s[56:59], s5 offen offset:1024 sc1
    v_dot2c_f32_bf16 v65, v13, v36
    v_dot2c_f32_bf16 v65, v13, v37
    v_dot2c_f32_bf16 v65, v13, v38
    v_dot2c_f32_bf16 v65, v13, v39
    s_waitcnt lgkmcnt(2)
    buffer_store_dwordx4 v[40:43], v12, s[56:59], s7 offen offset:1024 sc1
    v_dot2c_f32_bf16 v66, v13, v40
    v_dot2c_f32_bf16 v66, v13, v41
    v_dot2c_f32_bf16 v66, v13, v42
    v_dot2c_f32_bf16 v66, v13, v43
    s_waitcnt lgkmcnt(0)
    buffer_store_dwordx4 v[44:47], v12, s[56:59], s9 offen offset:1024 sc1
    v_dot2c_f32_bf16 v67, v13, v44
    v_dot2c_f32_bf16 v67, v13, v45
    v_dot2c_f32_bf16 v67, v13, v46
    v_dot2c_f32_bf16 v67, v13, v47
    ds_read_b64_tr_b16 v[48:49], v8 offset:20480
    ds_read_b64_tr_b16 v[50:51], v8 offset:22528
    ds_read_b64_tr_b16 v[52:53], v9 offset:20480
    ds_read_b64_tr_b16 v[54:55], v9 offset:22528
    ds_read_b64_tr_b16 v[56:57], v10 offset:20480
    ds_read_b64_tr_b16 v[58:59], v10 offset:22528
    ds_read_b64_tr_b16 v[60:61], v11 offset:20480
    ds_read_b64_tr_b16 v[62:63], v11 offset:22528
    s_waitcnt lgkmcnt(6)
    buffer_store_dwordx4 v[48:51], v12, s[56:59], 0 offen offset:2048 sc1
    v_dot2c_f32_bf16 v64, v13, v48
    v_dot2c_f32_bf16 v64, v13, v49
    v_dot2c_f32_bf16 v64, v13, v50
    v_dot2c_f32_bf16 v64, v13, v51
    s_waitcnt lgkmcnt(4)
    buffer_store_dwordx4 v[52:55], v12, s[56:59], s5 offen offset:2048 sc1
    v_dot2c_f32_bf16 v65, v13, v52
    v_dot2c_f32_bf16 v65, v13, v53
    v_dot2c_f32_bf16 v65, v13, v54
    v_dot2c_f32_bf16 v65, v13, v55
    s_waitcnt lgkmcnt(2)
    buffer_store_dwordx4 v[56:59], v12, s[56:59], s7 offen offset:2048 sc1
    v_dot2c_f32_bf16 v66, v13, v56
    v_dot2c_f32_bf16 v66, v13, v57
    v_dot2c_f32_bf16 v66, v13, v58
    v_dot2c_f32_bf16 v66, v13, v59
    s_waitcnt lgkmcnt(0)
    buffer_store_dwordx4 v[60:63], v12, s[56:59], s9 offen offset:2048 sc1
    v_dot2c_f32_bf16 v67, v13, v60
    v_dot2c_f32_bf16 v67, v13, v61
    v_dot2c_f32_bf16 v67, v13, v62
    v_dot2c_f32_bf16 v67, v13, v63
    v_mov_b32 v68, v64
    s_nop 1
    v_permlane32_swap_b32 v68, v64
    v_add_f32 v64, v64, v68
    v_mov_b32 v68, v64
    s_nop 1
    v_permlane16_swap_b32 v68, v64
    v_add_f32 v64, v64, v68
    v_mov_b32 v69, v65
    s_nop 1
    v_permlane32_swap_b32 v69, v65
    v_add_f32 v65, v65, v69
    v_mov_b32 v69, v65
    s_nop 1
    v_permlane16_swap_b32 v69, v65
    v_add_f32 v65, v65, v69
    v_mov_b32 v70, v66
    s_nop 1
    v_permlane32_swap_b32 v70, v66
    v_add_f32 v66, v66, v70
    v_mov_b32 v70, v66
    s_nop 1
    v_permlane16_swap_b32 v70, v66
    v_add_f32 v66, v66, v70
    v_mov_b32 v71, v67
    s_nop 1
    v_permlane32_swap_b32 v71, v67
    v_add_f32 v67, v67, v71
    v_mov_b32 v71, v67
    s_nop 1
    v_permlane16_swap_b32 v71, v67
    v_add_f32 v67, v67, v71
    v_lshrrev_b32 v5, 4, v1
    v_cmp_eq_u32 vcc, 1, v5
    s_nop 1
    v_cndmask_b32 v64, v64, v65, vcc
    v_cmp_eq_u32 vcc, 2, v5
    s_nop 1
    v_cndmask_b32 v64, v64, v66, vcc
    v_cmp_eq_u32 vcc, 3, v5
    s_nop 1
    v_cndmask_b32 v64, v64, v67, vcc
    v_lshlrev_b32 v5, 2, v1
    v_add_u32 v5, s15, v5
    buffer_store_dword v64, v5, s[60:63], 0 offen sc1
    s_and_b32 s13, s94, 28
    s_add_u32 s13, s13, s3
    s_add_u32 s13, s13, 128
    s_mul_i32 s15, s13, 57
    s_lshr_b32 s15, s15, 9
    s_mul_i32 s46, s15, 9
    s_sub_u32 s46, s13, s46
    s_mul_i32 s15, s15, 36864
    s_lshl_b32 s46, s46, 7
    s_add_u32 s15, s15, s46
    v_add_u32 v201, s15, v200
    s_add_u32 m0, s14, 0
    s_mov_b32 s47, 0
    buffer_load_dwordx4 v201, s[64:67], s47 offen offset:0 nt lds
    s_add_u32 s47, s47, 8192
    buffer_load_dwordx4 v201, s[64:67], s47 offen offset:1024 nt lds
    s_add_u32 s47, s47, 8192
    buffer_load_dwordx4 v201, s[64:67], s47 offen offset:2048 nt lds
    s_add_u32 s47, s47, 8192
    buffer_load_dwordx4 v201, s[64:67], s47 offen offset:3072 nt lds
    s_and_b32 s13, s94, 28
    s_add_u32 s13, s13, s3
    s_add_u32 s13, s13, 160
    s_mul_i32 s15, s13, 57
    s_lshr_b32 s15, s15, 9
    s_mul_i32 s46, s15, 9
    s_sub_u32 s46, s13, s46
    s_mul_i32 s15, s15, 36864
    s_lshl_b32 s46, s46, 7
    s_add_u32 s15, s15, s46
    v_add_u32 v201, s15, v200
    s_add_u32 m0, s14, 4096
    s_mov_b32 s47, 0
    buffer_load_dwordx4 v201, s[64:67], s47 offen offset:0 nt lds
    s_add_u32 s47, s47, 8192
    buffer_load_dwordx4 v201, s[64:67], s47 offen offset:1024 nt lds
    s_add_u32 s47, s47, 8192
    buffer_load_dwordx4 v201, s[64:67], s47 offen offset:2048 nt lds
    s_add_u32 s47, s47, 8192
    buffer_load_dwordx4 v201, s[64:67], s47 offen offset:3072 nt lds
    s_lshl_b32 s10, s93, 7
    s_lshl_b32 s5, s92, 2
    s_add_u32 s10, s10, s5
    s_add_u32 s10, s10, 25600
    s_mov_b32 s4, s93
    s_mov_b32 s5, s94
    v_lshlrev_b32 v2, 4, v1
    s_lshl_b32 s6, s5, 1
    s_add_u32 s6, s6, s95
    s_add_u32 s6, s6, 506
    s_mov_b32 s8, 0
    s_mov_b32 s9, 33280
    s_lshl_b32 s46, s6, 12
    s_add_u32 s64, s24, s46
    s_addc_u32 s65, s25, 0
    s_mov_b32 s66, 4096
    s_mov_b32 s67, 0x20000
    s_lshl_b32 s47, s3, 10
    v_add_u32 v24, s47, v2
    v_subrev_u32 v24, 16, v24
    buffer_load_dwordx4 v[192:195], v24, s[64:67], 0 offen offset:0 nt
    buffer_load_dwordx4 v[196:199], v24, s[64:67], 0 offen offset:16 nt
    s_mov_b32 s64, s26
    s_mov_b32 s65, s27
    s_mov_b32 s66, 1152
    s_mov_b32 s67, 0x20000
    s_lshl_b32 s47, s6, 1
    v_mov_b32 v24, s47
    buffer_load_ushort v23, v24, s[64:67], 0 offen
    s_lshl_b32 s11, s3, 10
    s_add_u32 s11, s11, s46
    s_lshl_b32 s92, s3, 8
    s_lshl_b32 s12, s6, 2
    s_add_u32 s92, s92, s12
    s_add_u32 s92, s92, 18432
    s_lshr_b32 s13, s3, 1
    s_lshl_b32 s15, s2, 1
    s_add_u32 s15, s15, s13
    s_and_b32 s96, s3, 1
    s_mul_i32 s0, s13, 4576
    s_add_u32 s0, s0, 147456
    s_lshl_b32 s46, s15, 12
    s_add_u32 s64, s24, s46
    s_addc_u32 s65, s25, 0
    s_mov_b32 s66, 4096
    s_mov_b32 s67, 0x20000
    s_lshl_b32 s47, s96, 10
    v_add_u32 v19, s47, v2
    v_subrev_u32 v19, 16, v19
    buffer_load_dwordx4 v[28:31], v19, s[64:67], 0 offen offset:0 nt
    buffer_load_dwordx4 v[32:35], v19, s[64:67], 0 offen offset:16 nt
    buffer_load_dwordx4 v[36:39], v19, s[64:67], 0 offen offset:2048 nt
    buffer_load_dwordx4 v[40:43], v19, s[64:67], 0 offen offset:2064 nt
    s_mov_b32 s64, s26
    s_mov_b32 s65, s27
    s_mov_b32 s66, 1152
    s_mov_b32 s67, 0x20000
    s_lshl_b32 s47, s15, 1
    v_mov_b32 v19, s47
    buffer_load_ushort v18, v19, s[64:67], 0 offen
    s_mul_i32 s1, s13, 33280
    s_add_u32 s1, s1, 73728
    s_lshl_b32 s97, s96, 11
    s_lshl_b32 s98, s15, 2
    s_add_u32 s98, s98, s97
    s_add_u32 s98, s98, 0x4000
    s_add_u32 s97, s97, s46
    v_and_b32 v13, 31, v1
    v_lshlrev_b32 v13, 2, v13
    s_lshr_b32 s13, s2, 5
    s_sub_u32 s13, 8, s13
    s_lshl_b32 s13, s13, 7
    v_mov_b32 v12, s13
    v_cmp_gt_u32 vcc, 32, v1
    s_nop 1
    v_cndmask_b32 v12, 0, v12, vcc
    v_sub_u32 v13, v13, v12
    v_add_u32 v13, 27648, v13
    buffer_load_dword v12, v13, s[68:71], 0 offen sc1
    s_waitcnt vmcnt(17)
    v_lshlrev_b32 v5, 20, v1
    v_mov_b32 v4, s90
    buffer_store_dword v4, v5, s[68:71], s10 offen sc1
    s_mul_i32 s47, s93, 663552
    s_add_u32 s64, s36, s47
    s_addc_u32 s65, s37, 0
    s_mov_b32 s66, 663552
    s_mov_b32 s67, 0x20000
    s_waitcnt vmcnt(1)
    v_subrev_u32 v12, s90, v12
    v_cmp_lt_u32 vcc, 0, v12
    s_mov_b32 s91, 20000
    s_nop 0
    s_cbranch_vccz ck4
cr4:
    s_sleep 4
    buffer_load_dword v12, v13, s[68:71], 0 offen sc1
    s_sub_u32 s91, s91, 1
    s_waitcnt vmcnt(0)
    v_subrev_u32 v12, s90, v12
    v_cmp_lt_u32 vcc, 0, v12
    s_cbranch_scc1 ck4
    s_nop 0
    s_cbranch_vccnz cr4
ck4:
    s_and_b32 s47, s11, 0xfffff000
    s_add_u32 s47, s47, 4980736
    s_add_u32 s64, s44, s47
    s_addc_u32 s65, s45, 0
    s_mov_b32 s66, 4096
    s_mov_b32 s67, 0x20000
    s_lshl_b32 s47, s3, 10
    v_add_u32 v19, s47, v2
    s_add_u32 m0, s9, s47
    s_nop 0
    buffer_load_dwordx4 v19, s[64:67], 0 offen offset:0 sc1 lds
    s_and_b32 s47, s97, 0xfffff000
    s_add_u32 s47, s47, 4980736
    s_add_u32 s64, s44, s47
    s_addc_u32 s65, s45, 0
    s_mov_b32 s66, 4096
    s_mov_b32 s67, 0x20000
    s_lshl_b32 s47, s96, 10
    v_add_u32 v19, s47, v2
    s_add_u32 m0, s0, s47
    s_nop 0
    buffer_load_dwordx4 v19, s[64:67], 0 offen offset:0 sc1 lds
    buffer_load_dwordx4 v19, s[64:67], 0 offen offset:2048 sc1 lds
    v_mov_b32 v128, 0
    v_mov_b32 v129, 0
    v_mov_b32 v130, 0
    v_mov_b32 v131, 0
    v_min_u32 v20, 464, v2
    v_add_u32 v20, s9, v20
    v_and_b32 v21, 7, v1
    v_mul_u32_u24 v14, 4160, v21
    v_add_u32 v14, s8, v14
    ds_write_b128 v20, v[128:131] offset:4096
    ds_write_b128 v14, v[128:131]
    s_lshl_b32 s99, s3, 10
    s_add_u32 s99, s99, s8
    v_add_u32 v20, s99, v2
    ds_write_b128 v20, v[194:197] offset:12496
    ds_write_b128 v20, v[196:199] offset:29136
    v_mov_b32 v132, v193
    v_mov_b32 v133, v194
    v_mov_b32 v134, v195
    v_mov_b32 v135, v196
    v_mov_b32 v136, v197
    v_mov_b32 v137, v198
    v_alignbit_b32 v138, v193, v192, 16
    v_alignbit_b32 v139, v194, v193, 16
    v_alignbit_b32 v140, v195, v194, 16
    v_alignbit_b32 v141, v196, v195, 16
    v_alignbit_b32 v142, v197, v196, 16
    v_alignbit_b32 v143, v198, v197, 16
    v_alignbit_b32 v144, v199, v198, 16
    v_alignbit_b32 v146, v194, v193, 16
    v_alignbit_b32 v147, v195, v194, 16
    v_alignbit_b32 v148, v196, v195, 16
    v_alignbit_b32 v149, v197, v196, 16
    v_alignbit_b32 v150, v198, v197, 16
    v_alignbit_b32 v151, v199, v198, 16
    ds_write_b128 v20, v[138:141] offset:16
    ds_write_b128 v20, v[132:135] offset:4176
    ds_write_b128 v20, v[146:149] offset:8336
    ds_write_b128 v20, v[140:143] offset:16656
    ds_write_b128 v20, v[134:137] offset:20816
    ds_write_b128 v20, v[148:151] offset:24976
    s_add_u32 s56, s44, 7340032
    s_addc_u32 s57, s45, 0
    s_mov_b32 s58, 2359296
    s_mov_b32 s59, 0x20000
    s_add_u32 s60, s44, 10485760
    s_addc_u32 s61, s45, 0
    s_mov_b32 s62, 10616832
    s_mov_b32 s63, 0x20000
    s_waitcnt vmcnt(0)
    v_lshrrev_b32 v20, 2, v1
    v_and_b32 v21, 6, v20
    v_bfe_u32 v22, v1, 1, 1
    v_xor_b32 v21, v21, v22
    v_lshlrev_b32 v21, 4, v21
    v_lshl_add_u32 v21, v20, 7, v21
    v_and_b32 v22, 1, v1
    v_lshl_add_u32 v8, v22, 3, v21
    v_xor_b32 v9, 32, v8
    v_xor_b32 v10, 64, v8
    v_xor_b32 v11, 96, v8
    v_add_u32 v8, s14, v8
    v_add_u32 v9, s14, v9
    v_add_u32 v10, s14, v10
    v_add_u32 v11, s14, v11
    ds_read_b64_tr_b16 a[0:1], v8 offset:0
    ds_read_b64_tr_b16 a[2:3], v8 offset:2048
    ds_read_b64_tr_b16 a[4:5], v9 offset:0
    ds_read_b64_tr_b16 a[6:7], v9 offset:2048
    ds_read_b64_tr_b16 a[8:9], v10 offset:0
    ds_read_b64_tr_b16 a[10:11], v10 offset:2048
    ds_read_b64_tr_b16 a[12:13], v11 offset:0
    ds_read_b64_tr_b16 a[14:15], v11 offset:2048
    s_and_b32 s13, s94, 28
    s_add_u32 s13, s13, s3
    s_add_u32 s13, s13, 128
    s_mul_i32 s15, s13, 57
    s_lshr_b32 s15, s15, 9
    s_mul_i32 s46, s15, 9
    s_sub_u32 s46, s13, s46
    s_sub_u32 s47, s46, s4
    s_sub_u32 s47, s47, 1
    s_and_b32 s47, s47, 7
    s_add_u32 s47, s47, 10
    s_cmp_lt_u32 s46, 8
    s_cselect_b32 s47, s47, 9
    s_mul_i32 s46, s4, 72
    s_add_u32 s47, s47, s46
    s_mul_i32 s47, s47, 18432
    s_lshl_b32 s15, s15, 10
    s_add_u32 s47, s47, s15
    s_cmp_lt_u32 s13, 162
    s_cselect_b32 s47, s47, 0x40000000
    v_add_u32 v244, s47, v2
    ds_read_b64_tr_b16 a[16:17], v8 offset:4096
    ds_read_b64_tr_b16 a[18:19], v8 offset:6144
    ds_read_b64_tr_b16 a[20:21], v9 offset:4096
    ds_read_b64_tr_b16 a[22:23], v9 offset:6144
    ds_read_b64_tr_b16 a[24:25], v10 offset:4096
    ds_read_b64_tr_b16 a[26:27], v10 offset:6144
    ds_read_b64_tr_b16 a[28:29], v11 offset:4096
    ds_read_b64_tr_b16 a[30:31], v11 offset:6144
    s_and_b32 s13, s94, 28
    s_add_u32 s13, s13, s3
    s_add_u32 s13, s13, 160
    s_mul_i32 s15, s13, 57
    s_lshr_b32 s15, s15, 9
    s_mul_i32 s46, s15, 9
    s_sub_u32 s46, s13, s46
    s_sub_u32 s47, s46, s4
    s_sub_u32 s47, s47, 1
    s_and_b32 s47, s47, 7
    s_add_u32 s47, s47, 10
    s_cmp_lt_u32 s46, 8
    s_cselect_b32 s47, s47, 9
    s_mul_i32 s46, s4, 72
    s_add_u32 s47, s47, s46
    s_mul_i32 s47, s47, 18432
    s_lshl_b32 s15, s15, 10
    s_add_u32 s47, s47, s15
    s_cmp_lt_u32 s13, 162
    s_cselect_b32 s47, s47, 0x40000000
    v_add_u32 v245, s47, v2
    s_mul_i32 s99, s3, 128
    v_and_b32 v20, 8, v1
    v_lshl_add_u32 v14, v20, 1, v14
    v_lshrrev_b32 v16, 4, v1
    v_lshl_add_u32 v14, v16, 4, v14
    v_add_u32 v14, s99, v14
    v_and_b32 v17, 15, v1
    v_lshlrev_b32 v17, 5, v17
    v_lshlrev_b32 v15, 4, v16
    v_sub_u32 v15, v15, v17
    s_add_u32 s99, s99, s9
    s_add_u32 s99, s99, 480
    v_add_u32 v15, s99, v15
    s_waitcnt lgkmcnt(0)
    s_barrier
    ds_read_b128 v[80:83], v14 offset:0
    ds_read_b128 v[124:127], v15 offset:0
    ds_read_b128 v[120:123], v15 offset:512
    ds_read_b128 v[116:119], v15 offset:1024
    ds_read_b128 v[112:115], v15 offset:1536
    ds_read_b128 v[108:111], v15 offset:2048
    ds_read_b128 v[104:107], v15 offset:2560
    ds_read_b128 v[100:103], v15 offset:3072
    ds_read_b128 v[96:99], v15 offset:3584
    ds_read_b128 v[84:87], v14 offset:512
    ds_read_b128 v[88:91], v14 offset:1024
    ds_read_b128 v[92:95], v14 offset:1536
    s_waitcnt lgkmcnt(10)
    v_mfma_f32_16x16x32_bf16 v[76:79], v[80:83], v[124:127], 0
    s_mul_i32 s47, s4, 663552
    s_add_u32 s64, s36, s47
    s_addc_u32 s65, s37, 0
    s_mov_b32 s66, 663552
    s_mov_b32 s67, 0x20000
    v_lshrrev_b32 v20, 3, v1
    v_and_b32 v21, 6, v20
    v_and_b32 v22, 7, v1
    v_xor_b32 v21, v21, v22
    v_lshlrev_b32 v21, 4, v21
    v_mul_u32_u24 v20, 1152, v20
    v_add_u32 v19, v20, v21
    s_lshl_b32 s13, s5, 2
    s_add_u32 s13, s13, s3
    s_mul_i32 s15, s13, 57
    s_lshr_b32 s15, s15, 9
    s_mul_i32 s46, s15, 9
    s_sub_u32 s46, s13, s46
    s_mul_i32 s15, s15, 36864
    s_lshl_b32 s46, s46, 7
    s_add_u32 s15, s15, s46
    s_lshl_b32 s47, s3, 10
    s_add_u32 m0, s47, 53248
    s_nop 0
    buffer_load_dwordx4 v19, s[64:67], s15 offen nt lds
    s_add_u32 m0, m0, 0x1000
    s_add_u32 s15, s15, 9216
    buffer_load_dwordx4 v19, s[64:67], s15 offen nt lds
    s_add_u32 m0, m0, 0x1000
    s_add_u32 s15, s15, 9216
    buffer_load_dwordx4 v19, s[64:67], s15 offen nt lds
    s_add_u32 m0, m0, 0x1000
    s_add_u32 s15, s15, 9216
    buffer_load_dwordx4 v19, s[64:67], s15 offen nt lds
    s_waitcnt lgkmcnt(9)
    v_mfma_f32_16x16x32_bf16 v[72:75], v[80:83], v[120:123], 0
    s_mov_b32 s91, 0
    buffer_store_dwordx4 a[0:3], v244, s[60:63], s91 offen sc1
    s_waitcnt lgkmcnt(8)
    v_mfma_f32_16x16x32_bf16 v[68:71], v[80:83], v[116:119], 0
    s_waitcnt lgkmcnt(7)
    v_mfma_f32_16x16x32_bf16 v[64:67], v[80:83], v[112:115], 0
    s_waitcnt lgkmcnt(6)
    v_mfma_f32_16x16x32_bf16 v[60:63], v[80:83], v[108:111], 0
    s_mov_b32 s91, 331776
    buffer_store_dwordx4 a[4:7], v244, s[60:63], s91 offen sc1
    s_waitcnt lgkmcnt(5)
    v_mfma_f32_16x16x32_bf16 v[56:59], v[80:83], v[104:107], 0
    s_waitcnt lgkmcnt(4)
    v_mfma_f32_16x16x32_bf16 v[52:55], v[80:83], v[100:103], 0
    s_waitcnt lgkmcnt(3)
    v_mfma_f32_16x16x32_bf16 v[48:51], v[80:83], v[96:99], 0
    s_mov_b32 s91, 663552
    buffer_store_dwordx4 a[8:11], v244, s[60:63], s91 offen sc1
    s_waitcnt lgkmcnt(2)
    v_mfma_f32_16x16x32_bf16 v[76:79], v[84:87], v[120:123], v[76:79]
    ds_read_b128 v[80:83], v14 offset:2048
    v_mfma_f32_16x16x32_bf16 v[72:75], v[84:87], v[116:119], v[72:75]
    ds_read_b128 v[156:159], v15 offset:64
    v_mfma_f32_16x16x32_bf16 v[68:71], v[84:87], v[112:115], v[68:71]
    ds_read_b128 v[152:155], v15 offset:576
    s_mov_b32 s91, 995328
    buffer_store_dwordx4 a[12:15], v244, s[60:63], s91 offen sc1
    v_mfma_f32_16x16x32_bf16 v[64:67], v[84:87], v[108:111], v[64:67]
    ds_read_b128 v[148:151], v15 offset:1088
    v_mfma_f32_16x16x32_bf16 v[60:63], v[84:87], v[104:107], v[60:63]
    ds_read_b128 v[144:147], v15 offset:1600
    v_mfma_f32_16x16x32_bf16 v[56:59], v[84:87], v[100:103], v[56:59]
    ds_read_b128 v[140:143], v15 offset:2112
    s_mov_b32 s91, 0
    buffer_store_dwordx4 a[16:19], v245, s[60:63], s91 offen sc1
    v_mfma_f32_16x16x32_bf16 v[52:55], v[84:87], v[96:99], v[52:55]
    ds_read_b128 v[136:139], v15 offset:2624
    s_waitcnt lgkmcnt(8)
    v_mfma_f32_16x16x32_bf16 v[76:79], v[88:91], v[116:119], v[76:79]
    ds_read_b128 v[84:87], v14 offset:2560
    v_mfma_f32_16x16x32_bf16 v[72:75], v[88:91], v[112:115], v[72:75]
    ds_read_b128 v[132:135], v15 offset:3136
    s_mov_b32 s91, 331776
    buffer_store_dwordx4 a[20:23], v245, s[60:63], s91 offen sc1
    v_mfma_f32_16x16x32_bf16 v[68:71], v[88:91], v[108:111], v[68:71]
    ds_read_b128 v[128:131], v15 offset:3648
    v_mfma_f32_16x16x32_bf16 v[64:67], v[88:91], v[104:107], v[64:67]
    v_mfma_f32_16x16x32_bf16 v[60:63], v[88:91], v[100:103], v[60:63]
    s_mov_b32 s91, 663552
    buffer_store_dwordx4 a[24:27], v245, s[60:63], s91 offen sc1
    v_mfma_f32_16x16x32_bf16 v[56:59], v[88:91], v[96:99], v[56:59]
    s_waitcnt lgkmcnt(10)
    v_mfma_f32_16x16x32_bf16 v[76:79], v[92:95], v[112:115], v[76:79]
    ds_read_b128 v[88:91], v14 offset:3072
    v_mfma_f32_16x16x32_bf16 v[72:75], v[92:95], v[108:111], v[72:75]
    s_mov_b32 s91, 995328
    buffer_store_dwordx4 a[28:31], v245, s[60:63], s91 offen sc1
    v_mfma_f32_16x16x32_bf16 v[68:71], v[92:95], v[104:107], v[68:71]
    v_mfma_f32_16x16x32_bf16 v[64:67], v[92:95], v[100:103], v[64:67]
    v_mfma_f32_16x16x32_bf16 v[60:63], v[92:95], v[96:99], v[60:63]
    s_waitcnt lgkmcnt(10)
    v_mfma_f32_16x16x32_bf16 v[76:79], v[80:83], v[108:111], v[76:79]
    ds_read_b128 v[92:95], v14 offset:3584
    v_mfma_f32_16x16x32_bf16 v[72:75], v[80:83], v[104:107], v[72:75]
    v_mfma_f32_16x16x32_bf16 v[68:71], v[80:83], v[100:103], v[68:71]
    v_mfma_f32_16x16x32_bf16 v[64:67], v[80:83], v[96:99], v[64:67]
    s_waitcnt lgkmcnt(4)
    v_mfma_f32_16x16x32_bf16 v[76:79], v[84:87], v[104:107], v[76:79]
    ds_read_b128 v[80:83], v14 offset:64
    v_mfma_f32_16x16x32_bf16 v[72:75], v[84:87], v[100:103], v[72:75]
    v_mfma_f32_16x16x32_bf16 v[68:71], v[84:87], v[96:99], v[68:71]
    s_waitcnt lgkmcnt(2)
    v_mfma_f32_16x16x32_bf16 v[76:79], v[88:91], v[100:103], v[76:79]
    ds_read_b128 v[84:87], v14 offset:576
    v_mfma_f32_16x16x32_bf16 v[72:75], v[88:91], v[96:99], v[72:75]
    s_waitcnt lgkmcnt(2)
    v_mfma_f32_16x16x32_bf16 v[76:79], v[92:95], v[96:99], v[76:79]
    ds_read_b128 v[88:91], v14 offset:1088
    s_waitcnt lgkmcnt(2)
    v_mfma_f32_16x16x32_bf16 v[76:79], v[80:83], v[156:159], v[76:79]
    ds_read_b128 v[92:95], v14 offset:1600
    v_mfma_f32_16x16x32_bf16 v[72:75], v[80:83], v[152:155], v[72:75]
    v_mfma_f32_16x16x32_bf16 v[68:71], v[80:83], v[148:151], v[68:71]
    v_mfma_f32_16x16x32_bf16 v[64:67], v[80:83], v[144:147], v[64:67]
    v_mfma_f32_16x16x32_bf16 v[60:63], v[80:83], v[140:143], v[60:63]
    v_mfma_f32_16x16x32_bf16 v[56:59], v[80:83], v[136:139], v[56:59]
    v_mfma_f32_16x16x32_bf16 v[52:55], v[80:83], v[132:135], v[52:55]
    v_mfma_f32_16x16x32_bf16 v[48:51], v[80:83], v[128:131], v[48:51]
    s_waitcnt lgkmcnt(2)
    v_mfma_f32_16x16x32_bf16 v[76:79], v[84:87], v[152:155], v[76:79]
    ds_read_b128 v[80:83], v14 offset:2112
    v_mfma_f32_16x16x32_bf16 v[72:75], v[84:87], v[148:151], v[72:75]
    v_mfma_f32_16x16x32_bf16 v[68:71], v[84:87], v[144:147], v[68:71]
    v_mfma_f32_16x16x32_bf16 v[64:67], v[84:87], v[140:143], v[64:67]
    v_mfma_f32_16x16x32_bf16 v[60:63], v[84:87], v[136:139], v[60:63]
    v_mfma_f32_16x16x32_bf16 v[56:59], v[84:87], v[132:135], v[56:59]
    v_mfma_f32_16x16x32_bf16 v[52:55], v[84:87], v[128:131], v[52:55]
    s_waitcnt lgkmcnt(2)
    v_mfma_f32_16x16x32_bf16 v[76:79], v[88:91], v[148:151], v[76:79]
    ds_read_b128 v[84:87], v14 offset:2624
    v_mfma_f32_16x16x32_bf16 v[72:75], v[88:91], v[144:147], v[72:75]
    v_mfma_f32_16x16x32_bf16 v[68:71], v[88:91], v[140:143], v[68:71]
    v_mfma_f32_16x16x32_bf16 v[64:67], v[88:91], v[136:139], v[64:67]
    v_mfma_f32_16x16x32_bf16 v[60:63], v[88:91], v[132:135], v[60:63]
    v_mfma_f32_16x16x32_bf16 v[56:59], v[88:91], v[128:131], v[56:59]
    s_waitcnt lgkmcnt(2)
    v_mfma_f32_16x16x32_bf16 v[76:79], v[92:95], v[144:147], v[76:79]
    ds_read_b128 v[88:91], v14 offset:3136
    v_mfma_f32_16x16x32_bf16 v[72:75], v[92:95], v[140:143], v[72:75]
    v_mfma_f32_16x16x32_bf16 v[68:71], v[92:95], v[136:139], v[68:71]
    v_mfma_f32_16x16x32_bf16 v[64:67], v[92:95], v[132:135], v[64:67]
    v_mfma_f32_16x16x32_bf16 v[60:63], v[92:95], v[128:131], v[60:63]
    s_waitcnt lgkmcnt(2)
    v_mfma_f32_16x16x32_bf16 v[76:79], v[80:83], v[140:143], v[76:79]
    ds_read_b128 v[92:95], v14 offset:3648
    v_mfma_f32_16x16x32_bf16 v[72:75], v[80:83], v[136:139], v[72:75]
    v_mfma_f32_16x16x32_bf16 v[68:71], v[80:83], v[132:135], v[68:71]
    v_mfma_f32_16x16x32_bf16 v[64:67], v[80:83], v[128:131], v[64:67]
    s_waitcnt lgkmcnt(2)
    v_mfma_f32_16x16x32_bf16 v[76:79], v[84:87], v[136:139], v[76:79]
    v_mfma_f32_16x16x32_bf16 v[72:75], v[84:87], v[132:135], v[72:75]
    v_mfma_f32_16x16x32_bf16 v[68:71], v[84:87], v[128:131], v[68:71]
    s_waitcnt lgkmcnt(1)
    v_mfma_f32_16x16x32_bf16 v[76:79], v[88:91], v[132:135], v[76:79]
    v_mfma_f32_16x16x32_bf16 v[72:75], v[88:91], v[128:131], v[72:75]
    s_waitcnt lgkmcnt(0)
    v_mfma_f32_16x16x32_bf16 v[76:79], v[92:95], v[128:131], v[76:79]
    s_lshl_b32 s99, s3, 13
    s_add_u32 s99, s99, s8
    v_add_u32 v20, s99, v2
    v_lshlrev_b32 v22, 3, v16
    v_add_u32 v22, v22, v17
    s_mul_i32 s99, s3, 1024
    s_sub_u32 s99, s9, s99
    s_add_u32 s99, s99, 3576
    v_sub_u32 v15, s99, v22
    s_mul_i32 s99, s3, 2048
    s_add_u32 s99, s99, s8
    v_add_u32 v21, s99, v2
    v_add_u32 v22, s99, v22
    s_barrier
    ds_write_b128 v20, v[48:51] offset:0
    ds_write_b128 v20, v[52:55] offset:1024
    ds_write_b128 v20, v[56:59] offset:2048
    ds_write_b128 v20, v[60:63] offset:3072
    ds_write_b128 v20, v[64:67] offset:4096
    ds_write_b128 v20, v[68:71] offset:5120
    ds_write_b128 v20, v[72:75] offset:6144
    ds_write_b128 v20, v[76:79] offset:7168
    ds_read_b64 v[80:81], v15 offset:512
    ds_read_b64 v[82:83], v15 offset:0
    s_waitcnt lgkmcnt(0)
    s_barrier
    ds_read_b128 v[48:51], v21 offset:0
    ds_read_b128 v[52:55], v21 offset:1024
    ds_read_b128 v[56:59], v21 offset:8192
    ds_read_b128 v[60:63], v21 offset:9216
    ds_read_b128 v[64:67], v21 offset:16384
    ds_read_b128 v[68:71], v21 offset:17408
    ds_read_b128 v[72:75], v21 offset:24576
    ds_read_b128 v[76:79], v21 offset:25600
    v_lshlrev_b32 v23, 16, v23
    v_and_b32 v96, 0xffff0000, v81
    v_lshlrev_b32 v97, 16, v81
    v_and_b32 v98, 0xffff0000, v80
    v_lshlrev_b32 v99, 16, v80
    v_and_b32 v100, 0xffff0000, v83
    v_lshlrev_b32 v101, 16, v83
    v_and_b32 v102, 0xffff0000, v82
    v_lshlrev_b32 v103, 16, v82
    s_waitcnt lgkmcnt(0)
    v_fmac_f32 v48, v96, v23
    v_fmac_f32 v49, v97, v23
    v_fmac_f32 v50, v98, v23
    v_fmac_f32 v51, v99, v23
    v_add_f32 v48, v48, v56
    v_add_f32 v49, v49, v57
    v_add_f32 v50, v50, v58
    v_add_f32 v51, v51, v59
    v_add_f32 v48, v48, v64
    v_add_f32 v49, v49, v65
    v_add_f32 v50, v50, v66
    v_add_f32 v51, v51, v67
    v_add_f32 v48, v48, v72
    v_add_f32 v49, v49, v73
    v_add_f32 v50, v50, v74
    v_add_f32 v51, v51, v75
    v_cvt_pk_bf16_f32 v128, v48, v49
    v_cvt_pk_bf16_f32 v129, v50, v51
    ds_write_b64 v22, v[128:129] offset:0
    v_fmac_f32 v52, v100, v23
    v_fmac_f32 v53, v101, v23
    v_fmac_f32 v54, v102, v23
    v_fmac_f32 v55, v103, v23
    v_add_f32 v52, v52, v60
    v_add_f32 v53, v53, v61
    v_add_f32 v54, v54, v62
    v_add_f32 v55, v55, v63
    v_add_f32 v52, v52, v68
    v_add_f32 v53, v53, v69
    v_add_f32 v54, v54, v70
    v_add_f32 v55, v55, v71
    v_add_f32 v52, v52, v76
    v_add_f32 v53, v53, v77
    v_add_f32 v54, v54, v78
    v_add_f32 v55, v55, v79
    v_cvt_pk_bf16_f32 v130, v52, v53
    v_cvt_pk_bf16_f32 v131, v54, v55
    ds_write_b64 v22, v[130:131] offset:512
    ds_read_b128 v[136:139], v21 offset:0
    s_waitcnt vmcnt(8)
    s_waitcnt lgkmcnt(0)
    buffer_store_dwordx4 v[136:139], v2, s[56:59], s11 offen offset:0 sc1
    v_mov_b32 v128, 0
    v_mov_b32 v129, 0
    v_mov_b32 v130, 0
    v_mov_b32 v131, 0
    v_min_u32 v20, 464, v2
    v_add_u32 v20, s0, v20
    v_and_b32 v21, 7, v1
    v_mul_u32_u24 v14, 4160, v21
    v_add_u32 v14, s1, v14
    ds_write_b128 v20, v[128:131] offset:4096
    ds_write_b128 v14, v[128:131]
    s_lshl_b32 s99, s96, 10
    s_add_u32 s99, s99, s1
    v_add_u32 v20, s99, v2
    ds_write_b128 v20, v[30:33] offset:12496
    ds_write_b128 v20, v[32:35] offset:29136
    v_mov_b32 v132, v29
    v_mov_b32 v133, v30
    v_mov_b32 v134, v31
    v_mov_b32 v135, v32
    v_mov_b32 v136, v33
    v_mov_b32 v137, v34
    v_alignbit_b32 v138, v29, v28, 16
    v_alignbit_b32 v139, v30, v29, 16
    v_alignbit_b32 v140, v31, v30, 16
    v_alignbit_b32 v141, v32, v31, 16
    v_alignbit_b32 v142, v33, v32, 16
    v_alignbit_b32 v143, v34, v33, 16
    v_alignbit_b32 v144, v35, v34, 16
    v_alignbit_b32 v146, v30, v29, 16
    v_alignbit_b32 v147, v31, v30, 16
    v_alignbit_b32 v148, v32, v31, 16
    v_alignbit_b32 v149, v33, v32, 16
    v_alignbit_b32 v150, v34, v33, 16
    v_alignbit_b32 v151, v35, v34, 16
    ds_write_b128 v20, v[138:141] offset:16
    ds_write_b128 v20, v[132:135] offset:4176
    ds_write_b128 v20, v[146:149] offset:8336
    ds_write_b128 v20, v[140:143] offset:16656
    ds_write_b128 v20, v[134:137] offset:20816
    ds_write_b128 v20, v[148:151] offset:24976
    ds_write_b128 v20, v[38:41] offset:14544
    ds_write_b128 v20, v[40:43] offset:31184
    v_mov_b32 v96, v37
    v_mov_b32 v97, v38
    v_mov_b32 v98, v39
    v_mov_b32 v99, v40
    v_mov_b32 v100, v41
    v_mov_b32 v101, v42
    v_alignbit_b32 v102, v37, v36, 16
    v_alignbit_b32 v103, v38, v37, 16
    v_alignbit_b32 v104, v39, v38, 16
    v_alignbit_b32 v105, v40, v39, 16
    v_alignbit_b32 v106, v41, v40, 16
    v_alignbit_b32 v107, v42, v41, 16
    v_alignbit_b32 v108, v43, v42, 16
    v_alignbit_b32 v110, v38, v37, 16
    v_alignbit_b32 v111, v39, v38, 16
    v_alignbit_b32 v112, v40, v39, 16
    v_alignbit_b32 v113, v41, v40, 16
    v_alignbit_b32 v114, v42, v41, 16
    v_alignbit_b32 v115, v43, v42, 16
    ds_write_b128 v20, v[102:105] offset:2064
    ds_write_b128 v20, v[96:99] offset:6224
    ds_write_b128 v20, v[110:113] offset:10384
    ds_write_b128 v20, v[104:107] offset:18704
    ds_write_b128 v20, v[98:101] offset:22864
    ds_write_b128 v20, v[112:115] offset:27024
    s_waitcnt lgkmcnt(0)
k3_fj:
    s_nop 4
    v_lshrrev_b32 v20, 2, v1
    v_and_b32 v21, 6, v20
    v_bfe_u32 v22, v1, 1, 1
    v_xor_b32 v21, v21, v22
    v_lshlrev_b32 v21, 4, v21
    v_lshl_add_u32 v21, v20, 7, v21
    v_and_b32 v22, 1, v1
    v_lshl_add_u32 v8, v22, 3, v21
    v_and_b32 v9, 0x400, v8
    v_mul_u32_u24 v9, 3, v9
    s_lshl_b32 s47, s3, 10
    s_add_u32 s47, s47, 53248
    v_add3_u32 v8, v8, v9, s47
    v_xor_b32 v9, 0, v8
    ds_read_b64_tr_b16 a[0:1], v9
    ds_read_b64_tr_b16 a[2:3], v9 offset:8192
    v_xor_b32 v9, 32, v8
    ds_read_b64_tr_b16 a[4:5], v9
    ds_read_b64_tr_b16 a[6:7], v9 offset:8192
    v_xor_b32 v9, 64, v8
    ds_read_b64_tr_b16 a[8:9], v9
    ds_read_b64_tr_b16 a[10:11], v9 offset:8192
    v_xor_b32 v9, 96, v8
    ds_read_b64_tr_b16 a[12:13], v9
    ds_read_b64_tr_b16 a[14:15], v9 offset:8192
    s_lshl_b32 s13, s5, 2
    s_add_u32 s13, s13, s3
    s_mul_i32 s15, s13, 57
    s_lshr_b32 s15, s15, 9
    s_mul_i32 s46, s15, 9
    s_sub_u32 s46, s13, s46
    s_sub_u32 s47, s46, s4
    s_sub_u32 s47, s47, 1
    s_and_b32 s47, s47, 7
    s_add_u32 s47, s47, 10
    s_cmp_lt_u32 s46, 8
    s_cselect_b32 s47, s47, 9
    s_mul_i32 s46, s4, 72
    s_add_u32 s47, s47, s46
    s_mul_i32 s47, s47, 18432
    s_lshl_b32 s15, s15, 10
    s_add_u32 s47, s47, s15
    s_cmp_lt_u32 s13, 162
    s_cselect_b32 s47, s47, 0x40000000
    v_add_u32 v244, s47, v2
    v_and_b32 v25, 31, v1
    v_lshlrev_b32 v25, 2, v25
    s_lshl_b32 s94, s4, 7
    s_add_u32 s94, s94, 25600
    buffer_load_dword v26, v25, s[68:71], s94 offen sc1
    s_mul_i32 s99, s96, 256
    v_and_b32 v20, 8, v1
    v_lshl_add_u32 v14, v20, 1, v14
    v_lshrrev_b32 v16, 4, v1
    v_lshl_add_u32 v14, v16, 4, v14
    v_add_u32 v14, s99, v14
    v_and_b32 v17, 15, v1
    v_lshlrev_b32 v17, 5, v17
    v_lshlrev_b32 v15, 4, v16
    v_sub_u32 v15, v15, v17
    s_add_u32 s99, s99, s0
    s_add_u32 s99, s99, 480
    v_add_u32 v15, s99, v15
    s_waitcnt lgkmcnt(0)
    s_barrier
    ds_read_b128 v[80:83], v14 offset:0
    ds_read_b128 v[124:127], v15 offset:0
    ds_read_b128 v[120:123], v15 offset:512
    ds_read_b128 v[116:119], v15 offset:1024
    ds_read_b128 v[112:115], v15 offset:1536
    ds_read_b128 v[108:111], v15 offset:2048
    ds_read_b128 v[104:107], v15 offset:2560
    ds_read_b128 v[100:103], v15 offset:3072
    ds_read_b128 v[96:99], v15 offset:3584
    ds_read_b128 v[84:87], v14 offset:512
    ds_read_b128 v[88:91], v14 offset:1024
    ds_read_b128 v[92:95], v14 offset:1536
    s_waitcnt lgkmcnt(10)
    v_mfma_f32_16x16x32_bf16 v[76:79], v[80:83], v[124:127], 0
    s_add_u32 s52, s44, 10485760
    s_addc_u32 s53, s45, 0
    s_mov_b32 s54, 10616832
    s_waitcnt lgkmcnt(9)
    v_mfma_f32_16x16x32_bf16 v[72:75], v[80:83], v[120:123], 0
    s_mov_b32 s55, 0x20000
    s_lshl_b32 s8, s4, 2
    s_waitcnt lgkmcnt(8)
    v_mfma_f32_16x16x32_bf16 v[68:71], v[80:83], v[116:119], 0
    s_add_u32 s8, s8, s3
    s_mul_i32 s8, s8, 331776
    s_waitcnt lgkmcnt(7)
    v_mfma_f32_16x16x32_bf16 v[64:67], v[80:83], v[112:115], 0
    v_add_u32 v3, 18432, v2
    v_add_u32 v0, 147456, v2
    s_waitcnt lgkmcnt(6)
    v_mfma_f32_16x16x32_bf16 v[60:63], v[80:83], v[108:111], 0
    s_add_u32 s48, s44, 2621440
    s_addc_u32 s49, s45, 0
    s_mov_b32 s50, 2359296
    s_waitcnt lgkmcnt(5)
    v_mfma_f32_16x16x32_bf16 v[56:59], v[80:83], v[104:107], 0
    s_mov_b32 s51, 0x20000
    s_mul_i32 s6, s5, 73728
    s_waitcnt lgkmcnt(4)
    v_mfma_f32_16x16x32_bf16 v[52:55], v[80:83], v[100:103], 0
    s_lshl_b32 s7, s3, 10
    s_add_u32 s6, s6, s7
    s_waitcnt lgkmcnt(3)
    v_mfma_f32_16x16x32_bf16 v[48:51], v[80:83], v[96:99], 0
    s_movk_i32 s9, 0x1000
    s_mov_b32 m0, s7
    s_waitcnt lgkmcnt(2)
    v_mfma_f32_16x16x32_bf16 v[76:79], v[84:87], v[120:123], v[76:79]
    ds_read_b128 v[80:83], v14 offset:2048
    s_add_u32 s60, s44, 9699328
    s_addc_u32 s61, s45, 0
    s_mov_b32 s62, 196608
    v_mfma_f32_16x16x32_bf16 v[72:75], v[84:87], v[116:119], v[72:75]
    ds_read_b128 v[156:159], v15 offset:64
    s_mov_b32 s63, 0x20000
    s_add_u32 s64, s44, 10289152
    s_addc_u32 s65, s45, 0
    v_mfma_f32_16x16x32_bf16 v[68:71], v[84:87], v[112:115], v[68:71]
    ds_read_b128 v[152:155], v15 offset:576
    s_mov_b32 s66, 110592
    s_mov_b32 s67, 0x20000
    v_mfma_f32_16x16x32_bf16 v[64:67], v[84:87], v[108:111], v[64:67]
    ds_read_b128 v[148:151], v15 offset:1088
    s_add_u32 s56, s44, 22020096
    s_addc_u32 s57, s45, 0
    s_mov_b32 s58, 18874368
    v_mfma_f32_16x16x32_bf16 v[60:63], v[84:87], v[104:107], v[60:63]
    ds_read_b128 v[144:147], v15 offset:1600
    s_mov_b32 s59, 0x20000
    s_mov_b32 s20, s16
    v_mfma_f32_16x16x32_bf16 v[56:59], v[84:87], v[100:103], v[56:59]
    ds_read_b128 v[140:143], v15 offset:2112
    s_mov_b32 s21, s17
    s_mov_b32 s22, 2359296
    v_mfma_f32_16x16x32_bf16 v[52:55], v[84:87], v[96:99], v[52:55]
    ds_read_b128 v[136:139], v15 offset:2624
    s_mov_b32 s23, 0x20000
    s_add_u32 s24, s44, 7340032
    s_addc_u32 s25, s45, 0
    s_waitcnt lgkmcnt(8)
    v_mfma_f32_16x16x32_bf16 v[76:79], v[88:91], v[116:119], v[76:79]
    ds_read_b128 v[84:87], v14 offset:2560
    s_mov_b32 s26, 2359296
    s_mov_b32 s27, 0x20000
    v_mfma_f32_16x16x32_bf16 v[72:75], v[88:91], v[112:115], v[72:75]
    ds_read_b128 v[132:135], v15 offset:3136
    s_mov_b32 s28, s40
    s_mov_b32 s29, s41
    v_mfma_f32_16x16x32_bf16 v[68:71], v[88:91], v[108:111], v[68:71]
    ds_read_b128 v[128:131], v15 offset:3648
    s_mov_b32 s30, 2359296
    s_mov_b32 s31, 0x20000
    v_mfma_f32_16x16x32_bf16 v[64:67], v[88:91], v[104:107], v[64:67]
    v_lshrrev_b32 v11, 4, v1
    v_lshlrev_b32 v11, 4, v11
    v_mfma_f32_16x16x32_bf16 v[60:63], v[88:91], v[100:103], v[60:63]
    s_add_u32 s12, s7, 152576
    v_add_u32 v11, s12, v11
    v_mfma_f32_16x16x32_bf16 v[56:59], v[88:91], v[96:99], v[56:59]
    v_add_u32 v5, s12, v2
    v_lshrrev_b32 v4, 3, v1
    s_waitcnt lgkmcnt(10)
    v_mfma_f32_16x16x32_bf16 v[76:79], v[92:95], v[112:115], v[76:79]
    ds_read_b128 v[88:91], v14 offset:3072
    v_lshlrev_b32 v4, 9, v4
    v_and_b32 v28, 7, v1
    v_mfma_f32_16x16x32_bf16 v[72:75], v[92:95], v[108:111], v[72:75]
    v_lshl_add_u32 v4, v28, 4, v4
    s_lshl_b32 s13, s3, 6
    v_mfma_f32_16x16x32_bf16 v[68:71], v[92:95], v[104:107], v[68:71]
    v_mov_b32 v28, s13
    v_cmp_gt_u32 vcc, 32, v1
    s_nop 1
    v_cndmask_b32 v28, 0, v28, vcc
    v_mfma_f32_16x16x32_bf16 v[64:67], v[92:95], v[100:103], v[64:67]
    v_add3_u32 v4, v4, v28, s13
    s_mul_i32 s13, s4, 2304
    v_mfma_f32_16x16x32_bf16 v[60:63], v[92:95], v[96:99], v[60:63]
    v_add_u32 v7, 0x10000, v2
    v_add_u32 v8, 0x20000, v2
    s_waitcnt lgkmcnt(10)
    v_mfma_f32_16x16x32_bf16 v[76:79], v[80:83], v[108:111], v[76:79]
    ds_read_b128 v[92:95], v14 offset:3584
    s_lshl_b32 s10, s3, 12
    s_add_u32 s15, s10, 73728
    v_mfma_f32_16x16x32_bf16 v[72:75], v[80:83], v[104:107], v[72:75]
    v_add_u32 v9, s15, v2
    s_lshr_b32 s15, s3, 1
    v_mfma_f32_16x16x32_bf16 v[68:71], v[80:83], v[100:103], v[68:71]
    s_lshl_b32 s15, s15, 12
    s_and_b32 s46, s3, 1
    v_mfma_f32_16x16x32_bf16 v[64:67], v[80:83], v[96:99], v[64:67]
    s_lshl_b32 s46, s46, 3
    s_add_u32 s18, s15, s46
    s_waitcnt lgkmcnt(4)
    v_mfma_f32_16x16x32_bf16 v[76:79], v[84:87], v[104:107], v[76:79]
    ds_read_b128 v[80:83], v14 offset:64
    s_add_u32 s15, s18, 139264
    v_add_u32 v10, s15, v2
    v_mfma_f32_16x16x32_bf16 v[72:75], v[84:87], v[100:103], v[72:75]
    s_mul_i32 s19, s5, 73728
    s_lshl_b32 s46, s3, 11
    v_mfma_f32_16x16x32_bf16 v[68:71], v[84:87], v[96:99], v[68:71]
    s_add_u32 s19, s19, s46
    s_mul_i32 s15, s4, 2359296
    s_waitcnt lgkmcnt(2)
    v_mfma_f32_16x16x32_bf16 v[76:79], v[88:91], v[100:103], v[76:79]
    ds_read_b128 v[84:87], v14 offset:576
    s_add_u32 s15, s15, s19
    s_add_u32 s32, s15, 0x10000
    v_mfma_f32_16x16x32_bf16 v[72:75], v[88:91], v[96:99], v[72:75]
    s_add_u32 s46, s4, 1
    s_and_b32 s46, s46, 7
    s_waitcnt lgkmcnt(2)
    v_mfma_f32_16x16x32_bf16 v[76:79], v[92:95], v[96:99], v[76:79]
    ds_read_b128 v[88:91], v14 offset:1088
    s_lshl_b32 s46, s46, 13
    s_add_u32 s33, s15, s46
    s_waitcnt lgkmcnt(2)
    v_mfma_f32_16x16x32_bf16 v[76:79], v[80:83], v[156:159], v[76:79]
    ds_read_b128 v[92:95], v14 offset:1600
    s_add_u32 s46, s4, 2
    s_and_b32 s46, s46, 7
    v_mfma_f32_16x16x32_bf16 v[72:75], v[80:83], v[152:155], v[72:75]
    s_lshl_b32 s46, s46, 13
    s_add_u32 s34, s15, s46
    v_mfma_f32_16x16x32_bf16 v[68:71], v[80:83], v[148:151], v[68:71]
    s_add_u32 s46, s4, 3
    s_and_b32 s46, s46, 7
    v_mfma_f32_16x16x32_bf16 v[64:67], v[80:83], v[144:147], v[64:67]
    s_lshl_b32 s46, s46, 13
    s_add_u32 s35, s15, s46
    v_mfma_f32_16x16x32_bf16 v[60:63], v[80:83], v[140:143], v[60:63]
    s_add_u32 s46, s4, 4
    s_and_b32 s46, s46, 7
    v_mfma_f32_16x16x32_bf16 v[56:59], v[80:83], v[136:139], v[56:59]
    s_lshl_b32 s46, s46, 13
    s_add_u32 s36, s15, s46
    v_mfma_f32_16x16x32_bf16 v[52:55], v[80:83], v[132:135], v[52:55]
    s_add_u32 s46, s4, 5
    s_and_b32 s46, s46, 7
    v_mfma_f32_16x16x32_bf16 v[48:51], v[80:83], v[128:131], v[48:51]
    s_lshl_b32 s46, s46, 13
    s_add_u32 s37, s15, s46
    s_waitcnt lgkmcnt(2)
    v_mfma_f32_16x16x32_bf16 v[76:79], v[84:87], v[152:155], v[76:79]
    ds_read_b128 v[80:83], v14 offset:2112
    s_add_u32 s46, s4, 6
    s_and_b32 s46, s46, 7
    v_mfma_f32_16x16x32_bf16 v[72:75], v[84:87], v[148:151], v[72:75]
    ds_read_b128 v[124:127], v15 offset:128
    s_lshl_b32 s46, s46, 13
    s_add_u32 s38, s15, s46
    v_mfma_f32_16x16x32_bf16 v[68:71], v[84:87], v[144:147], v[68:71]
    ds_read_b128 v[120:123], v15 offset:640
    s_add_u32 s46, s4, 7
    s_and_b32 s46, s46, 7
    v_mfma_f32_16x16x32_bf16 v[64:67], v[84:87], v[140:143], v[64:67]
    ds_read_b128 v[116:119], v15 offset:1152
    s_lshl_b32 s46, s46, 13
    s_add_u32 s39, s15, s46
    v_mfma_f32_16x16x32_bf16 v[60:63], v[84:87], v[136:139], v[60:63]
    ds_read_b128 v[112:115], v15 offset:1664
    s_lshl_b32 s42, s5, 2
    s_add_u32 s42, s42, s3
    v_mfma_f32_16x16x32_bf16 v[56:59], v[84:87], v[132:135], v[56:59]
    ds_read_b128 v[108:111], v15 offset:2176
    s_lshl_b32 s42, s42, 7
    s_lshl_b32 s43, s4, 2
    v_mfma_f32_16x16x32_bf16 v[52:55], v[84:87], v[128:131], v[52:55]
    ds_read_b128 v[104:107], v15 offset:2688
    s_add_u32 s43, s43, s42
    s_lshl_b32 s10, s5, 10
    s_waitcnt lgkmcnt(8)
    v_mfma_f32_16x16x32_bf16 v[76:79], v[88:91], v[148:151], v[76:79]
    ds_read_b128 v[84:87], v14 offset:2624
    s_lshl_b32 s47, s3, 8
    s_add_u32 s10, s10, s47
    v_mfma_f32_16x16x32_bf16 v[72:75], v[88:91], v[144:147], v[72:75]
    ds_read_b128 v[100:103], v15 offset:3200
    v_and_b32 v6, 15, v1
    v_lshlrev_b32 v6, 4, v6
    v_mfma_f32_16x16x32_bf16 v[68:71], v[88:91], v[140:143], v[68:71]
    ds_read_b128 v[96:99], v15 offset:3712
    v_lshrrev_b32 v232, 4, v1
    v_lshl_add_u32 v232, v232, 15, v6
    v_mfma_f32_16x16x32_bf16 v[64:67], v[88:91], v[136:139], v[64:67]
    v_add_u32 v233, 0x20000, v232
    s_add_u32 s47, s47, 147456
    v_mfma_f32_16x16x32_bf16 v[60:63], v[88:91], v[132:135], v[60:63]
    v_mfma_f32_16x16x32_bf16 v[56:59], v[88:91], v[128:131], v[56:59]
    s_waitcnt lgkmcnt(10)
    v_mfma_f32_16x16x32_bf16 v[76:79], v[92:95], v[144:147], v[76:79]
    ds_read_b128 v[88:91], v14 offset:3136
    v_mfma_f32_16x16x32_bf16 v[72:75], v[92:95], v[140:143], v[72:75]
    v_mfma_f32_16x16x32_bf16 v[68:71], v[92:95], v[136:139], v[68:71]
    s_waitcnt vmcnt(0)
    v_lshlrev_b32 v24, 20, v1
    v_mov_b32 v23, s90
    buffer_store_dword v23, v24, s[68:71], s92 offen sc1
    v_subrev_u32 v26, s90, v26
    v_cmp_lt_u32 vcc, 0, v26
    s_mov_b32 s91, 20000
    s_nop 0
    s_cbranch_vccz ck5
cr5:
    s_sleep 2
    buffer_load_dword v26, v25, s[68:71], s94 offen sc1
    s_sub_u32 s91, s91, 1
    s_waitcnt vmcnt(0)
    v_subrev_u32 v26, s90, v26
    v_cmp_lt_u32 vcc, 0, v26
    s_cbranch_scc1 ck5
    s_nop 0
    s_cbranch_vccnz cr5
ck5:
    s_mov_b32 s91, 0
    buffer_store_dwordx4 a[0:3], v244, s[52:55], s91 offen sc1
    v_mfma_f32_16x16x32_bf16 v[64:67], v[92:95], v[132:135], v[64:67]
    v_mfma_f32_16x16x32_bf16 v[60:63], v[92:95], v[128:131], v[60:63]
    s_waitcnt lgkmcnt(10)
    v_mfma_f32_16x16x32_bf16 v[76:79], v[80:83], v[140:143], v[76:79]
    ds_read_b128 v[92:95], v14 offset:3648
    v_mfma_f32_16x16x32_bf16 v[72:75], v[80:83], v[136:139], v[72:75]
    s_mov_b32 s91, 331776
    buffer_store_dwordx4 a[4:7], v244, s[52:55], s91 offen sc1
    v_mfma_f32_16x16x32_bf16 v[68:71], v[80:83], v[132:135], v[68:71]
    v_mfma_f32_16x16x32_bf16 v[64:67], v[80:83], v[128:131], v[64:67]
    s_waitcnt lgkmcnt(4)
    v_mfma_f32_16x16x32_bf16 v[76:79], v[84:87], v[136:139], v[76:79]
    ds_read_b128 v[80:83], v14 offset:128
    v_mfma_f32_16x16x32_bf16 v[72:75], v[84:87], v[132:135], v[72:75]
    s_mov_b32 s91, 663552
    buffer_store_dwordx4 a[8:11], v244, s[52:55], s91 offen sc1
    v_mfma_f32_16x16x32_bf16 v[68:71], v[84:87], v[128:131], v[68:71]
    s_waitcnt lgkmcnt(2)
    v_mfma_f32_16x16x32_bf16 v[76:79], v[88:91], v[132:135], v[76:79]
    ds_read_b128 v[84:87], v14 offset:640
    v_mfma_f32_16x16x32_bf16 v[72:75], v[88:91], v[128:131], v[72:75]
    s_waitcnt lgkmcnt(2)
    v_mfma_f32_16x16x32_bf16 v[76:79], v[92:95], v[128:131], v[76:79]
    ds_read_b128 v[88:91], v14 offset:1152
    s_mov_b32 s91, 995328
    buffer_store_dwordx4 a[12:15], v244, s[52:55], s91 offen sc1
    s_waitcnt lgkmcnt(2)
    v_mfma_f32_16x16x32_bf16 v[76:79], v[80:83], v[124:127], v[76:79]
    ds_read_b128 v[92:95], v14 offset:1664
    v_mfma_f32_16x16x32_bf16 v[72:75], v[80:83], v[120:123], v[72:75]
    v_mfma_f32_16x16x32_bf16 v[68:71], v[80:83], v[116:119], v[68:71]
    v_mfma_f32_16x16x32_bf16 v[64:67], v[80:83], v[112:115], v[64:67]
    s_add_u32 s11, s8, 0
    buffer_load_dwordx4 v[160:163], v2, s[52:55], s11 offen offset:0 sc1
    v_mfma_f32_16x16x32_bf16 v[60:63], v[80:83], v[108:111], v[60:63]
    v_mfma_f32_16x16x32_bf16 v[56:59], v[80:83], v[104:107], v[56:59]
    v_mfma_f32_16x16x32_bf16 v[52:55], v[80:83], v[100:103], v[52:55]
    v_mfma_f32_16x16x32_bf16 v[48:51], v[80:83], v[96:99], v[48:51]
    buffer_load_dwordx4 v[164:167], v3, s[52:55], s11 offen offset:0 sc1
    s_waitcnt lgkmcnt(2)
    v_mfma_f32_16x16x32_bf16 v[76:79], v[84:87], v[120:123], v[76:79]
    ds_read_b128 v[80:83], v14 offset:2176
    v_mfma_f32_16x16x32_bf16 v[72:75], v[84:87], v[116:119], v[72:75]
    ds_read_b128 v[156:159], v15 offset:192
    v_mfma_f32_16x16x32_bf16 v[68:71], v[84:87], v[112:115], v[68:71]
    ds_read_b128 v[152:155], v15 offset:704
    v_mfma_f32_16x16x32_bf16 v[64:67], v[84:87], v[108:111], v[64:67]
    ds_read_b128 v[148:151], v15 offset:1216
    buffer_load_dwordx4 v[168:171], v2, s[52:55], s11 offen offset:1024 sc1
    v_mfma_f32_16x16x32_bf16 v[60:63], v[84:87], v[104:107], v[60:63]
    ds_read_b128 v[144:147], v15 offset:1728
    v_mfma_f32_16x16x32_bf16 v[56:59], v[84:87], v[100:103], v[56:59]
    ds_read_b128 v[140:143], v15 offset:2240
    v_mfma_f32_16x16x32_bf16 v[52:55], v[84:87], v[96:99], v[52:55]
    ds_read_b128 v[136:139], v15 offset:2752
    s_waitcnt lgkmcnt(8)
    v_mfma_f32_16x16x32_bf16 v[76:79], v[88:91], v[116:119], v[76:79]
    ds_read_b128 v[84:87], v14 offset:2688
    buffer_load_dwordx4 v[172:175], v3, s[52:55], s11 offen offset:1024 sc1
    v_mfma_f32_16x16x32_bf16 v[72:75], v[88:91], v[112:115], v[72:75]
    ds_read_b128 v[132:135], v15 offset:3264
    v_mfma_f32_16x16x32_bf16 v[68:71], v[88:91], v[108:111], v[68:71]
    ds_read_b128 v[128:131], v15 offset:3776
    v_mfma_f32_16x16x32_bf16 v[64:67], v[88:91], v[104:107], v[64:67]
    v_mfma_f32_16x16x32_bf16 v[60:63], v[88:91], v[100:103], v[60:63]
    buffer_load_dwordx4 v[176:179], v2, s[52:55], s11 offen offset:2048 sc1
    v_mfma_f32_16x16x32_bf16 v[56:59], v[88:91], v[96:99], v[56:59]
    s_waitcnt lgkmcnt(10)
    v_mfma_f32_16x16x32_bf16 v[76:79], v[92:95], v[112:115], v[76:79]
    ds_read_b128 v[88:91], v14 offset:3200
    v_mfma_f32_16x16x32_bf16 v[72:75], v[92:95], v[108:111], v[72:75]
    v_mfma_f32_16x16x32_bf16 v[68:71], v[92:95], v[104:107], v[68:71]
    buffer_load_dwordx4 v[180:183], v3, s[52:55], s11 offen offset:2048 sc1
    v_mfma_f32_16x16x32_bf16 v[64:67], v[92:95], v[100:103], v[64:67]
    v_mfma_f32_16x16x32_bf16 v[60:63], v[92:95], v[96:99], v[60:63]
    s_waitcnt lgkmcnt(10)
    v_mfma_f32_16x16x32_bf16 v[76:79], v[80:83], v[108:111], v[76:79]
    ds_read_b128 v[92:95], v14 offset:3712
    v_mfma_f32_16x16x32_bf16 v[72:75], v[80:83], v[104:107], v[72:75]
    buffer_load_dwordx4 v[184:187], v2, s[52:55], s11 offen offset:3072 sc1
    v_mfma_f32_16x16x32_bf16 v[68:71], v[80:83], v[100:103], v[68:71]
    v_mfma_f32_16x16x32_bf16 v[64:67], v[80:83], v[96:99], v[64:67]
    s_waitcnt lgkmcnt(4)
    v_mfma_f32_16x16x32_bf16 v[76:79], v[84:87], v[104:107], v[76:79]
    ds_read_b128 v[80:83], v14 offset:192
    v_mfma_f32_16x16x32_bf16 v[72:75], v[84:87], v[100:103], v[72:75]
    buffer_load_dwordx4 v[188:191], v3, s[52:55], s11 offen offset:3072 sc1
    v_mfma_f32_16x16x32_bf16 v[68:71], v[84:87], v[96:99], v[68:71]
    s_waitcnt lgkmcnt(2)
    v_mfma_f32_16x16x32_bf16 v[76:79], v[88:91], v[100:103], v[76:79]
    ds_read_b128 v[84:87], v14 offset:704
    v_mfma_f32_16x16x32_bf16 v[72:75], v[88:91], v[96:99], v[72:75]
    s_waitcnt lgkmcnt(2)
    v_mfma_f32_16x16x32_bf16 v[76:79], v[92:95], v[96:99], v[76:79]
    ds_read_b128 v[88:91], v14 offset:1216
    s_add_u32 s11, s8, 4096
    buffer_load_dwordx4 v[192:195], v2, s[52:55], s11 offen offset:0 sc1
    s_waitcnt lgkmcnt(2)
    v_mfma_f32_16x16x32_bf16 v[76:79], v[80:83], v[156:159], v[76:79]
    ds_read_b128 v[92:95], v14 offset:1728
    v_mfma_f32_16x16x32_bf16 v[72:75], v[80:83], v[152:155], v[72:75]
    v_mfma_f32_16x16x32_bf16 v[68:71], v[80:83], v[148:151], v[68:71]
    v_mfma_f32_16x16x32_bf16 v[64:67], v[80:83], v[144:147], v[64:67]
    buffer_load_dwordx4 v[196:199], v3, s[52:55], s11 offen offset:0 sc1
    v_mfma_f32_16x16x32_bf16 v[60:63], v[80:83], v[140:143], v[60:63]
    v_mfma_f32_16x16x32_bf16 v[56:59], v[80:83], v[136:139], v[56:59]
    v_mfma_f32_16x16x32_bf16 v[52:55], v[80:83], v[132:135], v[52:55]
    v_mfma_f32_16x16x32_bf16 v[48:51], v[80:83], v[128:131], v[48:51]
    buffer_load_dwordx4 v[200:203], v2, s[52:55], s11 offen offset:1024 sc1
    s_waitcnt lgkmcnt(2)
    v_mfma_f32_16x16x32_bf16 v[76:79], v[84:87], v[152:155], v[76:79]
    ds_read_b128 v[80:83], v14 offset:2240
    v_mfma_f32_16x16x32_bf16 v[72:75], v[84:87], v[148:151], v[72:75]
    v_mfma_f32_16x16x32_bf16 v[68:71], v[84:87], v[144:147], v[68:71]
    v_mfma_f32_16x16x32_bf16 v[64:67], v[84:87], v[140:143], v[64:67]
    v_min_u32 v25, 5, v1
    v_lshlrev_b32 v25, 2, v25
    buffer_load_dword v26, v25, s[68:71], s42 offen offset:32 sc1
    buffer_load_dwordx4 v[204:207], v3, s[52:55], s11 offen offset:1024 sc1
    v_mfma_f32_16x16x32_bf16 v[60:63], v[84:87], v[136:139], v[60:63]
    v_mfma_f32_16x16x32_bf16 v[56:59], v[84:87], v[132:135], v[56:59]
    v_mfma_f32_16x16x32_bf16 v[52:55], v[84:87], v[128:131], v[52:55]
    s_waitcnt lgkmcnt(2)
    v_mfma_f32_16x16x32_bf16 v[76:79], v[88:91], v[148:151], v[76:79]
    ds_read_b128 v[84:87], v14 offset:2752
    buffer_load_dwordx4 v[208:211], v2, s[52:55], s11 offen offset:2048 sc1
    v_mfma_f32_16x16x32_bf16 v[72:75], v[88:91], v[144:147], v[72:75]
    v_mfma_f32_16x16x32_bf16 v[68:71], v[88:91], v[140:143], v[68:71]
    v_mfma_f32_16x16x32_bf16 v[64:67], v[88:91], v[136:139], v[64:67]
    v_mfma_f32_16x16x32_bf16 v[60:63], v[88:91], v[132:135], v[60:63]
    buffer_load_dwordx4 v[212:215], v3, s[52:55], s11 offen offset:2048 sc1
    v_mfma_f32_16x16x32_bf16 v[56:59], v[88:91], v[128:131], v[56:59]
    s_waitcnt lgkmcnt(2)
    v_mfma_f32_16x16x32_bf16 v[76:79], v[92:95], v[144:147], v[76:79]
    ds_read_b128 v[88:91], v14 offset:3264
    v_mfma_f32_16x16x32_bf16 v[72:75], v[92:95], v[140:143], v[72:75]
    v_mfma_f32_16x16x32_bf16 v[68:71], v[92:95], v[136:139], v[68:71]
    buffer_load_dwordx4 v[216:219], v2, s[52:55], s11 offen offset:3072 sc1
    v_mfma_f32_16x16x32_bf16 v[64:67], v[92:95], v[132:135], v[64:67]
    v_mfma_f32_16x16x32_bf16 v[60:63], v[92:95], v[128:131], v[60:63]
    s_waitcnt lgkmcnt(2)
    v_mfma_f32_16x16x32_bf16 v[76:79], v[80:83], v[140:143], v[76:79]
    ds_read_b128 v[92:95], v14 offset:3776
    v_mfma_f32_16x16x32_bf16 v[72:75], v[80:83], v[136:139], v[72:75]
    buffer_load_dwordx4 v[220:223], v3, s[52:55], s11 offen offset:3072 sc1
    v_mfma_f32_16x16x32_bf16 v[68:71], v[80:83], v[132:135], v[68:71]
    v_mfma_f32_16x16x32_bf16 v[64:67], v[80:83], v[128:131], v[64:67]
    s_waitcnt lgkmcnt(2)
    v_mfma_f32_16x16x32_bf16 v[76:79], v[84:87], v[136:139], v[76:79]
    v_mfma_f32_16x16x32_bf16 v[72:75], v[84:87], v[132:135], v[72:75]
    v_mfma_f32_16x16x32_bf16 v[68:71], v[84:87], v[128:131], v[68:71]
    s_waitcnt lgkmcnt(1)
    v_mfma_f32_16x16x32_bf16 v[76:79], v[88:91], v[132:135], v[76:79]
    v_mfma_f32_16x16x32_bf16 v[72:75], v[88:91], v[128:131], v[72:75]
    s_waitcnt lgkmcnt(0)
    v_mfma_f32_16x16x32_bf16 v[76:79], v[92:95], v[128:131], v[76:79]
    s_lshl_b32 s99, s96, 13
    s_add_u32 s99, s99, s1
    v_add_u32 v20, s99, v2
    v_lshlrev_b32 v22, 3, v16
    v_add_u32 v22, v22, v17
    s_mul_i32 s99, s96, 2048
    s_sub_u32 s99, s0, s99
    s_add_u32 s99, s99, 2552
    v_sub_u32 v15, s99, v22
    s_mul_i32 s99, s96, 4096
    s_add_u32 s99, s99, s1
    v_add_u32 v21, s99, v2
    v_add_u32 v22, s99, v22
    s_barrier
    ds_write_b128 v20, v[48:51] offset:0
    ds_write_b128 v20, v[52:55] offset:1024
    ds_write_b128 v20, v[56:59] offset:2048
    ds_write_b128 v20, v[60:63] offset:3072
    ds_write_b128 v20, v[64:67] offset:4096
    ds_write_b128 v20, v[68:71] offset:5120
    ds_write_b128 v20, v[72:75] offset:6144
    ds_write_b128 v20, v[76:79] offset:7168
    ds_read_b64 v[80:81], v15 offset:1536
    ds_read_b64 v[82:83], v15 offset:1024
    ds_read_b64 v[84:85], v15 offset:512
    ds_read_b64 v[86:87], v15 offset:0
    s_waitcnt vmcnt(5)
    v_subrev_u32 v26, s90, v26
    v_cmp_lt_u32 vcc, 0, v26
    s_mov_b32 s91, 20000
    s_nop 0
    s_cbranch_vccz ck6
cr6:
    s_sleep 1
    buffer_load_dword v26, v25, s[68:71], s42 offen offset:32 sc1
    s_sub_u32 s91, s91, 1
    s_waitcnt vmcnt(0)
    v_subrev_u32 v26, s90, v26
    v_cmp_lt_u32 vcc, 0, v26
    s_cbranch_scc1 ck6
    s_nop 0
    s_cbranch_vccnz cr6
ck6:
    buffer_load_dwordx4 v2, s[48:51], s6 offen sc1 lds
    s_add_u32 m0, m0, s9
    s_add_u32 s6, s6, s9
    buffer_load_dwordx4 v2, s[48:51], s6 offen sc1 lds
    s_add_u32 m0, m0, s9
    s_add_u32 s6, s6, s9
    buffer_load_dwordx4 v2, s[48:51], s6 offen sc1 lds
    buffer_load_dwordx3 v[224:226], v232, s[60:63], s10 offen sc1
    buffer_load_dwordx3 v[228:230], v233, s[60:63], s10 offen sc1
    s_add_u32 m0, m0, s9
    s_add_u32 s6, s6, s9
    buffer_load_dwordx4 v2, s[48:51], s6 offen sc1 lds
    s_add_u32 m0, m0, s9
    s_add_u32 s6, s6, s9
    buffer_load_dwordx4 v2, s[48:51], s6 offen sc1 lds
    s_add_u32 m0, m0, s9
    s_add_u32 s6, s6, s9
    buffer_load_dwordx4 v2, s[48:51], s6 offen sc1 lds
    s_waitcnt lgkmcnt(0)
    s_barrier
    ds_read_b128 v[48:51], v21 offset:0
    ds_read_b128 v[52:55], v21 offset:1024
    ds_read_b128 v[56:59], v21 offset:2048
    ds_read_b128 v[60:63], v21 offset:3072
    ds_read_b128 v[64:67], v21 offset:8192
    ds_read_b128 v[68:71], v21 offset:9216
    ds_read_b128 v[72:75], v21 offset:10240
    ds_read_b128 v[76:79], v21 offset:11264
    v_lshlrev_b32 v18, 16, v18
    v_and_b32 v96, 0xffff0000, v81
    v_lshlrev_b32 v97, 16, v81
    v_and_b32 v98, 0xffff0000, v80
    v_lshlrev_b32 v99, 16, v80
    v_and_b32 v100, 0xffff0000, v83
    v_lshlrev_b32 v101, 16, v83
    v_and_b32 v102, 0xffff0000, v82
    v_lshlrev_b32 v103, 16, v82
    v_and_b32 v104, 0xffff0000, v85
    v_lshlrev_b32 v105, 16, v85
    v_and_b32 v106, 0xffff0000, v84
    v_lshlrev_b32 v107, 16, v84
    v_and_b32 v108, 0xffff0000, v87
    v_lshlrev_b32 v109, 16, v87
    v_and_b32 v110, 0xffff0000, v86
    v_lshlrev_b32 v111, 16, v86
    s_waitcnt lgkmcnt(0)
    v_fmac_f32 v48, v96, v18
    v_fmac_f32 v49, v97, v18
    v_fmac_f32 v50, v98, v18
    v_fmac_f32 v51, v99, v18
    v_add_f32 v48, v48, v64
    v_add_f32 v49, v49, v65
    v_add_f32 v50, v50, v66
    v_add_f32 v51, v51, v67
    v_cvt_pk_bf16_f32 v128, v48, v49
    v_cvt_pk_bf16_f32 v129, v50, v51
    ds_write_b64 v22, v[128:129] offset:0
    v_fmac_f32 v52, v100, v18
    v_fmac_f32 v53, v101, v18
    v_fmac_f32 v54, v102, v18
    v_fmac_f32 v55, v103, v18
    v_add_f32 v52, v52, v68
    v_add_f32 v53, v53, v69
    v_add_f32 v54, v54, v70
    v_add_f32 v55, v55, v71
    v_cvt_pk_bf16_f32 v130, v52, v53
    v_cvt_pk_bf16_f32 v131, v54, v55
    ds_write_b64 v22, v[130:131] offset:512
    v_fmac_f32 v56, v104, v18
    v_fmac_f32 v57, v105, v18
    v_fmac_f32 v58, v106, v18
    v_fmac_f32 v59, v107, v18
    v_add_f32 v56, v56, v72
    v_add_f32 v57, v57, v73
    v_add_f32 v58, v58, v74
    v_add_f32 v59, v59, v75
    v_cvt_pk_bf16_f32 v132, v56, v57
    v_cvt_pk_bf16_f32 v133, v58, v59
    ds_write_b64 v22, v[132:133] offset:1024
    v_fmac_f32 v60, v108, v18
    v_fmac_f32 v61, v109, v18
    v_fmac_f32 v62, v110, v18
    v_fmac_f32 v63, v111, v18
    v_add_f32 v60, v60, v76
    v_add_f32 v61, v61, v77
    v_add_f32 v62, v62, v78
    v_add_f32 v63, v63, v79
    v_cvt_pk_bf16_f32 v134, v60, v61
    v_cvt_pk_bf16_f32 v135, v62, v63
    ds_write_b64 v22, v[134:135] offset:1536
    ds_read_b128 v[136:139], v21 offset:0
    ds_read_b128 v[140:143], v21 offset:1024
    s_add_u32 m0, m0, s9
    s_add_u32 s6, s6, s9
    buffer_load_dwordx4 v2, s[48:51], s6 offen sc1 lds
    s_add_u32 m0, m0, s9
    s_add_u32 s6, s6, s9
    buffer_load_dwordx4 v2, s[48:51], s6 offen sc1 lds
    s_add_u32 m0, m0, s9
    s_add_u32 s6, s6, s9
    buffer_load_dwordx4 v2, s[48:51], s6 offen sc1 lds
    s_add_u32 m0, m0, s9
    s_add_u32 s6, s6, s9
    buffer_load_dwordx4 v2, s[48:51], s6 offen sc1 lds
    s_add_u32 m0, m0, s9
    s_add_u32 s6, s6, s9
    buffer_load_dwordx4 v2, s[48:51], s6 offen sc1 lds
    s_add_u32 m0, m0, s9
    s_add_u32 s6, s6, s9
    buffer_load_dwordx4 v2, s[48:51], s6 offen sc1 lds
    s_add_u32 m0, m0, s9
    s_add_u32 s6, s6, s9
    buffer_load_dwordx4 v2, s[48:51], s6 offen sc1 lds
    s_add_u32 m0, m0, s9
    s_add_u32 s6, s6, s9
    buffer_load_dwordx4 v2, s[48:51], s6 offen sc1 lds
    s_waitcnt lgkmcnt(1)
    buffer_store_dwordx4 v[136:139], v2, s[24:27], s97 offen offset:0 sc1
    s_waitcnt lgkmcnt(0)
    buffer_store_dwordx4 v[140:143], v2, s[24:27], s97 offen offset:1024 sc1
    s_waitcnt vmcnt(15)
    s_barrier
    ds_read_b128 a[0:3], v2 offset:0
    ds_read_b128 a[4:7], v2 offset:1024
    ds_read_b128 a[8:11], v2 offset:2048
    ds_read_b128 a[12:15], v2 offset:3072
    ds_read_b128 a[16:19], v2 offset:4096
    ds_read_b128 a[20:23], v2 offset:5120
    ds_read_b128 a[24:27], v2 offset:6144
    ds_read_b128 a[28:31], v2 offset:7168
    s_waitcnt lgkmcnt(4)
    v_mfma_f32_16x16x32_bf16 v[48:51], v[160:163], a[0:3], 0
    ds_read_b128 a[32:35], v2 offset:8192
    s_add_u32 m0, m0, s9
    s_add_u32 s6, s6, s9
    buffer_load_dwordx4 v2, s[48:51], s6 offen sc1 lds
    v_mfma_f32_16x16x32_bf16 v[52:55], v[160:163], a[4:7], 0
    ds_read_b128 a[36:39], v2 offset:9216
    s_add_u32 m0, m0, s9
    s_add_u32 s6, s6, s9
    buffer_load_dwordx4 v2, s[48:51], s6 offen sc1 lds
    v_mfma_f32_16x16x32_bf16 v[56:59], v[160:163], a[8:11], 0
    ds_read_b128 a[40:43], v2 offset:10240
    s_add_u32 m0, m0, s9
    s_add_u32 s6, s6, s9
    buffer_load_dwordx4 v2, s[48:51], s6 offen sc1 lds
    v_mfma_f32_16x16x32_bf16 v[60:63], v[160:163], a[12:15], 0
    ds_read_b128 a[44:47], v2 offset:11264
    s_add_u32 m0, m0, s9
    s_add_u32 s6, s6, s9
    buffer_load_dwordx4 v2, s[48:51], s6 offen sc1 lds
    v_mfma_f32_16x16x32_bf16 v[64:67], v[164:167], a[0:3], 0
    buffer_load_dwordx4 v[112:115], v4, s[64:67], s13 offen sc1
    v_mfma_f32_16x16x32_bf16 v[68:71], v[164:167], a[4:7], 0
    s_add_u32 s11, s8, 8192
    buffer_load_dwordx4 v[160:163], v2, s[52:55], s11 offen offset:0 sc1
    v_mfma_f32_16x16x32_bf16 v[72:75], v[164:167], a[8:11], 0
    s_add_u32 s13, s13, 18432
    buffer_load_dwordx4 v[116:119], v4, s[64:67], s13 offen sc1
    v_mfma_f32_16x16x32_bf16 v[76:79], v[164:167], a[12:15], 0
    s_add_u32 s13, s13, 18432
    buffer_load_dwordx4 v[120:123], v4, s[64:67], s13 offen sc1
    s_waitcnt vmcnt(16)
    s_barrier
    s_waitcnt lgkmcnt(4)
    v_mfma_f32_16x16x32_bf16 v[48:51], v[168:171], a[16:19], v[48:51]
    ds_read_b128 a[48:51], v2 offset:12288
    s_add_u32 s13, s13, 18432
    buffer_load_dwordx4 v[124:127], v4, s[64:67], s13 offen sc1
    v_mfma_f32_16x16x32_bf16 v[52:55], v[168:171], a[20:23], v[52:55]
    buffer_load_dwordx4 v[164:167], v3, s[52:55], s11 offen offset:0 sc1
    s_add_u32 s13, s13, 18432
    buffer_load_dwordx4 v[128:131], v4, s[64:67], s13 offen sc1
    v_mfma_f32_16x16x32_bf16 v[56:59], v[168:171], a[24:27], v[56:59]
    ds_read_b128 a[52:55], v2 offset:13312
    s_add_u32 s13, s13, 18432
    buffer_load_dwordx4 v[132:135], v4, s[64:67], s13 offen sc1
    v_mfma_f32_16x16x32_bf16 v[60:63], v[168:171], a[28:31], v[60:63]
    ds_read_b128 a[56:59], v2 offset:14336
    v_mfma_f32_16x16x32_bf16 v[64:67], v[172:175], a[16:19], v[64:67]
    ds_read_b128 a[60:63], v2 offset:15360
    v_mfma_f32_16x16x32_bf16 v[68:71], v[172:175], a[20:23], v[68:71]
    buffer_load_dwordx4 v[168:171], v2, s[52:55], s11 offen offset:1024 sc1
    v_mfma_f32_16x16x32_bf16 v[72:75], v[172:175], a[24:27], v[72:75]
    v_mfma_f32_16x16x32_bf16 v[76:79], v[172:175], a[28:31], v[76:79]
    s_waitcnt lgkmcnt(4)
    v_mfma_f32_16x16x32_bf16 v[48:51], v[176:179], a[32:35], v[48:51]
    ds_read_b128 a[64:67], v2 offset:16384
    v_add_f32 v224, v224, v228
    v_add_f32 v225, v225, v229
    v_add_f32 v226, v226, v230
    v_mfma_f32_16x16x32_bf16 v[52:55], v[176:179], a[36:39], v[52:55]
    buffer_load_dwordx4 v[172:175], v3, s[52:55], s11 offen offset:1024 sc1
    v_mov_b32 v228, v224
    v_mfma_f32_16x16x32_bf16 v[56:59], v[176:179], a[40:43], v[56:59]
    ds_read_b128 a[68:71], v2 offset:17408
    v_mov_b32 v229, v225
    v_mov_b32 v230, v226
    v_mfma_f32_16x16x32_bf16 v[60:63], v[176:179], a[44:47], v[60:63]
    ds_read_b128 a[72:75], v2 offset:18432
    v_permlane32_swap_b32 v228, v224
    v_permlane32_swap_b32 v229, v225
    v_mfma_f32_16x16x32_bf16 v[64:67], v[180:183], a[32:35], v[64:67]
    ds_read_b128 a[76:79], v2 offset:19456
    v_permlane32_swap_b32 v230, v226
    v_mfma_f32_16x16x32_bf16 v[68:71], v[180:183], a[36:39], v[68:71]
    buffer_load_dwordx4 v[176:179], v2, s[52:55], s11 offen offset:2048 sc1
    v_add_f32 v224, v224, v228
    v_add_f32 v225, v225, v229
    v_mfma_f32_16x16x32_bf16 v[72:75], v[180:183], a[40:43], v[72:75]
    v_add_f32 v226, v226, v230
    v_mov_b32 v228, v224
    v_mov_b32 v229, v225
    v_mfma_f32_16x16x32_bf16 v[76:79], v[180:183], a[44:47], v[76:79]
    v_mov_b32 v230, v226
    v_permlane16_swap_b32 v228, v224
    s_waitcnt lgkmcnt(4)
    v_mfma_f32_16x16x32_bf16 v[48:51], v[184:187], a[48:51], v[48:51]
    ds_read_b128 a[80:83], v2 offset:20480
    v_permlane16_swap_b32 v229, v225
    v_mfma_f32_16x16x32_bf16 v[52:55], v[184:187], a[52:55], v[52:55]
    buffer_load_dwordx4 v[180:183], v3, s[52:55], s11 offen offset:2048 sc1
    v_permlane16_swap_b32 v230, v226
    v_add_f32 v224, v224, v228
    v_mfma_f32_16x16x32_bf16 v[56:59], v[184:187], a[56:59], v[56:59]
    ds_read_b128 a[84:87], v2 offset:21504
    v_add_f32 v225, v225, v229
    v_add_f32 v226, v226, v230
    v_mfma_f32_16x16x32_bf16 v[60:63], v[184:187], a[60:63], v[60:63]
    ds_read_b128 a[88:91], v2 offset:22528
    v_mul_f32 v28, 0xbae38e39, v224
    v_mfma_f32_16x16x32_bf16 v[64:67], v[188:191], a[48:51], v[64:67]
    ds_read_b128 a[92:95], v2 offset:23552
    v_mul_f32 v225, 0x3ae38e39, v225
    v_mul_f32 v226, 0xbfb8aa3b, v226
    v_mfma_f32_16x16x32_bf16 v[68:71], v[188:191], a[52:55], v[68:71]
    buffer_load_dwordx4 v[184:187], v2, s[52:55], s11 offen offset:3072 sc1
    v_fma_f32 v225, -v28, v28, v225
    v_mfma_f32_16x16x32_bf16 v[72:75], v[188:191], a[56:59], v[72:75]
    v_exp_f32 v226, v226
    v_max_f32 v225, 0, v225
    v_mfma_f32_16x16x32_bf16 v[76:79], v[188:191], a[60:63], v[76:79]
    v_add_f32 v225, 0x3727c5ac, v225
    v_add_f32 v226, 1.0, v226
    s_waitcnt lgkmcnt(4)
    v_mfma_f32_16x16x32_bf16 v[48:51], v[192:195], a[64:67], v[48:51]
    ds_read_b128 a[96:99], v2 offset:24576
    v_rsq_f32 v224, v225
    v_mfma_f32_16x16x32_bf16 v[52:55], v[192:195], a[68:71], v[52:55]
    buffer_load_dwordx4 v[188:191], v3, s[52:55], s11 offen offset:3072 sc1
    v_sqrt_f32 v31, v225
    v_mfma_f32_16x16x32_bf16 v[56:59], v[192:195], a[72:75], v[56:59]
    ds_read_b128 a[100:103], v2 offset:25600
    v_rcp_f32 v226, v226
    v_mfma_f32_16x16x32_bf16 v[60:63], v[192:195], a[76:79], v[60:63]
    ds_read_b128 a[104:107], v2 offset:26624
    v_add_u32 v227, s47, v6
    v_mfma_f32_16x16x32_bf16 v[64:67], v[196:199], a[64:67], v[64:67]
    ds_read_b128 a[108:111], v2 offset:27648
    v_mul_f32 v29, 0xc0135761, v224
    v_mul_f32 v30, v224, v224
    v_mfma_f32_16x16x32_bf16 v[68:71], v[196:199], a[68:71], v[68:71]
    s_add_u32 s11, s8, 12288
    buffer_load_dwordx4 v[192:195], v2, s[52:55], s11 offen offset:0 sc1
    v_mfma_f32_16x16x32_bf16 v[72:75], v[196:199], a[72:75], v[72:75]
    v_mul_f32 v30, v30, v29
    v_mul_f32 v30, 0x3d372713, v30
    v_lshrrev_b32 v228, 2, v227
    v_mfma_f32_16x16x32_bf16 v[76:79], v[196:199], a[76:79], v[76:79]
    v_add_u32 v228, 114688, v228
    v_add_u32 v6, 147456, v6
    s_waitcnt lgkmcnt(4)
    v_mfma_f32_16x16x32_bf16 v[48:51], v[200:203], a[80:83], v[48:51]
    ds_read_b128 a[112:115], v2 offset:28672
    v_mfma_f32_16x16x32_bf16 v[52:55], v[200:203], a[84:87], v[52:55]
    buffer_load_dwordx4 v[196:199], v3, s[52:55], s11 offen offset:0 sc1
    ds_write_b128 v227, v[28:31]
    v_mfma_f32_16x16x32_bf16 v[56:59], v[200:203], a[88:91], v[56:59]
    ds_read_b128 a[116:119], v2 offset:29696
    ds_write_b32 v228, v226
    v_mfma_f32_16x16x32_bf16 v[60:63], v[200:203], a[92:95], v[60:63]
    ds_read_b128 a[120:123], v2 offset:30720
    v_mfma_f32_16x16x32_bf16 v[64:67], v[204:207], a[80:83], v[64:67]
    ds_read_b128 a[124:127], v2 offset:31744
    v_mfma_f32_16x16x32_bf16 v[68:71], v[204:207], a[84:87], v[68:71]
    buffer_load_dwordx4 v[200:203], v2, s[52:55], s11 offen offset:1024 sc1
    v_mfma_f32_16x16x32_bf16 v[72:75], v[204:207], a[88:91], v[72:75]
    v_mfma_f32_16x16x32_bf16 v[76:79], v[204:207], a[92:95], v[76:79]
    s_waitcnt lgkmcnt(2)
    s_barrier
    ds_read_b128 v[12:15], v6 offset:0
    ds_read_b128 v[16:19], v6 offset:256
    ds_read_b128 v[20:23], v6 offset:512
    ds_read_b128 v[24:27], v6 offset:768
    s_waitcnt vmcnt(24)
    s_barrier
    v_mfma_f32_16x16x32_bf16 v[48:51], v[208:211], a[96:99], v[48:51]
    ds_read_b128 a[128:131], v2 offset:32768
    v_mfma_f32_16x16x32_bf16 v[52:55], v[208:211], a[100:103], v[52:55]
    buffer_load_dwordx4 v[204:207], v3, s[52:55], s11 offen offset:1024 sc1
    v_mfma_f32_16x16x32_bf16 v[56:59], v[208:211], a[104:107], v[56:59]
    ds_read_b128 a[132:135], v2 offset:33792
    v_mfma_f32_16x16x32_bf16 v[60:63], v[208:211], a[108:111], v[60:63]
    ds_read_b128 a[136:139], v2 offset:34816
    v_mfma_f32_16x16x32_bf16 v[64:67], v[212:215], a[96:99], v[64:67]
    ds_read_b128 a[140:143], v2 offset:35840
    v_mfma_f32_16x16x32_bf16 v[68:71], v[212:215], a[100:103], v[68:71]
    buffer_load_dwordx4 v[208:211], v2, s[52:55], s11 offen offset:2048 sc1
    v_mfma_f32_16x16x32_bf16 v[72:75], v[212:215], a[104:107], v[72:75]
    v_mfma_f32_16x16x32_bf16 v[76:79], v[212:215], a[108:111], v[76:79]
    s_waitcnt lgkmcnt(8)
    v_mfma_f32_16x16x32_bf16 v[48:51], v[216:219], a[112:115], v[48:51]
    ds_read_b128 a[144:147], v2 offset:36864
    s_waitcnt vmcnt(11)
    v_add_f32 v112, v112, v116
    v_add_f32 v113, v113, v117
    v_mfma_f32_16x16x32_bf16 v[52:55], v[216:219], a[116:119], v[52:55]
    buffer_load_dwordx4 v[212:215], v3, s[52:55], s11 offen offset:2048 sc1
    v_lshlrev_b32 v36, 20, v1
    v_mov_b32 v37, s90
    buffer_store_dword v37, v36, s[68:71], s98 offen sc1
    s_lshr_b32 s95, s42, 5
    s_lshl_b32 s93, s4, 9
    s_add_u32 s93, s93, 0x5400
    s_add_u32 s95, s95, s93
    buffer_store_dword v37, v36, s[68:71], s95 offen sc1
    v_mfma_f32_16x16x32_bf16 v[56:59], v[216:219], a[120:123], v[56:59]
    ds_read_b128 a[148:151], v2 offset:37888
    v_add_f32 v114, v114, v118
    v_mfma_f32_16x16x32_bf16 v[60:63], v[216:219], a[124:127], v[60:63]
    ds_read_b128 a[152:155], v2 offset:38912
    v_add_f32 v115, v115, v119
    v_mfma_f32_16x16x32_bf16 v[64:67], v[220:223], a[112:115], v[64:67]
    ds_read_b128 a[156:159], v2 offset:39936
    v_add_f32 v112, v112, v120
    v_mfma_f32_16x16x32_bf16 v[68:71], v[220:223], a[116:119], v[68:71]
    buffer_load_dwordx4 v[216:219], v2, s[52:55], s11 offen offset:3072 sc1
    v_add_f32 v113, v113, v121
    v_mfma_f32_16x16x32_bf16 v[72:75], v[220:223], a[120:123], v[72:75]
    v_add_f32 v114, v114, v122
    v_add_f32 v115, v115, v123
    v_mfma_f32_16x16x32_bf16 v[76:79], v[220:223], a[124:127], v[76:79]
    v_add_f32 v112, v112, v124
    v_add_f32 v113, v113, v125
    s_waitcnt lgkmcnt(4)
    v_mfma_f32_16x16x32_bf16 v[48:51], v[160:163], a[128:131], v[48:51]
    ds_read_b128 a[160:163], v2 offset:40960
    v_add_f32 v114, v114, v126
    v_mfma_f32_16x16x32_bf16 v[52:55], v[160:163], a[132:135], v[52:55]
    buffer_load_dwordx4 v[220:223], v3, s[52:55], s11 offen offset:3072 sc1
    v_add_f32 v115, v115, v127
    v_mfma_f32_16x16x32_bf16 v[56:59], v[160:163], a[136:139], v[56:59]
    ds_read_b128 a[164:167], v2 offset:41984
    v_add_f32 v112, v112, v128
    v_mfma_f32_16x16x32_bf16 v[60:63], v[160:163], a[140:143], v[60:63]
    ds_read_b128 a[168:171], v2 offset:43008
    v_add_f32 v113, v113, v129
    v_mfma_f32_16x16x32_bf16 v[64:67], v[164:167], a[128:131], v[64:67]
    ds_read_b128 a[172:175], v2 offset:44032
    v_add_f32 v114, v114, v130
    v_mfma_f32_16x16x32_bf16 v[68:71], v[164:167], a[132:135], v[68:71]
    s_add_u32 s11, s8, 16384
    buffer_load_dwordx4 v[160:163], v2, s[52:55], s11 offen offset:0 sc1
    v_mfma_f32_16x16x32_bf16 v[72:75], v[164:167], a[136:139], v[72:75]
    v_add_f32 v115, v115, v131
    v_add_f32 v112, v112, v132
    v_mfma_f32_16x16x32_bf16 v[76:79], v[164:167], a[140:143], v[76:79]
    v_add_f32 v113, v113, v133
    v_add_f32 v114, v114, v134
    s_waitcnt vmcnt(15)
    s_waitcnt lgkmcnt(4)
    v_mfma_f32_16x16x32_bf16 v[48:51], v[168:171], a[144:147], v[48:51]
    ds_read_b128 a[176:179], v2 offset:45056
    v_add_f32 v115, v115, v135
    v_mfma_f32_16x16x32_bf16 v[52:55], v[168:171], a[148:151], v[52:55]
    buffer_load_dwordx4 v[164:167], v3, s[52:55], s11 offen offset:0 sc1
    ds_write_b128 v5, v[112:115]
    ds_read_b128 v[92:95], v11 offset:128
    s_waitcnt lgkmcnt(0)
    v_mfma_f32_16x16x32_bf16 v[56:59], v[168:171], a[152:155], v[56:59]
    ds_read_b128 a[180:183], v2 offset:46080
    ds_read_b128 v[108:111], v11 offset:192
    v_mfma_f32_16x16x32_bf16 v[60:63], v[168:171], a[156:159], v[60:63]
    ds_read_b128 a[184:187], v2 offset:47104
    ds_read_b128 v[40:43], v11 offset:0
    v_mul_f32 v80, v12, v92
    v_mfma_f32_16x16x32_bf16 v[64:67], v[172:175], a[144:147], v[64:67]
    ds_read_b128 a[188:191], v2 offset:48128
    ds_read_b128 v[44:47], v11 offset:64
    v_mul_f32 v81, v12, v93
    v_mfma_f32_16x16x32_bf16 v[68:71], v[172:175], a[148:151], v[68:71]
    buffer_load_dwordx4 v[168:171], v2, s[52:55], s11 offen offset:1024 sc1
    ds_read_b128 v[124:127], v11 offset:256
    v_mfma_f32_16x16x32_bf16 v[72:75], v[172:175], a[152:155], v[72:75]
    ds_read_b128 v[140:143], v11 offset:320
    ds_read_b128 v[156:159], v11 offset:512
    v_mul_f32 v82, v12, v94
    v_mfma_f32_16x16x32_bf16 v[76:79], v[172:175], a[156:159], v[76:79]
    v_mul_f32 v83, v12, v95
    v_mul_f32 v84, v16, v92
    v_mul_f32 v85, v16, v93
    s_waitcnt vmcnt(15)
    v_mfma_f32_16x16x32_bf16 v[48:51], v[176:179], a[160:163], v[48:51]
    ds_read_b128 a[192:195], v2 offset:49152
    v_mul_f32 v86, v16, v94
    v_mfma_f32_16x16x32_bf16 v[52:55], v[176:179], a[164:167], v[52:55]
    buffer_load_dwordx4 v[172:175], v3, s[52:55], s11 offen offset:1024 sc1
    v_mul_f32 v87, v16, v95
    v_mfma_f32_16x16x32_bf16 v[56:59], v[176:179], a[168:171], v[56:59]
    ds_read_b128 a[196:199], v2 offset:50176
    v_mul_f32 v88, v20, v92
    v_mul_f32 v89, v20, v93
    v_mfma_f32_16x16x32_bf16 v[60:63], v[176:179], a[172:175], v[60:63]
    ds_read_b128 a[200:203], v2 offset:51200
    v_mul_f32 v90, v20, v94
    v_mfma_f32_16x16x32_bf16 v[64:67], v[180:183], a[160:163], v[64:67]
    ds_read_b128 a[204:207], v2 offset:52224
    v_mul_f32 v91, v20, v95
    v_mul_f32 v92, v24, v92
    v_mfma_f32_16x16x32_bf16 v[68:71], v[180:183], a[164:167], v[68:71]
    s_add_u32 s11, s8, 36864
    buffer_load_dwordx4 v[176:179], v2, s[52:55], s11 offen offset:0 sc1
    v_mul_f32 v93, v24, v93
    v_mfma_f32_16x16x32_bf16 v[72:75], v[180:183], a[168:171], v[72:75]
    v_mul_f32 v94, v24, v94
    v_mul_f32 v95, v24, v95
    v_mul_f32 v96, v12, v108
    v_mfma_f32_16x16x32_bf16 v[76:79], v[180:183], a[172:175], v[76:79]
    v_mul_f32 v97, v12, v109
    v_mul_f32 v98, v12, v110
    s_barrier
    s_waitcnt vmcnt(15)
    s_waitcnt lgkmcnt(8)
    v_mfma_f32_16x16x32_bf16 v[48:51], v[184:187], a[176:179], v[48:51]
    ds_read_b128 a[208:211], v2 offset:53248
    v_mul_f32 v99, v12, v111
    v_mfma_f32_16x16x32_bf16 v[52:55], v[184:187], a[180:183], v[52:55]
    buffer_load_dwordx4 v[180:183], v3, s[52:55], s11 offen offset:0 sc1
    v_mul_f32 v100, v16, v108
    v_mfma_f32_16x16x32_bf16 v[56:59], v[184:187], a[184:187], v[56:59]
    ds_read_b128 a[212:215], v2 offset:54272
    v_mul_f32 v101, v16, v109
    v_mfma_f32_16x16x32_bf16 v[60:63], v[184:187], a[188:191], v[60:63]
    ds_read_b128 a[216:219], v2 offset:55296
    v_mul_f32 v102, v16, v110
    v_mfma_f32_16x16x32_bf16 v[64:67], v[188:191], a[176:179], v[64:67]
    ds_read_b128 a[220:223], v2 offset:56320
    v_mul_f32 v103, v16, v111
    v_mfma_f32_16x16x32_bf16 v[68:71], v[188:191], a[180:183], v[68:71]
    buffer_load_dwordx4 v[184:187], v2, s[52:55], s11 offen offset:1024 sc1
    v_mul_f32 v104, v20, v108
    v_mfma_f32_16x16x32_bf16 v[72:75], v[188:191], a[184:187], v[72:75]
    v_mul_f32 v105, v20, v109
    v_mul_f32 v106, v20, v110
    v_mul_f32 v107, v20, v111
    v_mfma_f32_16x16x32_bf16 v[76:79], v[188:191], a[188:191], v[76:79]
    v_mul_f32 v108, v24, v108
    v_mul_f32 v109, v24, v109
    v_mul_f32 v110, v24, v110
    s_waitcnt vmcnt(15)
    s_waitcnt lgkmcnt(4)
    v_mfma_f32_16x16x32_bf16 v[48:51], v[192:195], a[192:195], v[48:51]
    ds_read_b128 a[224:227], v2 offset:57344
    v_mul_f32 v111, v24, v111
    v_mfma_f32_16x16x32_bf16 v[52:55], v[192:195], a[196:199], v[52:55]
    buffer_load_dwordx4 v[188:191], v3, s[52:55], s11 offen offset:1024 sc1
    v_mul_f32 v112, v12, v124
    v_mfma_f32_16x16x32_bf16 v[56:59], v[192:195], a[200:203], v[56:59]
    ds_read_b128 a[228:231], v2 offset:58368
    v_mul_f32 v113, v12, v125
    v_mfma_f32_16x16x32_bf16 v[60:63], v[192:195], a[204:207], v[60:63]
    ds_read_b128 a[232:235], v2 offset:59392
    v_mul_f32 v114, v12, v126
    v_mul_f32 v115, v12, v127
    v_mfma_f32_16x16x32_bf16 v[64:67], v[196:199], a[192:195], v[64:67]
    ds_read_b128 a[236:239], v2 offset:60416
    v_mul_f32 v116, v16, v124
    v_mfma_f32_16x16x32_bf16 v[68:71], v[196:199], a[196:199], v[68:71]
    buffer_load_dwordx4 v[192:195], v2, s[52:55], s11 offen offset:2048 sc1
    v_mul_f32 v117, v16, v125
    v_mul_f32 v118, v16, v126
    v_mfma_f32_16x16x32_bf16 v[72:75], v[196:199], a[200:203], v[72:75]
    v_mul_f32 v119, v16, v127
    v_mul_f32 v120, v20, v124
    v_mul_f32 v121, v20, v125
    v_mfma_f32_16x16x32_bf16 v[76:79], v[196:199], a[204:207], v[76:79]
    v_mul_f32 v122, v20, v126
    v_mul_f32 v123, v20, v127
    s_waitcnt vmcnt(15)
    s_waitcnt lgkmcnt(4)
    v_mfma_f32_16x16x32_bf16 v[48:51], v[200:203], a[208:211], v[48:51]
    ds_read_b128 a[240:243], v2 offset:61440
    v_mul_f32 v124, v24, v124
    v_mfma_f32_16x16x32_bf16 v[52:55], v[200:203], a[212:215], v[52:55]
    buffer_load_dwordx4 v[196:199], v3, s[52:55], s11 offen offset:2048 sc1
    v_mul_f32 v125, v24, v125
    v_mfma_f32_16x16x32_bf16 v[56:59], v[200:203], a[216:219], v[56:59]
    ds_read_b128 a[244:247], v2 offset:62464
    v_mul_f32 v126, v24, v126
    v_mul_f32 v127, v24, v127
    v_mfma_f32_16x16x32_bf16 v[60:63], v[200:203], a[220:223], v[60:63]
    ds_read_b128 a[248:251], v2 offset:63488
    v_mul_f32 v128, v12, v140
    v_mfma_f32_16x16x32_bf16 v[64:67], v[204:207], a[208:211], v[64:67]
    ds_read_b128 a[252:255], v2 offset:64512
    v_mul_f32 v129, v12, v141
    v_mul_f32 v130, v12, v142
    v_mfma_f32_16x16x32_bf16 v[68:71], v[204:207], a[212:215], v[68:71]
    buffer_load_dwordx4 v[200:203], v2, s[52:55], s11 offen offset:3072 sc1
    v_mul_f32 v131, v12, v143
    v_mul_f32 v132, v16, v140
    v_mfma_f32_16x16x32_bf16 v[72:75], v[204:207], a[216:219], v[72:75]
    v_mul_f32 v133, v16, v141
    v_mul_f32 v134, v16, v142
    v_mfma_f32_16x16x32_bf16 v[76:79], v[204:207], a[220:223], v[76:79]
    v_mul_f32 v135, v16, v143
    v_mul_f32 v136, v20, v140
    v_mul_f32 v137, v20, v141
    s_waitcnt vmcnt(15)
    s_waitcnt lgkmcnt(4)
    v_mfma_f32_16x16x32_bf16 v[48:51], v[208:211], a[224:227], v[48:51]
    ds_read_b128 v[224:227], v7 offset:0
    v_mul_f32 v138, v20, v142
    v_mfma_f32_16x16x32_bf16 v[52:55], v[208:211], a[228:231], v[52:55]
    buffer_load_dwordx4 v[204:207], v3, s[52:55], s11 offen offset:3072 sc1
    v_mul_f32 v139, v20, v143
    v_mfma_f32_16x16x32_bf16 v[56:59], v[208:211], a[232:235], v[56:59]
    ds_read_b128 v[228:231], v7 offset:1024
    v_mul_f32 v140, v24, v140
    v_mfma_f32_16x16x32_bf16 v[60:63], v[208:211], a[236:239], v[60:63]
    ds_read_b128 v[232:235], v7 offset:2048
    v_mul_f32 v141, v24, v141
    v_mul_f32 v142, v24, v142
    v_mfma_f32_16x16x32_bf16 v[64:67], v[212:215], a[224:227], v[64:67]
    ds_read_b128 v[236:239], v7 offset:3072
    v_mul_f32 v143, v24, v143
    v_mul_f32 v144, v12, v156
    v_mfma_f32_16x16x32_bf16 v[68:71], v[212:215], a[228:231], v[68:71]
    s_add_u32 s11, s8, 40960
    buffer_load_dwordx4 v[208:211], v2, s[52:55], s11 offen offset:0 sc1
    v_mfma_f32_16x16x32_bf16 v[72:75], v[212:215], a[232:235], v[72:75]
    v_mul_f32 v145, v12, v157
    v_mul_f32 v146, v12, v158
    v_mul_f32 v147, v12, v159
    v_mfma_f32_16x16x32_bf16 v[76:79], v[212:215], a[236:239], v[76:79]
    v_mul_f32 v148, v16, v156
    v_mul_f32 v149, v16, v157
    v_mul_f32 v150, v16, v158
    s_waitcnt vmcnt(13)
    s_waitcnt lgkmcnt(4)
    v_mfma_f32_16x16x32_bf16 v[48:51], v[216:219], a[240:243], v[48:51]
    ds_read_b128 v[240:243], v7 offset:4096
    v_mul_f32 v151, v16, v159
    v_mfma_f32_16x16x32_bf16 v[52:55], v[216:219], a[244:247], v[52:55]
    buffer_load_dwordx4 v[212:215], v3, s[52:55], s11 offen offset:0 sc1
    v_mul_f32 v152, v20, v156
    v_mfma_f32_16x16x32_bf16 v[56:59], v[216:219], a[248:251], v[56:59]
    ds_read_b128 v[244:247], v7 offset:5120
    v_mul_f32 v153, v20, v157
    v_mfma_f32_16x16x32_bf16 v[60:63], v[216:219], a[252:255], v[60:63]
    ds_read_b128 v[248:251], v7 offset:6144
    v_mul_f32 v154, v20, v158
    v_mfma_f32_16x16x32_bf16 v[64:67], v[220:223], a[240:243], v[64:67]
    ds_read_b128 v[252:255], v7 offset:7168
    v_mul_f32 v155, v20, v159
    v_mul_f32 v156, v24, v156
    v_mfma_f32_16x16x32_bf16 v[68:71], v[220:223], a[244:247], v[68:71]
    buffer_load_dwordx4 v[216:219], v2, s[52:55], s11 offen offset:1024 sc1
    v_mul_f32 v157, v24, v157
    v_mul_f32 v158, v24, v158
    v_mfma_f32_16x16x32_bf16 v[72:75], v[220:223], a[248:251], v[72:75]
    v_mul_f32 v159, v24, v159
    v_mfma_f32_16x16x32_bf16 v[76:79], v[220:223], a[252:255], v[76:79]
    s_waitcnt vmcnt(13)
    s_waitcnt lgkmcnt(4)
    v_mfma_f32_16x16x32_bf16 v[48:51], v[160:163], v[224:227], v[48:51]
    v_mfma_f32_16x16x32_bf16 v[52:55], v[160:163], v[228:231], v[52:55]
    buffer_load_dwordx4 v[220:223], v3, s[52:55], s11 offen offset:1024 sc1
    v_mfma_f32_16x16x32_bf16 v[56:59], v[160:163], v[232:235], v[56:59]
    v_mfma_f32_16x16x32_bf16 v[60:63], v[160:163], v[236:239], v[60:63]
    v_mfma_f32_16x16x32_bf16 v[64:67], v[164:167], v[224:227], v[64:67]
    v_mfma_f32_16x16x32_bf16 v[68:71], v[164:167], v[228:231], v[68:71]
    buffer_load_dwordx4 v[160:163], v2, s[52:55], s11 offen offset:2048 sc1
    v_mfma_f32_16x16x32_bf16 v[72:75], v[164:167], v[232:235], v[72:75]
    v_mfma_f32_16x16x32_bf16 v[76:79], v[164:167], v[236:239], v[76:79]
    s_waitcnt vmcnt(13)
    s_waitcnt lgkmcnt(0)
    v_mfma_f32_16x16x32_bf16 v[48:51], v[168:171], v[240:243], v[48:51]
    v_mfma_f32_16x16x32_bf16 v[52:55], v[168:171], v[244:247], v[52:55]
    buffer_load_dwordx4 v[164:167], v3, s[52:55], s11 offen offset:2048 sc1
    v_mfma_f32_16x16x32_bf16 v[56:59], v[168:171], v[248:251], v[56:59]
    v_mfma_f32_16x16x32_bf16 v[60:63], v[168:171], v[252:255], v[60:63]
    v_mfma_f32_16x16x32_bf16 v[64:67], v[172:175], v[240:243], v[64:67]
    v_mfma_f32_16x16x32_bf16 v[68:71], v[172:175], v[244:247], v[68:71]
    buffer_load_dwordx4 v[168:171], v2, s[52:55], s11 offen offset:3072 sc1
    v_mfma_f32_16x16x32_bf16 v[72:75], v[172:175], v[248:251], v[72:75]
    v_mfma_f32_16x16x32_bf16 v[76:79], v[172:175], v[252:255], v[76:79]
    s_getpc_b64 s[12:13]
kl_pc1:
    s_add_u32 s48, s12, 8192
    s_addc_u32 s49, s13, 0
    s_mov_b32 s50, code_end-kl_pc1-8192
    s_mov_b32 s51, 0x20000
    s_lshr_b32 s12, s2, 3
    s_lshl_b32 s12, s12, 13
    s_lshl_b32 s13, s3, 20
    s_add_u32 s12, s12, s13
    v_lshlrev_b32 v6, 7, v1
    v_add_u32 v6, s12, v6
    buffer_load_dword v6, v6, s[48:51], 0 offen
    s_waitcnt vmcnt(12)
    v_mfma_f32_16x16x32_bf16 v[80:83], v[176:179], a[0:3], v[80:83]
    v_fmac_f32 v48, v12, v40
    v_fmac_f32 v49, v12, v41
    v_fmac_f32 v50, v12, v42
    v_fmac_f32 v51, v12, v43
    v_mfma_f32_16x16x32_bf16 v[84:87], v[176:179], a[4:7], v[84:87]
    buffer_load_dwordx4 v[172:175], v3, s[52:55], s11 offen offset:3072 sc1
    v_mul_f32 v28, v48, v48
    v_mfma_f32_16x16x32_bf16 v[88:91], v[176:179], a[8:11], v[88:91]
    v_mul_f32 v29, v49, v49
    v_mul_f32 v30, v50, v50
    v_mul_f32 v31, v51, v51
    v_mfma_f32_16x16x32_bf16 v[92:95], v[176:179], a[12:15], v[92:95]
    v_fma_f32 v28, v28, v14, v13
    v_fma_f32 v29, v29, v14, v13
    v_fma_f32 v30, v30, v14, v13
    v_mfma_f32_16x16x32_bf16 v[96:99], v[180:183], a[0:3], v[96:99]
    v_fma_f32 v31, v31, v14, v13
    v_mul_f32 v28, v48, v28
    v_mfma_f32_16x16x32_bf16 v[100:103], v[180:183], a[4:7], v[100:103]
    s_add_u32 s11, s8, 45056
    buffer_load_dwordx4 v[176:179], v2, s[52:55], s11 offen offset:0 sc1
    v_mul_f32 v29, v49, v29
    v_mfma_f32_16x16x32_bf16 v[104:107], v[180:183], a[8:11], v[104:107]
    v_mul_f32 v30, v50, v30
    v_mul_f32 v31, v51, v31
    v_mfma_f32_16x16x32_bf16 v[108:111], v[180:183], a[12:15], v[108:111]
    v_exp_f32 v28, v28
    v_mfma_f32_16x16x32_bf16 v[80:83], v[184:187], a[16:19], v[80:83]
    v_exp_f32 v29, v29
    v_exp_f32 v30, v30
    v_mfma_f32_16x16x32_bf16 v[84:87], v[184:187], a[20:23], v[84:87]
    buffer_load_dwordx4 v[180:183], v3, s[52:55], s11 offen offset:0 sc1
    v_exp_f32 v31, v31
    v_mfma_f32_16x16x32_bf16 v[88:91], v[184:187], a[24:27], v[88:91]
    v_fma_f32 v28, v28, v15, v15
    v_fma_f32 v29, v29, v15, v15
    v_mfma_f32_16x16x32_bf16 v[92:95], v[184:187], a[28:31], v[92:95]
    v_fma_f32 v30, v30, v15, v15
    v_fma_f32 v31, v31, v15, v15
    v_mfma_f32_16x16x32_bf16 v[96:99], v[188:191], a[16:19], v[96:99]
    v_rcp_f32 v28, v28
    v_mfma_f32_16x16x32_bf16 v[100:103], v[188:191], a[20:23], v[100:103]
    buffer_load_dwordx4 v[184:187], v2, s[52:55], s11 offen offset:1024 sc1
    v_rcp_f32 v29, v29
    v_mfma_f32_16x16x32_bf16 v[104:107], v[188:191], a[24:27], v[104:107]
    v_rcp_f32 v30, v30
    v_mfma_f32_16x16x32_bf16 v[108:111], v[188:191], a[28:31], v[108:111]
    v_rcp_f32 v31, v31
    v_mul_f32 v28, v48, v28
    v_mul_f32 v29, v49, v29
    s_waitcnt vmcnt(12)
    v_mfma_f32_16x16x32_bf16 v[80:83], v[192:195], a[32:35], v[80:83]
    v_mul_f32 v30, v50, v30
    v_mul_f32 v31, v51, v31
    v_mfma_f32_16x16x32_bf16 v[84:87], v[192:195], a[36:39], v[84:87]
    buffer_load_dwordx4 v[188:191], v3, s[52:55], s11 offen offset:1024 sc1
    v_cvt_pk_bf16_f32 v36, v28, v29
    v_mfma_f32_16x16x32_bf16 v[88:91], v[192:195], a[40:43], v[88:91]
    v_cvt_pk_bf16_f32 v37, v30, v31
    v_fmac_f32 v64, v12, v44
    v_fmac_f32 v65, v12, v45
    v_mfma_f32_16x16x32_bf16 v[92:95], v[192:195], a[44:47], v[92:95]
    v_fmac_f32 v66, v12, v46
    v_fmac_f32 v67, v12, v47
    v_mfma_f32_16x16x32_bf16 v[96:99], v[196:199], a[32:35], v[96:99]
    v_mul_f32 v32, v64, v64
    v_mul_f32 v33, v65, v65
    v_mul_f32 v34, v66, v66
    v_mfma_f32_16x16x32_bf16 v[100:103], v[196:199], a[36:39], v[100:103]
    buffer_load_dwordx4 v[192:195], v2, s[52:55], s11 offen offset:2048 sc1
    v_mul_f32 v35, v67, v67
    v_fma_f32 v32, v32, v14, v13
    v_mfma_f32_16x16x32_bf16 v[104:107], v[196:199], a[40:43], v[104:107]
    v_fma_f32 v33, v33, v14, v13
    v_fma_f32 v34, v34, v14, v13
    v_mfma_f32_16x16x32_bf16 v[108:111], v[196:199], a[44:47], v[108:111]
    v_fma_f32 v35, v35, v14, v13
    v_mul_f32 v32, v64, v32
    v_mul_f32 v33, v65, v33
    v_mfma_f32_16x16x32_bf16 v[80:83], v[200:203], a[48:51], v[80:83]
    v_mul_f32 v34, v66, v34
    v_mul_f32 v35, v67, v35
    v_mfma_f32_16x16x32_bf16 v[84:87], v[200:203], a[52:55], v[84:87]
    buffer_load_dwordx4 v[196:199], v3, s[52:55], s11 offen offset:2048 sc1
    v_exp_f32 v32, v32
    v_mfma_f32_16x16x32_bf16 v[88:91], v[200:203], a[56:59], v[88:91]
    v_exp_f32 v33, v33
    v_mfma_f32_16x16x32_bf16 v[92:95], v[200:203], a[60:63], v[92:95]
    v_exp_f32 v34, v34
    v_exp_f32 v35, v35
    v_mfma_f32_16x16x32_bf16 v[96:99], v[204:207], a[48:51], v[96:99]
    v_fma_f32 v32, v32, v15, v15
    v_fma_f32 v33, v33, v15, v15
    v_mfma_f32_16x16x32_bf16 v[100:103], v[204:207], a[52:55], v[100:103]
    buffer_load_dwordx4 v[200:203], v2, s[52:55], s11 offen offset:3072 sc1
    v_fma_f32 v34, v34, v15, v15
    v_fma_f32 v35, v35, v15, v15
    v_mfma_f32_16x16x32_bf16 v[104:107], v[204:207], a[56:59], v[104:107]
    v_rcp_f32 v32, v32
    v_mfma_f32_16x16x32_bf16 v[108:111], v[204:207], a[60:63], v[108:111]
    v_rcp_f32 v33, v33
    s_waitcnt vmcnt(12)
    v_mfma_f32_16x16x32_bf16 v[80:83], v[208:211], a[64:67], v[80:83]
    v_rcp_f32 v34, v34
    v_mfma_f32_16x16x32_bf16 v[84:87], v[208:211], a[68:71], v[84:87]
    buffer_load_dwordx4 v[204:207], v3, s[52:55], s11 offen offset:3072 sc1
    v_rcp_f32 v35, v35
    v_mul_f32 v32, v64, v32
    v_mfma_f32_16x16x32_bf16 v[88:91], v[208:211], a[72:75], v[88:91]
    v_mul_f32 v33, v65, v33
    v_mul_f32 v34, v66, v34
    v_mfma_f32_16x16x32_bf16 v[92:95], v[208:211], a[76:79], v[92:95]
    v_mul_f32 v35, v67, v35
    v_cvt_pk_bf16_f32 v38, v32, v33
    v_cvt_pk_bf16_f32 v39, v34, v35
    v_mfma_f32_16x16x32_bf16 v[96:99], v[212:215], a[64:67], v[96:99]
    v_fmac_f32 v52, v16, v40
    v_fmac_f32 v53, v16, v41
    v_fmac_f32 v54, v16, v42
    v_mfma_f32_16x16x32_bf16 v[100:103], v[212:215], a[68:71], v[100:103]
    s_add_u32 s11, s8, 49152
    buffer_load_dwordx4 v[208:211], v2, s[52:55], s11 offen offset:0 sc1
    v_mfma_f32_16x16x32_bf16 v[104:107], v[212:215], a[72:75], v[104:107]
    ds_write_b128 v9, v[36:39] offset:0
    v_mfma_f32_16x16x32_bf16 v[108:111], v[212:215], a[76:79], v[108:111]
    v_fmac_f32 v55, v16, v43
    v_mul_f32 v28, v52, v52
    v_mfma_f32_16x16x32_bf16 v[80:83], v[216:219], a[80:83], v[80:83]
    v_mul_f32 v29, v53, v53
    v_mul_f32 v30, v54, v54
    v_mfma_f32_16x16x32_bf16 v[84:87], v[216:219], a[84:87], v[84:87]
    buffer_load_dwordx4 v[212:215], v3, s[52:55], s11 offen offset:0 sc1
    v_mul_f32 v31, v55, v55
    v_fma_f32 v28, v28, v18, v17
    v_mfma_f32_16x16x32_bf16 v[88:91], v[216:219], a[88:91], v[88:91]
    v_fma_f32 v29, v29, v18, v17
    v_fma_f32 v30, v30, v18, v17
    v_fma_f32 v31, v31, v18, v17
    v_mfma_f32_16x16x32_bf16 v[92:95], v[216:219], a[92:95], v[92:95]
    v_mul_f32 v28, v52, v28
    v_mul_f32 v29, v53, v29
    v_mul_f32 v30, v54, v30
    v_mfma_f32_16x16x32_bf16 v[96:99], v[220:223], a[80:83], v[96:99]
    v_mul_f32 v31, v55, v31
    v_exp_f32 v28, v28
    v_mfma_f32_16x16x32_bf16 v[100:103], v[220:223], a[84:87], v[100:103]
    buffer_load_dwordx4 v[216:219], v2, s[52:55], s11 offen offset:1024 sc1
    v_exp_f32 v29, v29
    v_mfma_f32_16x16x32_bf16 v[104:107], v[220:223], a[88:91], v[104:107]
    v_exp_f32 v30, v30
    v_mfma_f32_16x16x32_bf16 v[108:111], v[220:223], a[92:95], v[108:111]
    v_exp_f32 v31, v31
    s_waitcnt vmcnt(11)
    v_mfma_f32_16x16x32_bf16 v[80:83], v[160:163], a[96:99], v[80:83]
    v_fma_f32 v28, v28, v19, v19
    v_fma_f32 v29, v29, v19, v19
    v_mfma_f32_16x16x32_bf16 v[84:87], v[160:163], a[100:103], v[84:87]
    buffer_load_dwordx4 v[220:223], v3, s[52:55], s11 offen offset:1024 sc1
    v_fma_f32 v30, v30, v19, v19
    v_fma_f32 v31, v31, v19, v19
    v_mfma_f32_16x16x32_bf16 v[88:91], v[160:163], a[104:107], v[88:91]
    v_rcp_f32 v28, v28
    v_mfma_f32_16x16x32_bf16 v[92:95], v[160:163], a[108:111], v[92:95]
    v_rcp_f32 v29, v29
    v_mfma_f32_16x16x32_bf16 v[96:99], v[164:167], a[96:99], v[96:99]
    v_rcp_f32 v30, v30
    v_rcp_f32 v31, v31
    v_mfma_f32_16x16x32_bf16 v[100:103], v[164:167], a[100:103], v[100:103]
    buffer_load_dwordx4 v[160:163], v2, s[52:55], s11 offen offset:2048 sc1
    v_mul_f32 v28, v52, v28
    v_mfma_f32_16x16x32_bf16 v[104:107], v[164:167], a[104:107], v[104:107]
    v_mul_f32 v29, v53, v29
    v_mul_f32 v30, v54, v30
    v_mul_f32 v31, v55, v31
    v_mfma_f32_16x16x32_bf16 v[108:111], v[164:167], a[108:111], v[108:111]
    v_cvt_pk_bf16_f32 v36, v28, v29
    v_cvt_pk_bf16_f32 v37, v30, v31
    v_fmac_f32 v68, v16, v44
    v_mfma_f32_16x16x32_bf16 v[80:83], v[168:171], a[112:115], v[80:83]
    v_fmac_f32 v69, v16, v45
    v_fmac_f32 v70, v16, v46
    v_mfma_f32_16x16x32_bf16 v[84:87], v[168:171], a[116:119], v[84:87]
    buffer_load_dwordx4 v[164:167], v3, s[52:55], s11 offen offset:2048 sc1
    v_fmac_f32 v71, v16, v47
    v_mul_f32 v32, v68, v68
    v_mfma_f32_16x16x32_bf16 v[88:91], v[168:171], a[120:123], v[88:91]
    v_mul_f32 v33, v69, v69
    v_mul_f32 v34, v70, v70
    v_mul_f32 v35, v71, v71
    v_mfma_f32_16x16x32_bf16 v[92:95], v[168:171], a[124:127], v[92:95]
    v_fma_f32 v32, v32, v18, v17
    v_fma_f32 v33, v33, v18, v17
    v_mfma_f32_16x16x32_bf16 v[96:99], v[172:175], a[112:115], v[96:99]
    v_fma_f32 v34, v34, v18, v17
    v_fma_f32 v35, v35, v18, v17
    v_mul_f32 v32, v68, v32
    v_mfma_f32_16x16x32_bf16 v[100:103], v[172:175], a[116:119], v[100:103]
    buffer_load_dwordx4 v[168:171], v2, s[52:55], s11 offen offset:3072 sc1
    v_mul_f32 v33, v69, v33
    v_mul_f32 v34, v70, v34
    v_mfma_f32_16x16x32_bf16 v[104:107], v[172:175], a[120:123], v[104:107]
    v_mul_f32 v35, v71, v35
    v_exp_f32 v32, v32
    v_mfma_f32_16x16x32_bf16 v[108:111], v[172:175], a[124:127], v[108:111]
    v_exp_f32 v33, v33
    s_waitcnt vmcnt(11)
    v_mfma_f32_16x16x32_bf16 v[80:83], v[176:179], a[128:131], v[80:83]
    v_exp_f32 v34, v34
    v_mfma_f32_16x16x32_bf16 v[84:87], v[176:179], a[132:135], v[84:87]
    buffer_load_dwordx4 v[172:175], v3, s[52:55], s11 offen offset:3072 sc1
    v_exp_f32 v35, v35
    v_mfma_f32_16x16x32_bf16 v[88:91], v[176:179], a[136:139], v[88:91]
    v_fma_f32 v32, v32, v19, v19
    v_fma_f32 v33, v33, v19, v19
    v_mfma_f32_16x16x32_bf16 v[92:95], v[176:179], a[140:143], v[92:95]
    v_fma_f32 v34, v34, v19, v19
    v_fma_f32 v35, v35, v19, v19
    v_mfma_f32_16x16x32_bf16 v[96:99], v[180:183], a[128:131], v[96:99]
    v_rcp_f32 v32, v32
    v_rcp_f32 v33, v33
    v_mfma_f32_16x16x32_bf16 v[100:103], v[180:183], a[132:135], v[100:103]
    s_add_u32 s11, s8, 53248
    buffer_load_dwordx4 v[176:179], v2, s[52:55], s11 offen offset:0 sc1
    v_mfma_f32_16x16x32_bf16 v[104:107], v[180:183], a[136:139], v[104:107]
    v_rcp_f32 v34, v34
    v_mfma_f32_16x16x32_bf16 v[108:111], v[180:183], a[140:143], v[108:111]
    v_rcp_f32 v35, v35
    v_mul_f32 v32, v68, v32
    v_mul_f32 v33, v69, v33
    v_mfma_f32_16x16x32_bf16 v[80:83], v[184:187], a[144:147], v[80:83]
    v_mul_f32 v34, v70, v34
    v_mul_f32 v35, v71, v35
    v_mfma_f32_16x16x32_bf16 v[84:87], v[184:187], a[148:151], v[84:87]
    buffer_load_dwordx4 v[180:183], v3, s[52:55], s11 offen offset:0 sc1
    v_cvt_pk_bf16_f32 v38, v32, v33
    v_cvt_pk_bf16_f32 v39, v34, v35
    v_mfma_f32_16x16x32_bf16 v[88:91], v[184:187], a[152:155], v[88:91]
    v_fmac_f32 v56, v20, v40
    v_fmac_f32 v57, v20, v41
    v_fmac_f32 v58, v20, v42
    v_mfma_f32_16x16x32_bf16 v[92:95], v[184:187], a[156:159], v[92:95]
    ds_write_b128 v9, v[36:39] offset:1024
    v_mfma_f32_16x16x32_bf16 v[96:99], v[188:191], a[144:147], v[96:99]
    v_fmac_f32 v59, v20, v43
    v_mul_f32 v28, v56, v56
    v_mfma_f32_16x16x32_bf16 v[100:103], v[188:191], a[148:151], v[100:103]
    buffer_load_dwordx4 v[184:187], v2, s[52:55], s11 offen offset:1024 sc1
    v_mul_f32 v29, v57, v57
    v_mfma_f32_16x16x32_bf16 v[104:107], v[188:191], a[152:155], v[104:107]
    v_mul_f32 v30, v58, v58
    v_mul_f32 v31, v59, v59
    v_mfma_f32_16x16x32_bf16 v[108:111], v[188:191], a[156:159], v[108:111]
    v_fma_f32 v28, v28, v22, v21
    v_fma_f32 v29, v29, v22, v21
    v_fma_f32 v30, v30, v22, v21
    s_waitcnt vmcnt(11)
    v_mfma_f32_16x16x32_bf16 v[80:83], v[192:195], a[160:163], v[80:83]
    v_fma_f32 v31, v31, v22, v21
    v_mul_f32 v28, v56, v28
    v_mfma_f32_16x16x32_bf16 v[84:87], v[192:195], a[164:167], v[84:87]
    buffer_load_dwordx4 v[188:191], v3, s[52:55], s11 offen offset:1024 sc1
    v_mul_f32 v29, v57, v29
    v_mul_f32 v30, v58, v30
    v_mfma_f32_16x16x32_bf16 v[88:91], v[192:195], a[168:171], v[88:91]
    v_mul_f32 v31, v59, v31
    v_exp_f32 v28, v28
    v_mfma_f32_16x16x32_bf16 v[92:95], v[192:195], a[172:175], v[92:95]
    v_exp_f32 v29, v29
    v_mfma_f32_16x16x32_bf16 v[96:99], v[196:199], a[160:163], v[96:99]
    v_exp_f32 v30, v30
    v_mfma_f32_16x16x32_bf16 v[100:103], v[196:199], a[164:167], v[100:103]
    s_add_u32 s11, s8, 73728
    buffer_load_dwordx4 v[192:195], v2, s[52:55], s11 offen offset:0 sc1
    v_mfma_f32_16x16x32_bf16 v[104:107], v[196:199], a[168:171], v[104:107]
    v_exp_f32 v31, v31
    v_fma_f32 v28, v28, v23, v23
    v_fma_f32 v29, v29, v23, v23
    v_mfma_f32_16x16x32_bf16 v[108:111], v[196:199], a[172:175], v[108:111]
    v_fma_f32 v30, v30, v23, v23
    v_fma_f32 v31, v31, v23, v23
    v_mfma_f32_16x16x32_bf16 v[80:83], v[200:203], a[176:179], v[80:83]
    v_rcp_f32 v28, v28
    v_mfma_f32_16x16x32_bf16 v[84:87], v[200:203], a[180:183], v[84:87]
    buffer_load_dwordx4 v[196:199], v3, s[52:55], s11 offen offset:0 sc1
    v_rcp_f32 v29, v29
    v_mfma_f32_16x16x32_bf16 v[88:91], v[200:203], a[184:187], v[88:91]
    v_rcp_f32 v30, v30
    v_mfma_f32_16x16x32_bf16 v[92:95], v[200:203], a[188:191], v[92:95]
    v_rcp_f32 v31, v31
    v_mul_f32 v28, v56, v28
    v_mul_f32 v29, v57, v29
    v_mfma_f32_16x16x32_bf16 v[96:99], v[204:207], a[176:179], v[96:99]
    v_mul_f32 v30, v58, v30
    v_mul_f32 v31, v59, v31
    v_mfma_f32_16x16x32_bf16 v[100:103], v[204:207], a[180:183], v[100:103]
    buffer_load_dwordx4 v[200:203], v2, s[52:55], s11 offen offset:1024 sc1
    v_cvt_pk_bf16_f32 v36, v28, v29
    v_cvt_pk_bf16_f32 v37, v30, v31
    v_mfma_f32_16x16x32_bf16 v[104:107], v[204:207], a[184:187], v[104:107]
    v_fmac_f32 v72, v20, v44
    v_fmac_f32 v73, v20, v45
    v_fmac_f32 v74, v20, v46
    v_mfma_f32_16x16x32_bf16 v[108:111], v[204:207], a[188:191], v[108:111]
    v_fmac_f32 v75, v20, v47
    v_mul_f32 v32, v72, v72
    s_waitcnt vmcnt(11)
    v_mfma_f32_16x16x32_bf16 v[80:83], v[208:211], a[192:195], v[80:83]
    v_mul_f32 v33, v73, v73
    v_mul_f32 v34, v74, v74
    v_mfma_f32_16x16x32_bf16 v[84:87], v[208:211], a[196:199], v[84:87]
    buffer_load_dwordx4 v[204:207], v3, s[52:55], s11 offen offset:1024 sc1
    v_mul_f32 v35, v75, v75
    v_fma_f32 v32, v32, v22, v21
    v_mfma_f32_16x16x32_bf16 v[88:91], v[208:211], a[200:203], v[88:91]
    v_fma_f32 v33, v33, v22, v21
    v_fma_f32 v34, v34, v22, v21
    v_mfma_f32_16x16x32_bf16 v[92:95], v[208:211], a[204:207], v[92:95]
    v_fma_f32 v35, v35, v22, v21
    v_mul_f32 v32, v72, v32
    v_mul_f32 v33, v73, v33
    v_mfma_f32_16x16x32_bf16 v[96:99], v[212:215], a[192:195], v[96:99]
    v_mul_f32 v34, v74, v34
    v_mul_f32 v35, v75, v35
    v_mfma_f32_16x16x32_bf16 v[100:103], v[212:215], a[196:199], v[100:103]
    buffer_load_dwordx4 v[208:211], v2, s[52:55], s11 offen offset:2048 sc1
    v_exp_f32 v32, v32
    v_mfma_f32_16x16x32_bf16 v[104:107], v[212:215], a[200:203], v[104:107]
    v_exp_f32 v33, v33
    v_mfma_f32_16x16x32_bf16 v[108:111], v[212:215], a[204:207], v[108:111]
    v_exp_f32 v34, v34
    v_exp_f32 v35, v35
    v_mfma_f32_16x16x32_bf16 v[80:83], v[216:219], a[208:211], v[80:83]
    v_fma_f32 v32, v32, v23, v23
    v_fma_f32 v33, v33, v23, v23
    v_mfma_f32_16x16x32_bf16 v[84:87], v[216:219], a[212:215], v[84:87]
    buffer_load_dwordx4 v[212:215], v3, s[52:55], s11 offen offset:2048 sc1
    v_fma_f32 v34, v34, v23, v23
    v_fma_f32 v35, v35, v23, v23
    v_mfma_f32_16x16x32_bf16 v[88:91], v[216:219], a[216:219], v[88:91]
    v_rcp_f32 v32, v32
    v_mfma_f32_16x16x32_bf16 v[92:95], v[216:219], a[220:223], v[92:95]
    v_rcp_f32 v33, v33
    v_mfma_f32_16x16x32_bf16 v[96:99], v[220:223], a[208:211], v[96:99]
    v_rcp_f32 v34, v34
    v_rcp_f32 v35, v35
    v_mfma_f32_16x16x32_bf16 v[100:103], v[220:223], a[212:215], v[100:103]
    buffer_load_dwordx4 v[216:219], v2, s[52:55], s11 offen offset:3072 sc1
    v_mul_f32 v32, v72, v32
    v_mfma_f32_16x16x32_bf16 v[104:107], v[220:223], a[216:219], v[104:107]
    v_mul_f32 v33, v73, v33
    v_mul_f32 v34, v74, v34
    v_mul_f32 v35, v75, v35
    v_mfma_f32_16x16x32_bf16 v[108:111], v[220:223], a[220:223], v[108:111]
    v_cvt_pk_bf16_f32 v38, v32, v33
    v_cvt_pk_bf16_f32 v39, v34, v35
    s_waitcnt vmcnt(11)
    v_mfma_f32_16x16x32_bf16 v[80:83], v[160:163], a[224:227], v[80:83]
    v_fmac_f32 v60, v24, v40
    v_fmac_f32 v61, v24, v41
    v_mfma_f32_16x16x32_bf16 v[84:87], v[160:163], a[228:231], v[84:87]
    buffer_load_dwordx4 v[220:223], v3, s[52:55], s11 offen offset:3072 sc1
    ds_write_b128 v9, v[36:39] offset:2048
    v_mfma_f32_16x16x32_bf16 v[88:91], v[160:163], a[232:235], v[88:91]
    v_fmac_f32 v62, v24, v42
    v_fmac_f32 v63, v24, v43
    v_mfma_f32_16x16x32_bf16 v[92:95], v[160:163], a[236:239], v[92:95]
    v_mul_f32 v28, v60, v60
    v_mul_f32 v29, v61, v61
    v_mfma_f32_16x16x32_bf16 v[96:99], v[164:167], a[224:227], v[96:99]
    v_mul_f32 v30, v62, v62
    v_mul_f32 v31, v63, v63
    v_mfma_f32_16x16x32_bf16 v[100:103], v[164:167], a[228:231], v[100:103]
    s_add_u32 s11, s8, 77824
    buffer_load_dwordx4 v[160:163], v2, s[52:55], s11 offen offset:0 sc1
    v_fma_f32 v28, v28, v26, v25
    v_mfma_f32_16x16x32_bf16 v[104:107], v[164:167], a[232:235], v[104:107]
    v_fma_f32 v29, v29, v26, v25
    v_fma_f32 v30, v30, v26, v25
    v_fma_f32 v31, v31, v26, v25
    v_mfma_f32_16x16x32_bf16 v[108:111], v[164:167], a[236:239], v[108:111]
    v_mul_f32 v28, v60, v28
    v_mul_f32 v29, v61, v29
    v_mfma_f32_16x16x32_bf16 v[80:83], v[168:171], a[240:243], v[80:83]
    v_mul_f32 v30, v62, v30
    v_mul_f32 v31, v63, v31
    v_mfma_f32_16x16x32_bf16 v[84:87], v[168:171], a[244:247], v[84:87]
    buffer_load_dwordx4 v[164:167], v3, s[52:55], s11 offen offset:0 sc1
    v_exp_f32 v28, v28
    v_mfma_f32_16x16x32_bf16 v[88:91], v[168:171], a[248:251], v[88:91]
    v_exp_f32 v29, v29
    v_mfma_f32_16x16x32_bf16 v[92:95], v[168:171], a[252:255], v[92:95]
    v_exp_f32 v30, v30
    v_exp_f32 v31, v31
    v_mfma_f32_16x16x32_bf16 v[96:99], v[172:175], a[240:243], v[96:99]
    v_fma_f32 v28, v28, v27, v27
    v_fma_f32 v29, v29, v27, v27
    v_mfma_f32_16x16x32_bf16 v[100:103], v[172:175], a[244:247], v[100:103]
    buffer_load_dwordx4 v[168:171], v2, s[52:55], s11 offen offset:1024 sc1
    v_fma_f32 v30, v30, v27, v27
    v_fma_f32 v31, v31, v27, v27
    v_mfma_f32_16x16x32_bf16 v[104:107], v[172:175], a[248:251], v[104:107]
    v_rcp_f32 v28, v28
    v_mfma_f32_16x16x32_bf16 v[108:111], v[172:175], a[252:255], v[108:111]
    v_rcp_f32 v29, v29
    s_waitcnt vmcnt(11)
    v_mfma_f32_16x16x32_bf16 v[80:83], v[176:179], v[224:227], v[80:83]
    v_rcp_f32 v30, v30
    v_mfma_f32_16x16x32_bf16 v[84:87], v[176:179], v[228:231], v[84:87]
    buffer_load_dwordx4 v[172:175], v3, s[52:55], s11 offen offset:1024 sc1
    v_rcp_f32 v31, v31
    v_mul_f32 v28, v60, v28
    v_mfma_f32_16x16x32_bf16 v[88:91], v[176:179], v[232:235], v[88:91]
    v_mul_f32 v29, v61, v29
    v_mul_f32 v30, v62, v30
    v_mfma_f32_16x16x32_bf16 v[92:95], v[176:179], v[236:239], v[92:95]
    v_mul_f32 v31, v63, v31
    v_cvt_pk_bf16_f32 v36, v28, v29
    v_cvt_pk_bf16_f32 v37, v30, v31
    v_mfma_f32_16x16x32_bf16 v[96:99], v[180:183], v[224:227], v[96:99]
    v_fmac_f32 v76, v24, v44
    v_fmac_f32 v77, v24, v45
    v_fmac_f32 v78, v24, v46
    v_mfma_f32_16x16x32_bf16 v[100:103], v[180:183], v[228:231], v[100:103]
    buffer_load_dwordx4 v[176:179], v2, s[52:55], s11 offen offset:2048 sc1
    v_fmac_f32 v79, v24, v47
    v_mfma_f32_16x16x32_bf16 v[104:107], v[180:183], v[232:235], v[104:107]
    v_mul_f32 v32, v76, v76
    v_mul_f32 v33, v77, v77
    v_mul_f32 v34, v78, v78
    v_mfma_f32_16x16x32_bf16 v[108:111], v[180:183], v[236:239], v[108:111]
    v_mul_f32 v35, v79, v79
    v_fma_f32 v32, v32, v26, v25
    v_fma_f32 v33, v33, v26, v25
    v_mfma_f32_16x16x32_bf16 v[80:83], v[184:187], v[240:243], v[80:83]
    v_fma_f32 v34, v34, v26, v25
    v_fma_f32 v35, v35, v26, v25
    v_mfma_f32_16x16x32_bf16 v[84:87], v[184:187], v[244:247], v[84:87]
    buffer_load_dwordx4 v[180:183], v3, s[52:55], s11 offen offset:2048 sc1
    v_mul_f32 v32, v76, v32
    v_mul_f32 v33, v77, v33
    v_mfma_f32_16x16x32_bf16 v[88:91], v[184:187], v[248:251], v[88:91]
    v_mul_f32 v34, v78, v34
    v_mul_f32 v35, v79, v35
    v_mfma_f32_16x16x32_bf16 v[92:95], v[184:187], v[252:255], v[92:95]
    v_exp_f32 v32, v32
    v_exp_f32 v33, v33
    v_mfma_f32_16x16x32_bf16 v[96:99], v[188:191], v[240:243], v[96:99]
    v_exp_f32 v34, v34
    v_mfma_f32_16x16x32_bf16 v[100:103], v[188:191], v[244:247], v[100:103]
    buffer_load_dwordx4 v[184:187], v2, s[52:55], s11 offen offset:3072 sc1
    v_exp_f32 v35, v35
    v_mfma_f32_16x16x32_bf16 v[104:107], v[188:191], v[248:251], v[104:107]
    v_fma_f32 v32, v32, v27, v27
    v_fma_f32 v33, v33, v27, v27
    v_fma_f32 v34, v34, v27, v27
    v_mfma_f32_16x16x32_bf16 v[108:111], v[188:191], v[252:255], v[108:111]
    v_fma_f32 v35, v35, v27, v27
    v_rcp_f32 v32, v32
    s_waitcnt vmcnt(11)
    v_mfma_f32_16x16x32_bf16 v[112:115], v[192:195], a[0:3], v[112:115]
    v_rcp_f32 v33, v33
    v_mfma_f32_16x16x32_bf16 v[116:119], v[192:195], a[4:7], v[116:119]
    buffer_load_dwordx4 v[188:191], v3, s[52:55], s11 offen offset:3072 sc1
    v_rcp_f32 v34, v34
    v_mfma_f32_16x16x32_bf16 v[120:123], v[192:195], a[8:11], v[120:123]
    v_rcp_f32 v35, v35
    v_mfma_f32_16x16x32_bf16 v[124:127], v[192:195], a[12:15], v[124:127]
    v_mul_f32 v32, v76, v32
    v_mul_f32 v33, v77, v33
    v_mfma_f32_16x16x32_bf16 v[128:131], v[196:199], a[0:3], v[128:131]
    v_mul_f32 v34, v78, v34
    v_mul_f32 v35, v79, v35
    v_cvt_pk_bf16_f32 v38, v32, v33
    v_mfma_f32_16x16x32_bf16 v[132:135], v[196:199], a[4:7], v[132:135]
    s_add_u32 s11, s8, 81920
    buffer_load_dwordx4 v[192:195], v2, s[52:55], s11 offen offset:0 sc1
    v_cvt_pk_bf16_f32 v39, v34, v35
    v_mfma_f32_16x16x32_bf16 v[136:139], v[196:199], a[8:11], v[136:139]
    s_lshr_b32 s99, s5, 4
    s_lshl_b32 s99, s99, 11
    v_mfma_f32_16x16x32_bf16 v[140:143], v[196:199], a[12:15], v[140:143]
    ds_write_b128 v9, v[36:39] offset:3072
    v_mfma_f32_16x16x32_bf16 v[112:115], v[200:203], a[16:19], v[112:115]
    ds_read_b128 v[40:43], v11 offset:384
    ds_read_b128 v[44:47], v11 offset:448
    v_mfma_f32_16x16x32_bf16 v[116:119], v[200:203], a[20:23], v[116:119]
    buffer_load_dwordx4 v[196:199], v3, s[52:55], s11 offen offset:0 sc1
    s_lshl_b32 s6, s4, 2
    v_mfma_f32_16x16x32_bf16 v[120:123], v[200:203], a[24:27], v[120:123]
    s_add_u32 s6, s6, s3
    s_lshl_b32 s6, s6, 6
    s_add_u32 s99, s99, s6
    v_mfma_f32_16x16x32_bf16 v[124:127], v[200:203], a[28:31], v[124:127]
    s_add_u32 s99, s99, 0x4000
    s_lshr_b32 s94, s5, 3
    s_lshl_b32 s94, s94, 8
    v_mfma_f32_16x16x32_bf16 v[128:131], v[204:207], a[16:19], v[128:131]
    s_lshr_b32 s6, s4, 1
    s_lshl_b32 s6, s6, 6
    v_mfma_f32_16x16x32_bf16 v[132:135], v[204:207], a[20:23], v[132:135]
    buffer_load_dwordx4 v[200:203], v2, s[52:55], s11 offen offset:1024 sc1
    s_add_u32 s94, s94, s6
    s_add_u32 s94, s94, 0x5000
    v_mfma_f32_16x16x32_bf16 v[136:139], v[204:207], a[24:27], v[136:139]
    s_sub_u32 s94, s94, s99
    v_bfe_u32 v4, v1, 4, 1
    v_mul_lo_u32 v4, v4, s94
    v_mfma_f32_16x16x32_bf16 v[140:143], v[204:207], a[28:31], v[140:143]
    v_and_b32 v5, 15, v1
    v_lshl_add_u32 v5, v5, 2, v4
    buffer_load_dword v0, v5, s[68:71], s99 offen sc1
    v_mul_f32 v28, v80, v80
    s_waitcnt vmcnt(12)
    v_mfma_f32_16x16x32_bf16 v[112:115], v[208:211], a[32:35], v[112:115]
    s_waitcnt lgkmcnt(2)
    s_barrier
    v_mfma_f32_16x16x32_bf16 v[116:119], v[208:211], a[36:39], v[116:119]
    buffer_load_dwordx4 v[204:207], v3, s[52:55], s11 offen offset:1024 sc1
    v_mul_f32 v29, v81, v81
    v_mfma_f32_16x16x32_bf16 v[120:123], v[208:211], a[40:43], v[120:123]
    v_mul_f32 v30, v82, v82
    v_mul_f32 v31, v83, v83
    v_fma_f32 v28, v28, v14, v13
    v_mfma_f32_16x16x32_bf16 v[124:127], v[208:211], a[44:47], v[124:127]
    v_fma_f32 v29, v29, v14, v13
    v_fma_f32 v30, v30, v14, v13
    v_mfma_f32_16x16x32_bf16 v[128:131], v[212:215], a[32:35], v[128:131]
    v_fma_f32 v31, v31, v14, v13
    v_mul_f32 v28, v80, v28
    v_mul_f32 v29, v81, v29
    v_mfma_f32_16x16x32_bf16 v[132:135], v[212:215], a[36:39], v[132:135]
    buffer_load_dwordx4 v[208:211], v2, s[52:55], s11 offen offset:2048 sc1
    v_mul_f32 v30, v82, v30
    v_mul_f32 v31, v83, v31
    v_mfma_f32_16x16x32_bf16 v[136:139], v[212:215], a[40:43], v[136:139]
    v_exp_f32 v28, v28
    v_mfma_f32_16x16x32_bf16 v[140:143], v[212:215], a[44:47], v[140:143]
    v_exp_f32 v29, v29
    v_mfma_f32_16x16x32_bf16 v[112:115], v[216:219], a[48:51], v[112:115]
    v_exp_f32 v30, v30
    v_exp_f32 v31, v31
    v_mfma_f32_16x16x32_bf16 v[116:119], v[216:219], a[52:55], v[116:119]
    buffer_load_dwordx4 v[212:215], v3, s[52:55], s11 offen offset:2048 sc1
    v_fma_f32 v28, v28, v15, v15
    v_mfma_f32_16x16x32_bf16 v[120:123], v[216:219], a[56:59], v[120:123]
    v_fma_f32 v29, v29, v15, v15
    v_fma_f32 v30, v30, v15, v15
    v_fma_f32 v31, v31, v15, v15
    v_mfma_f32_16x16x32_bf16 v[124:127], v[216:219], a[60:63], v[124:127]
    v_rcp_f32 v28, v28
    v_mfma_f32_16x16x32_bf16 v[128:131], v[220:223], a[48:51], v[128:131]
    v_rcp_f32 v29, v29
    v_mfma_f32_16x16x32_bf16 v[132:135], v[220:223], a[52:55], v[132:135]
    buffer_load_dwordx4 v[216:219], v2, s[52:55], s11 offen offset:3072 sc1
    v_rcp_f32 v30, v30
    v_mfma_f32_16x16x32_bf16 v[136:139], v[220:223], a[56:59], v[136:139]
    v_rcp_f32 v31, v31
    v_mul_f32 v28, v80, v28
    v_mfma_f32_16x16x32_bf16 v[140:143], v[220:223], a[60:63], v[140:143]
    v_mul_f32 v29, v81, v29
    v_mul_f32 v30, v82, v30
    v_mul_f32 v31, v83, v31
    s_waitcnt vmcnt(12)
    v_mfma_f32_16x16x32_bf16 v[112:115], v[160:163], a[64:67], v[112:115]
    v_cvt_pk_bf16_f32 v36, v28, v29
    v_cvt_pk_bf16_f32 v37, v30, v31
    v_mfma_f32_16x16x32_bf16 v[116:119], v[160:163], a[68:71], v[116:119]
    buffer_load_dwordx4 v[220:223], v3, s[52:55], s11 offen offset:3072 sc1
    v_mul_f32 v32, v96, v96
    v_mfma_f32_16x16x32_bf16 v[120:123], v[160:163], a[72:75], v[120:123]
    v_mul_f32 v33, v97, v97
    v_mul_f32 v34, v98, v98
    v_mul_f32 v35, v99, v99
    v_mfma_f32_16x16x32_bf16 v[124:127], v[160:163], a[76:79], v[124:127]
    v_fma_f32 v32, v32, v14, v13
    v_fma_f32 v33, v33, v14, v13
    v_fma_f32 v34, v34, v14, v13
    v_mfma_f32_16x16x32_bf16 v[128:131], v[164:167], a[64:67], v[128:131]
    v_fma_f32 v35, v35, v14, v13
    v_mul_f32 v32, v96, v32
    v_mfma_f32_16x16x32_bf16 v[132:135], v[164:167], a[68:71], v[132:135]
    s_add_u32 s11, s8, 86016
    buffer_load_dwordx4 v[160:163], v2, s[52:55], s11 offen offset:0 sc1
    v_mul_f32 v33, v97, v33
    v_mfma_f32_16x16x32_bf16 v[136:139], v[164:167], a[72:75], v[136:139]
    v_mul_f32 v34, v98, v34
    v_mul_f32 v35, v99, v35
    v_mfma_f32_16x16x32_bf16 v[140:143], v[164:167], a[76:79], v[140:143]
    v_exp_f32 v32, v32
    v_exp_f32 v33, v33
    v_mfma_f32_16x16x32_bf16 v[112:115], v[168:171], a[80:83], v[112:115]
    v_exp_f32 v34, v34
    v_mfma_f32_16x16x32_bf16 v[116:119], v[168:171], a[84:87], v[116:119]
    buffer_load_dwordx4 v[164:167], v3, s[52:55], s11 offen offset:0 sc1
    v_exp_f32 v35, v35
    v_mfma_f32_16x16x32_bf16 v[120:123], v[168:171], a[88:91], v[120:123]
    v_fma_f32 v32, v32, v15, v15
    v_fma_f32 v33, v33, v15, v15
    v_fma_f32 v34, v34, v15, v15
    v_mfma_f32_16x16x32_bf16 v[124:127], v[168:171], a[92:95], v[124:127]
    v_fma_f32 v35, v35, v15, v15
    v_rcp_f32 v32, v32
    v_mfma_f32_16x16x32_bf16 v[128:131], v[172:175], a[80:83], v[128:131]
    v_rcp_f32 v33, v33
    v_mfma_f32_16x16x32_bf16 v[132:135], v[172:175], a[84:87], v[132:135]
    buffer_load_dwordx4 v[168:171], v2, s[52:55], s11 offen offset:1024 sc1
    v_rcp_f32 v34, v34
    v_mfma_f32_16x16x32_bf16 v[136:139], v[172:175], a[88:91], v[136:139]
    v_rcp_f32 v35, v35
    v_mfma_f32_16x16x32_bf16 v[140:143], v[172:175], a[92:95], v[140:143]
    v_mul_f32 v32, v96, v32
    v_mul_f32 v33, v97, v33
    v_mul_f32 v34, v98, v34
    s_waitcnt vmcnt(12)
    v_mfma_f32_16x16x32_bf16 v[112:115], v[176:179], a[96:99], v[112:115]
    v_mul_f32 v35, v99, v35
    v_cvt_pk_bf16_f32 v38, v32, v33
    v_mfma_f32_16x16x32_bf16 v[116:119], v[176:179], a[100:103], v[116:119]
    buffer_load_dwordx4 v[172:175], v3, s[52:55], s11 offen offset:1024 sc1
    v_cvt_pk_bf16_f32 v39, v34, v35
    v_mfma_f32_16x16x32_bf16 v[120:123], v[176:179], a[104:107], v[120:123]
    v_mul_f32 v28, v84, v84
    v_mul_f32 v29, v85, v85
    v_mul_f32 v30, v86, v86
    v_mfma_f32_16x16x32_bf16 v[124:127], v[176:179], a[108:111], v[124:127]
    ds_write_b128 v9, v[36:39] offset:16384
    v_mfma_f32_16x16x32_bf16 v[128:131], v[180:183], a[96:99], v[128:131]
    v_mul_f32 v31, v87, v87
    v_fma_f32 v28, v28, v18, v17
    v_mfma_f32_16x16x32_bf16 v[132:135], v[180:183], a[100:103], v[132:135]
    buffer_load_dwordx4 v[176:179], v2, s[52:55], s11 offen offset:2048 sc1
    v_fma_f32 v29, v29, v18, v17
    v_mfma_f32_16x16x32_bf16 v[136:139], v[180:183], a[104:107], v[136:139]
    v_fma_f32 v30, v30, v18, v17
    v_fma_f32 v31, v31, v18, v17
    v_mul_f32 v28, v84, v28
    v_mfma_f32_16x16x32_bf16 v[140:143], v[180:183], a[108:111], v[140:143]
    v_mul_f32 v29, v85, v29
    v_mul_f32 v30, v86, v30
    v_mul_f32 v31, v87, v31
    v_mfma_f32_16x16x32_bf16 v[112:115], v[184:187], a[112:115], v[112:115]
    v_exp_f32 v28, v28
    v_mfma_f32_16x16x32_bf16 v[116:119], v[184:187], a[116:119], v[116:119]
    buffer_load_dwordx4 v[180:183], v3, s[52:55], s11 offen offset:2048 sc1
    v_exp_f32 v29, v29
    v_mfma_f32_16x16x32_bf16 v[120:123], v[184:187], a[120:123], v[120:123]
    v_exp_f32 v30, v30
    v_mfma_f32_16x16x32_bf16 v[124:127], v[184:187], a[124:127], v[124:127]
    v_exp_f32 v31, v31
    v_fma_f32 v28, v28, v19, v19
    v_fma_f32 v29, v29, v19, v19
    v_mfma_f32_16x16x32_bf16 v[128:131], v[188:191], a[112:115], v[128:131]
    v_fma_f32 v30, v30, v19, v19
    v_fma_f32 v31, v31, v19, v19
    v_mfma_f32_16x16x32_bf16 v[132:135], v[188:191], a[116:119], v[132:135]
    buffer_load_dwordx4 v[184:187], v2, s[52:55], s11 offen offset:3072 sc1
    v_rcp_f32 v28, v28
    v_mfma_f32_16x16x32_bf16 v[136:139], v[188:191], a[120:123], v[136:139]
    v_rcp_f32 v29, v29
    v_mfma_f32_16x16x32_bf16 v[140:143], v[188:191], a[124:127], v[140:143]
    v_rcp_f32 v30, v30
    s_waitcnt vmcnt(11)
    v_mfma_f32_16x16x32_bf16 v[112:115], v[192:195], a[128:131], v[112:115]
    v_rcp_f32 v31, v31
    v_mul_f32 v28, v84, v28
    v_mfma_f32_16x16x32_bf16 v[116:119], v[192:195], a[132:135], v[116:119]
    buffer_load_dwordx4 v[188:191], v3, s[52:55], s11 offen offset:3072 sc1
    v_mul_f32 v29, v85, v29
    v_mul_f32 v30, v86, v30
    v_mfma_f32_16x16x32_bf16 v[120:123], v[192:195], a[136:139], v[120:123]
    v_mul_f32 v31, v87, v31
    v_cvt_pk_bf16_f32 v36, v28, v29
    v_mfma_f32_16x16x32_bf16 v[124:127], v[192:195], a[140:143], v[124:127]
    v_cvt_pk_bf16_f32 v37, v30, v31
    v_mul_f32 v32, v100, v100
    v_mul_f32 v33, v101, v101
    v_mfma_f32_16x16x32_bf16 v[128:131], v[196:199], a[128:131], v[128:131]
    v_mul_f32 v34, v102, v102
    v_mul_f32 v35, v103, v103
    v_fma_f32 v32, v32, v18, v17
    v_mfma_f32_16x16x32_bf16 v[132:135], v[196:199], a[132:135], v[132:135]
    s_add_u32 s11, s8, 90112
    buffer_load_dwordx4 v[192:195], v2, s[52:55], s11 offen offset:0 sc1
    v_fma_f32 v33, v33, v18, v17
    v_mfma_f32_16x16x32_bf16 v[136:139], v[196:199], a[136:139], v[136:139]
    v_fma_f32 v34, v34, v18, v17
    v_fma_f32 v35, v35, v18, v17
    v_mfma_f32_16x16x32_bf16 v[140:143], v[196:199], a[140:143], v[140:143]
    v_mul_f32 v32, v100, v32
    v_mul_f32 v33, v101, v33
    v_mul_f32 v34, v102, v34
    v_mfma_f32_16x16x32_bf16 v[112:115], v[200:203], a[144:147], v[112:115]
    v_mul_f32 v35, v103, v35
    v_exp_f32 v32, v32
    v_mfma_f32_16x16x32_bf16 v[116:119], v[200:203], a[148:151], v[116:119]
    buffer_load_dwordx4 v[196:199], v3, s[52:55], s11 offen offset:0 sc1
    v_exp_f32 v33, v33
    v_mfma_f32_16x16x32_bf16 v[120:123], v[200:203], a[152:155], v[120:123]
    v_exp_f32 v34, v34
    v_mfma_f32_16x16x32_bf16 v[124:127], v[200:203], a[156:159], v[124:127]
    v_exp_f32 v35, v35
    v_fma_f32 v32, v32, v19, v19
    v_mfma_f32_16x16x32_bf16 v[128:131], v[204:207], a[144:147], v[128:131]
    v_fma_f32 v33, v33, v19, v19
    v_fma_f32 v34, v34, v19, v19
    v_mfma_f32_16x16x32_bf16 v[132:135], v[204:207], a[148:151], v[132:135]
    buffer_load_dwordx4 v[200:203], v2, s[52:55], s11 offen offset:1024 sc1
    v_fma_f32 v35, v35, v19, v19
    v_mfma_f32_16x16x32_bf16 v[136:139], v[204:207], a[152:155], v[136:139]
    v_rcp_f32 v32, v32
    v_rcp_f32 v33, v33
    v_mfma_f32_16x16x32_bf16 v[140:143], v[204:207], a[156:159], v[140:143]
    v_rcp_f32 v34, v34
    s_waitcnt vmcnt(11)
    v_mfma_f32_16x16x32_bf16 v[112:115], v[208:211], a[160:163], v[112:115]
    v_rcp_f32 v35, v35
    v_mfma_f32_16x16x32_bf16 v[116:119], v[208:211], a[164:167], v[116:119]
    buffer_load_dwordx4 v[204:207], v3, s[52:55], s11 offen offset:1024 sc1
    v_mul_f32 v32, v100, v32
    v_mul_f32 v33, v101, v33
    v_mfma_f32_16x16x32_bf16 v[120:123], v[208:211], a[168:171], v[120:123]
    v_mul_f32 v34, v102, v34
    v_mul_f32 v35, v103, v35
    v_mfma_f32_16x16x32_bf16 v[124:127], v[208:211], a[172:175], v[124:127]
    v_cvt_pk_bf16_f32 v38, v32, v33
    v_cvt_pk_bf16_f32 v39, v34, v35
    v_mfma_f32_16x16x32_bf16 v[128:131], v[212:215], a[160:163], v[128:131]
    v_mul_f32 v28, v88, v88
    v_mul_f32 v29, v89, v89
    v_mul_f32 v30, v90, v90
    v_mul_f32 v31, v91, v91
    v_mfma_f32_16x16x32_bf16 v[132:135], v[212:215], a[164:167], v[132:135]
    s_add_u32 s11, s8, 110592
    buffer_load_dwordx4 v[208:211], v2, s[52:55], s11 offen offset:0 sc1
    v_mfma_f32_16x16x32_bf16 v[136:139], v[212:215], a[168:171], v[136:139]
    ds_write_b128 v9, v[36:39] offset:17408
    v_mfma_f32_16x16x32_bf16 v[140:143], v[212:215], a[172:175], v[140:143]
    v_fma_f32 v28, v28, v22, v21
    v_fma_f32 v29, v29, v22, v21
    v_mfma_f32_16x16x32_bf16 v[112:115], v[216:219], a[176:179], v[112:115]
    v_fma_f32 v30, v30, v22, v21
    v_fma_f32 v31, v31, v22, v21
    v_mfma_f32_16x16x32_bf16 v[116:119], v[216:219], a[180:183], v[116:119]
    buffer_load_dwordx4 v[212:215], v3, s[52:55], s11 offen offset:0 sc1
    v_mul_f32 v28, v88, v28
    v_mul_f32 v29, v89, v29
    v_mfma_f32_16x16x32_bf16 v[120:123], v[216:219], a[184:187], v[120:123]
    v_mul_f32 v30, v90, v30
    v_mul_f32 v31, v91, v31
    v_mfma_f32_16x16x32_bf16 v[124:127], v[216:219], a[188:191], v[124:127]
    v_exp_f32 v28, v28
    v_mfma_f32_16x16x32_bf16 v[128:131], v[220:223], a[176:179], v[128:131]
    v_exp_f32 v29, v29
    v_exp_f32 v30, v30
    v_mfma_f32_16x16x32_bf16 v[132:135], v[220:223], a[180:183], v[132:135]
    buffer_load_dwordx4 v[216:219], v2, s[52:55], s11 offen offset:1024 sc1
    v_exp_f32 v31, v31
    v_mfma_f32_16x16x32_bf16 v[136:139], v[220:223], a[184:187], v[136:139]
    v_fma_f32 v28, v28, v23, v23
    v_fma_f32 v29, v29, v23, v23
    v_mfma_f32_16x16x32_bf16 v[140:143], v[220:223], a[188:191], v[140:143]
    v_fma_f32 v30, v30, v23, v23
    v_fma_f32 v31, v31, v23, v23
    s_waitcnt vmcnt(11)
    v_mfma_f32_16x16x32_bf16 v[112:115], v[160:163], a[192:195], v[112:115]
    v_rcp_f32 v28, v28
    v_mfma_f32_16x16x32_bf16 v[116:119], v[160:163], a[196:199], v[116:119]
    buffer_load_dwordx4 v[220:223], v3, s[52:55], s11 offen offset:1024 sc1
    v_rcp_f32 v29, v29
    v_mfma_f32_16x16x32_bf16 v[120:123], v[160:163], a[200:203], v[120:123]
    v_rcp_f32 v30, v30
    v_mfma_f32_16x16x32_bf16 v[124:127], v[160:163], a[204:207], v[124:127]
    v_rcp_f32 v31, v31
    v_mul_f32 v28, v88, v28
    v_mfma_f32_16x16x32_bf16 v[128:131], v[164:167], a[192:195], v[128:131]
    v_mul_f32 v29, v89, v29
    v_mul_f32 v30, v90, v30
    v_mul_f32 v31, v91, v31
    v_mfma_f32_16x16x32_bf16 v[132:135], v[164:167], a[196:199], v[132:135]
    buffer_load_dwordx4 v[160:163], v2, s[52:55], s11 offen offset:2048 sc1
    v_cvt_pk_bf16_f32 v36, v28, v29
    v_cvt_pk_bf16_f32 v37, v30, v31
    v_mfma_f32_16x16x32_bf16 v[136:139], v[164:167], a[200:203], v[136:139]
    v_mul_f32 v32, v104, v104
    v_mul_f32 v33, v105, v105
    v_mul_f32 v34, v106, v106
    v_mfma_f32_16x16x32_bf16 v[140:143], v[164:167], a[204:207], v[140:143]
    v_mul_f32 v35, v107, v107
    v_fma_f32 v32, v32, v22, v21
    v_mfma_f32_16x16x32_bf16 v[112:115], v[168:171], a[208:211], v[112:115]
    v_fma_f32 v33, v33, v22, v21
    v_fma_f32 v34, v34, v22, v21
    v_fma_f32 v35, v35, v22, v21
    v_mfma_f32_16x16x32_bf16 v[116:119], v[168:171], a[212:215], v[116:119]
    buffer_load_dwordx4 v[164:167], v3, s[52:55], s11 offen offset:2048 sc1
    v_mul_f32 v32, v104, v32
    v_mul_f32 v33, v105, v33
    v_mfma_f32_16x16x32_bf16 v[120:123], v[168:171], a[216:219], v[120:123]
    v_mul_f32 v34, v106, v34
    v_mul_f32 v35, v107, v35
    v_mfma_f32_16x16x32_bf16 v[124:127], v[168:171], a[220:223], v[124:127]
    v_exp_f32 v32, v32
    v_mfma_f32_16x16x32_bf16 v[128:131], v[172:175], a[208:211], v[128:131]
    v_exp_f32 v33, v33
    v_exp_f32 v34, v34
    v_mfma_f32_16x16x32_bf16 v[132:135], v[172:175], a[212:215], v[132:135]
    buffer_load_dwordx4 v[168:171], v2, s[52:55], s11 offen offset:3072 sc1
    v_exp_f32 v35, v35
    v_mfma_f32_16x16x32_bf16 v[136:139], v[172:175], a[216:219], v[136:139]
    v_fma_f32 v32, v32, v23, v23
    v_fma_f32 v33, v33, v23, v23
    v_mfma_f32_16x16x32_bf16 v[140:143], v[172:175], a[220:223], v[140:143]
    v_fma_f32 v34, v34, v23, v23
    v_fma_f32 v35, v35, v23, v23
    s_waitcnt vmcnt(11)
    v_mfma_f32_16x16x32_bf16 v[112:115], v[176:179], a[224:227], v[112:115]
    v_rcp_f32 v32, v32
    v_mfma_f32_16x16x32_bf16 v[116:119], v[176:179], a[228:231], v[116:119]
    buffer_load_dwordx4 v[172:175], v3, s[52:55], s11 offen offset:3072 sc1
    v_rcp_f32 v33, v33
    v_mfma_f32_16x16x32_bf16 v[120:123], v[176:179], a[232:235], v[120:123]
    v_rcp_f32 v34, v34
    v_mfma_f32_16x16x32_bf16 v[124:127], v[176:179], a[236:239], v[124:127]
    v_rcp_f32 v35, v35
    v_mul_f32 v32, v104, v32
    v_mfma_f32_16x16x32_bf16 v[128:131], v[180:183], a[224:227], v[128:131]
    v_mul_f32 v33, v105, v33
    v_mul_f32 v34, v106, v34
    v_mul_f32 v35, v107, v35
    v_mfma_f32_16x16x32_bf16 v[132:135], v[180:183], a[228:231], v[132:135]
    s_add_u32 s11, s8, 114688
    buffer_load_dwordx4 v[176:179], v2, s[52:55], s11 offen offset:0 sc1
    v_cvt_pk_bf16_f32 v38, v32, v33
    v_mfma_f32_16x16x32_bf16 v[136:139], v[180:183], a[232:235], v[136:139]
    v_cvt_pk_bf16_f32 v39, v34, v35
    v_mul_f32 v28, v92, v92
    v_mul_f32 v29, v93, v93
    v_mfma_f32_16x16x32_bf16 v[140:143], v[180:183], a[236:239], v[140:143]
    ds_write_b128 v9, v[36:39] offset:18432
    v_mfma_f32_16x16x32_bf16 v[112:115], v[184:187], a[240:243], v[112:115]
    v_mul_f32 v30, v94, v94
    v_mul_f32 v31, v95, v95
    v_mfma_f32_16x16x32_bf16 v[116:119], v[184:187], a[244:247], v[116:119]
    buffer_load_dwordx4 v[180:183], v3, s[52:55], s11 offen offset:0 sc1
    v_fma_f32 v28, v28, v26, v25
    v_mfma_f32_16x16x32_bf16 v[120:123], v[184:187], a[248:251], v[120:123]
    v_fma_f32 v29, v29, v26, v25
    v_fma_f32 v30, v30, v26, v25
    v_mfma_f32_16x16x32_bf16 v[124:127], v[184:187], a[252:255], v[124:127]
    v_fma_f32 v31, v31, v26, v25
    v_mul_f32 v28, v92, v28
    v_mul_f32 v29, v93, v29
    v_mfma_f32_16x16x32_bf16 v[128:131], v[188:191], a[240:243], v[128:131]
    v_mul_f32 v30, v94, v30
    v_mul_f32 v31, v95, v31
    v_mfma_f32_16x16x32_bf16 v[132:135], v[188:191], a[244:247], v[132:135]
    buffer_load_dwordx4 v[184:187], v2, s[52:55], s11 offen offset:1024 sc1
    v_exp_f32 v28, v28
    v_mfma_f32_16x16x32_bf16 v[136:139], v[188:191], a[248:251], v[136:139]
    v_exp_f32 v29, v29
    v_mfma_f32_16x16x32_bf16 v[140:143], v[188:191], a[252:255], v[140:143]
    v_exp_f32 v30, v30
    v_exp_f32 v31, v31
    s_waitcnt vmcnt(11)
    v_mfma_f32_16x16x32_bf16 v[112:115], v[192:195], v[224:227], v[112:115]
    v_fma_f32 v28, v28, v27, v27
    v_fma_f32 v29, v29, v27, v27
    v_mfma_f32_16x16x32_bf16 v[116:119], v[192:195], v[228:231], v[116:119]
    buffer_load_dwordx4 v[188:191], v3, s[52:55], s11 offen offset:1024 sc1
    v_fma_f32 v30, v30, v27, v27
    v_mfma_f32_16x16x32_bf16 v[120:123], v[192:195], v[232:235], v[120:123]
    v_fma_f32 v31, v31, v27, v27
    v_rcp_f32 v28, v28
    v_mfma_f32_16x16x32_bf16 v[124:127], v[192:195], v[236:239], v[124:127]
    v_rcp_f32 v29, v29
    v_mfma_f32_16x16x32_bf16 v[128:131], v[196:199], v[224:227], v[128:131]
    v_rcp_f32 v30, v30
    v_mfma_f32_16x16x32_bf16 v[132:135], v[196:199], v[228:231], v[132:135]
    buffer_load_dwordx4 v[192:195], v2, s[52:55], s11 offen offset:2048 sc1
    v_rcp_f32 v31, v31
    v_mul_f32 v28, v92, v28
    v_mfma_f32_16x16x32_bf16 v[136:139], v[196:199], v[232:235], v[136:139]
    v_mul_f32 v29, v93, v29
    v_mul_f32 v30, v94, v30
    v_mfma_f32_16x16x32_bf16 v[140:143], v[196:199], v[236:239], v[140:143]
    v_mul_f32 v31, v95, v31
    v_cvt_pk_bf16_f32 v36, v28, v29
    v_cvt_pk_bf16_f32 v37, v30, v31
    v_mfma_f32_16x16x32_bf16 v[112:115], v[200:203], v[240:243], v[112:115]
    v_mul_f32 v32, v108, v108
    v_mul_f32 v33, v109, v109
    v_mul_f32 v34, v110, v110
    v_mfma_f32_16x16x32_bf16 v[116:119], v[200:203], v[244:247], v[116:119]
    buffer_load_dwordx4 v[196:199], v3, s[52:55], s11 offen offset:2048 sc1
    v_mul_f32 v35, v111, v111
    v_mfma_f32_16x16x32_bf16 v[120:123], v[200:203], v[248:251], v[120:123]
    v_fma_f32 v32, v32, v26, v25
    v_fma_f32 v33, v33, v26, v25
    v_fma_f32 v34, v34, v26, v25
    v_mfma_f32_16x16x32_bf16 v[124:127], v[200:203], v[252:255], v[124:127]
    v_fma_f32 v35, v35, v26, v25
    v_mul_f32 v32, v108, v32
    v_mul_f32 v33, v109, v33
    v_mfma_f32_16x16x32_bf16 v[128:131], v[204:207], v[240:243], v[128:131]
    v_mul_f32 v34, v110, v34
    v_mul_f32 v35, v111, v35
    v_mfma_f32_16x16x32_bf16 v[132:135], v[204:207], v[244:247], v[132:135]
    buffer_load_dwordx4 v[200:203], v2, s[52:55], s11 offen offset:3072 sc1
    v_exp_f32 v32, v32
    v_mfma_f32_16x16x32_bf16 v[136:139], v[204:207], v[248:251], v[136:139]
    v_exp_f32 v33, v33
    v_mfma_f32_16x16x32_bf16 v[140:143], v[204:207], v[252:255], v[140:143]
    v_exp_f32 v34, v34
    v_exp_f32 v35, v35
    s_waitcnt vmcnt(11)
    v_mfma_f32_16x16x32_bf16 v[48:51], v[208:211], a[0:3], 0
    v_fma_f32 v32, v32, v27, v27
    v_fma_f32 v33, v33, v27, v27
    v_mfma_f32_16x16x32_bf16 v[52:55], v[208:211], a[4:7], 0
    buffer_load_dwordx4 v[204:207], v3, s[52:55], s11 offen offset:3072 sc1
    v_fma_f32 v34, v34, v27, v27
    v_mfma_f32_16x16x32_bf16 v[56:59], v[208:211], a[8:11], 0
    v_fma_f32 v35, v35, v27, v27
    v_rcp_f32 v32, v32
    v_mfma_f32_16x16x32_bf16 v[60:63], v[208:211], a[12:15], 0
    v_rcp_f32 v33, v33
    v_mfma_f32_16x16x32_bf16 v[64:67], v[212:215], a[0:3], 0
    v_rcp_f32 v34, v34
    v_mfma_f32_16x16x32_bf16 v[68:71], v[212:215], a[4:7], 0
    s_add_u32 s11, s8, 118784
    buffer_load_dwordx4 v[208:211], v2, s[52:55], s11 offen offset:0 sc1
    v_rcp_f32 v35, v35
    v_mfma_f32_16x16x32_bf16 v[72:75], v[212:215], a[8:11], 0
    v_mul_f32 v32, v108, v32
    v_mul_f32 v33, v109, v33
    v_mfma_f32_16x16x32_bf16 v[76:79], v[212:215], a[12:15], 0
    v_mul_f32 v34, v110, v34
    v_mul_f32 v35, v111, v35
    v_cvt_pk_bf16_f32 v38, v32, v33
    v_mfma_f32_16x16x32_bf16 v[48:51], v[216:219], a[16:19], v[48:51]
    v_cvt_pk_bf16_f32 v39, v34, v35
    s_lshr_b32 s12, s4, 2
    s_xor_b32 s12, s12, 1
    v_mfma_f32_16x16x32_bf16 v[52:55], v[216:219], a[20:23], v[52:55]
    buffer_load_dwordx4 v[212:215], v3, s[52:55], s11 offen offset:0 sc1
    ds_write_b128 v9, v[36:39] offset:19456
    v_mfma_f32_16x16x32_bf16 v[56:59], v[216:219], a[24:27], v[56:59]
    s_lshl_b32 s12, s12, 15
    s_mul_i32 s15, s3, 5120
    v_mfma_f32_16x16x32_bf16 v[60:63], v[216:219], a[28:31], v[60:63]
    s_add_u32 s15, s15, s12
    v_lshrrev_b32 v4, 1, v1
    v_mfma_f32_16x16x32_bf16 v[64:67], v[220:223], a[16:19], v[64:67]
    v_mul_u32_u24 v4, 1152, v4
    v_and_b32 v5, 1, v1
    v_mfma_f32_16x16x32_bf16 v[68:71], v[220:223], a[20:23], v[68:71]
    buffer_load_dwordx4 v[216:219], v2, s[52:55], s11 offen offset:1024 sc1
    v_lshl_add_u32 v4, v5, 4, v4
    v_mfma_f32_16x16x32_bf16 v[72:75], v[220:223], a[24:27], v[72:75]
    s_mul_i32 s40, s5, 73728
    s_lshl_b32 s47, s4, 7
    s_add_u32 s40, s40, s47
    v_mfma_f32_16x16x32_bf16 v[76:79], v[220:223], a[28:31], v[76:79]
    s_lshl_b32 s47, s3, 5
    s_add_u32 s47, s47, s40
    s_mov_b32 m0, s15
    s_waitcnt vmcnt(11)
    v_mfma_f32_16x16x32_bf16 v[48:51], v[160:163], a[32:35], v[48:51]
    s_lshr_b32 s12, s4, 1
    s_cmp_eq_u32 s12, s3
    s_cselect_b32 s60, 0, 0x40000000
    v_mfma_f32_16x16x32_bf16 v[52:55], v[160:163], a[36:39], v[52:55]
    buffer_load_dwordx4 v[220:223], v3, s[52:55], s11 offen offset:1024 sc1
    buffer_load_dwordx4 v4, s[20:23], s47 offen lds
    s_add_u32 m0, m0, 0x400
    s_add_u32 s47, s47, 36864
    buffer_load_dwordx4 v4, s[20:23], s47 offen lds
    v_lshrrev_b32 v4, 3, v1
    v_mfma_f32_16x16x32_bf16 v[56:59], v[160:163], a[40:43], v[56:59]
    s_waitcnt lgkmcnt(0)
    s_barrier
    v_mfma_f32_16x16x32_bf16 v[60:63], v[160:163], a[44:47], v[60:63]
    v_lshlrev_b32 v4, 12, v4
    v_and_b32 v5, 7, v1
    v_mfma_f32_16x16x32_bf16 v[64:67], v[164:167], a[32:35], v[64:67]
    v_lshl_add_u32 v4, v5, 4, v4
    s_lshl_b32 s47, s4, 2
    s_add_u32 s47, s47, s3
    v_mfma_f32_16x16x32_bf16 v[68:71], v[164:167], a[36:39], v[68:71]
    buffer_load_dwordx4 v[160:163], v2, s[52:55], s11 offen offset:2048 sc1
    s_lshl_b32 s47, s47, 16
    s_lshl_b32 s10, s5, 7
    v_mfma_f32_16x16x32_bf16 v[72:75], v[164:167], a[40:43], v[72:75]
    s_add_u32 s47, s47, s10
    v_subrev_u32 v0, s90, v0
    v_cmp_lt_u32 vcc, 0, v0
    s_mov_b32 s91, 20000
    s_nop 0
    s_cbranch_vccz ck7
cr7:
    s_sleep 4
    v_bfe_u32 v0, v1, 4, 1
    v_mul_lo_u32 v0, v0, s94
    v_and_b32 v5, 15, v1
    v_lshl_add_u32 v5, v5, 2, v0
    buffer_load_dword v0, v5, s[68:71], s99 offen sc1
    s_sub_u32 s91, s91, 1
    s_waitcnt vmcnt(0)
    v_subrev_u32 v0, s90, v0
    v_cmp_lt_u32 vcc, 0, v0
    s_cbranch_scc1 ck7
    s_nop 0
    s_cbranch_vccnz cr7
ck7:
    v_mfma_f32_16x16x32_bf16 v[76:79], v[164:167], a[44:47], v[76:79]
    s_add_u32 m0, m0, 0x400
    s_nop 0
    buffer_load_dwordx4 v4, s[24:27], s47 offen sc1 lds
    s_add_u32 m0, m0, 0x400
    s_add_u32 s47, s47, 0x8000
    buffer_load_dwordx4 v4, s[24:27], s47 offen sc1 lds
    v_lshrrev_b32 v4, 2, v1
    v_lshlrev_b32 v4, 12, v4
    v_mfma_f32_16x16x32_bf16 v[48:51], v[168:171], a[48:51], v[48:51]
    v_and_b32 v5, 3, v1
    v_lshl_add_u32 v4, v5, 4, v4
    v_mfma_f32_16x16x32_bf16 v[52:55], v[168:171], a[52:55], v[52:55]
    buffer_load_dwordx4 v[164:167], v3, s[52:55], s11 offen offset:2048 sc1
    v_add_u32 v4, s60, v4
    v_mfma_f32_16x16x32_bf16 v[56:59], v[168:171], a[56:59], v[56:59]
    s_and_b32 s41, s4, 1
    s_lshl_b32 s6, s41, 6
    v_mfma_f32_16x16x32_bf16 v[60:63], v[168:171], a[60:63], v[60:63]
    s_add_u32 s10, s10, s6
    s_lshl_b32 s6, s12, 16
    v_mfma_f32_16x16x32_bf16 v[64:67], v[172:175], a[48:51], v[64:67]
    s_add_u32 s10, s10, s6
    s_add_u32 s10, s10, 2097152
    v_mfma_f32_16x16x32_bf16 v[68:71], v[172:175], a[52:55], v[68:71]
    buffer_load_dwordx4 v[168:171], v2, s[52:55], s11 offen offset:3072 sc1
    s_add_u32 m0, m0, 0x400
    s_nop 0
    buffer_load_dwordx4 v4, s[24:27], s10 offen sc1 lds
    v_lshlrev_b32 v0, 3, v1
    v_mul_f32 v28, v112, v112
    v_mfma_f32_16x16x32_bf16 v[72:75], v[172:175], a[56:59], v[72:75]
    buffer_load_dwordx2 v[4:5], v0, s[68:71], s93 offen sc1
    v_mul_f32 v29, v113, v113
    v_mul_f32 v30, v114, v114
    v_mfma_f32_16x16x32_bf16 v[76:79], v[172:175], a[60:63], v[76:79]
    v_mul_f32 v31, v115, v115
    v_fma_f32 v28, v28, v14, v13
    v_fma_f32 v29, v29, v14, v13
    s_waitcnt vmcnt(17)
    v_mfma_f32_16x16x32_bf16 v[48:51], v[176:179], a[64:67], v[48:51]
    v_fma_f32 v30, v30, v14, v13
    v_fma_f32 v31, v31, v14, v13
    v_mfma_f32_16x16x32_bf16 v[52:55], v[176:179], a[68:71], v[52:55]
    buffer_load_dwordx4 v[172:175], v3, s[52:55], s11 offen offset:3072 sc1
    v_mul_f32 v28, v112, v28
    v_mfma_f32_16x16x32_bf16 v[56:59], v[176:179], a[72:75], v[56:59]
    v_mul_f32 v29, v113, v29
    v_mul_f32 v30, v114, v30
    v_mul_f32 v31, v115, v31
    v_mfma_f32_16x16x32_bf16 v[60:63], v[176:179], a[76:79], v[60:63]
    v_exp_f32 v28, v28
    v_mfma_f32_16x16x32_bf16 v[64:67], v[180:183], a[64:67], v[64:67]
    v_exp_f32 v29, v29
    v_mfma_f32_16x16x32_bf16 v[68:71], v[180:183], a[68:71], v[68:71]
    s_add_u32 s11, s8, 122880
    buffer_load_dwordx4 v[176:179], v2, s[52:55], s11 offen offset:0 sc1
    v_exp_f32 v30, v30
    v_mfma_f32_16x16x32_bf16 v[72:75], v[180:183], a[72:75], v[72:75]
    v_exp_f32 v31, v31
    v_mfma_f32_16x16x32_bf16 v[76:79], v[180:183], a[76:79], v[76:79]
    v_fma_f32 v28, v28, v15, v15
    v_fma_f32 v29, v29, v15, v15
    v_fma_f32 v30, v30, v15, v15
    v_mfma_f32_16x16x32_bf16 v[48:51], v[184:187], a[80:83], v[48:51]
    v_fma_f32 v31, v31, v15, v15
    v_rcp_f32 v28, v28
    v_mfma_f32_16x16x32_bf16 v[52:55], v[184:187], a[84:87], v[52:55]
    buffer_load_dwordx4 v[180:183], v3, s[52:55], s11 offen offset:0 sc1
    v_rcp_f32 v29, v29
    v_mfma_f32_16x16x32_bf16 v[56:59], v[184:187], a[88:91], v[56:59]
    v_rcp_f32 v30, v30
    v_mfma_f32_16x16x32_bf16 v[60:63], v[184:187], a[92:95], v[60:63]
    v_rcp_f32 v31, v31
    v_mul_f32 v28, v112, v28
    v_mfma_f32_16x16x32_bf16 v[64:67], v[188:191], a[80:83], v[64:67]
    v_mul_f32 v29, v113, v29
    v_mul_f32 v30, v114, v30
    v_mfma_f32_16x16x32_bf16 v[68:71], v[188:191], a[84:87], v[68:71]
    buffer_load_dwordx4 v[184:187], v2, s[52:55], s11 offen offset:1024 sc1
    v_mul_f32 v31, v115, v31
    v_cvt_pk_bf16_f32 v36, v28, v29
    v_mfma_f32_16x16x32_bf16 v[72:75], v[188:191], a[88:91], v[72:75]
    v_cvt_pk_bf16_f32 v37, v30, v31
    v_mul_f32 v32, v128, v128
    v_mul_f32 v33, v129, v129
    v_mfma_f32_16x16x32_bf16 v[76:79], v[188:191], a[92:95], v[76:79]
    v_mul_f32 v34, v130, v130
    v_mul_f32 v35, v131, v131
    v_fma_f32 v32, v32, v14, v13
    s_waitcnt vmcnt(17)
    v_mfma_f32_16x16x32_bf16 v[48:51], v[192:195], a[96:99], v[48:51]
    v_fma_f32 v33, v33, v14, v13
    v_fma_f32 v34, v34, v14, v13
    v_mfma_f32_16x16x32_bf16 v[52:55], v[192:195], a[100:103], v[52:55]
    buffer_load_dwordx4 v[188:191], v3, s[52:55], s11 offen offset:1024 sc1
    v_fma_f32 v35, v35, v14, v13
    v_mfma_f32_16x16x32_bf16 v[56:59], v[192:195], a[104:107], v[56:59]
    v_mul_f32 v32, v128, v32
    v_mul_f32 v33, v129, v33
    v_mul_f32 v34, v130, v34
    v_mfma_f32_16x16x32_bf16 v[60:63], v[192:195], a[108:111], v[60:63]
    v_mul_f32 v35, v131, v35
    v_exp_f32 v32, v32
    v_mfma_f32_16x16x32_bf16 v[64:67], v[196:199], a[96:99], v[64:67]
    v_exp_f32 v33, v33
    v_mfma_f32_16x16x32_bf16 v[68:71], v[196:199], a[100:103], v[68:71]
    buffer_load_dwordx4 v[192:195], v2, s[52:55], s11 offen offset:2048 sc1
    v_exp_f32 v34, v34
    v_mfma_f32_16x16x32_bf16 v[72:75], v[196:199], a[104:107], v[72:75]
    v_exp_f32 v35, v35
    v_mfma_f32_16x16x32_bf16 v[76:79], v[196:199], a[108:111], v[76:79]
    v_fma_f32 v32, v32, v15, v15
    v_fma_f32 v33, v33, v15, v15
    v_fma_f32 v34, v34, v15, v15
    v_mfma_f32_16x16x32_bf16 v[48:51], v[200:203], a[112:115], v[48:51]
    v_fma_f32 v35, v35, v15, v15
    v_rcp_f32 v32, v32
    v_mfma_f32_16x16x32_bf16 v[52:55], v[200:203], a[116:119], v[52:55]
    buffer_load_dwordx4 v[196:199], v3, s[52:55], s11 offen offset:2048 sc1
    v_rcp_f32 v33, v33
    v_mfma_f32_16x16x32_bf16 v[56:59], v[200:203], a[120:123], v[56:59]
    v_rcp_f32 v34, v34
    v_mfma_f32_16x16x32_bf16 v[60:63], v[200:203], a[124:127], v[60:63]
    v_rcp_f32 v35, v35
    v_mul_f32 v32, v128, v32
    v_mfma_f32_16x16x32_bf16 v[64:67], v[204:207], a[112:115], v[64:67]
    v_mul_f32 v33, v129, v33
    v_mul_f32 v34, v130, v34
    v_mul_f32 v35, v131, v35
    v_mfma_f32_16x16x32_bf16 v[68:71], v[204:207], a[116:119], v[68:71]
    buffer_load_dwordx4 v[200:203], v2, s[52:55], s11 offen offset:3072 sc1
    v_cvt_pk_bf16_f32 v38, v32, v33
    v_mfma_f32_16x16x32_bf16 v[72:75], v[204:207], a[120:123], v[72:75]
    v_cvt_pk_bf16_f32 v39, v34, v35
    v_mul_f32 v28, v116, v116
    v_mul_f32 v29, v117, v117
    v_mfma_f32_16x16x32_bf16 v[76:79], v[204:207], a[124:127], v[76:79]
    ds_write_b128 v9, v[36:39] offset:32768
    s_waitcnt vmcnt(17)
    v_mfma_f32_16x16x32_bf16 v[48:51], v[208:211], a[128:131], v[48:51]
    v_mul_f32 v30, v118, v118
    v_mul_f32 v31, v119, v119
    v_mfma_f32_16x16x32_bf16 v[52:55], v[208:211], a[132:135], v[52:55]
    buffer_load_dwordx4 v[204:207], v3, s[52:55], s11 offen offset:3072 sc1
    v_fma_f32 v28, v28, v18, v17
    v_mfma_f32_16x16x32_bf16 v[56:59], v[208:211], a[136:139], v[56:59]
    v_fma_f32 v29, v29, v18, v17
    v_fma_f32 v30, v30, v18, v17
    v_mfma_f32_16x16x32_bf16 v[60:63], v[208:211], a[140:143], v[60:63]
    v_fma_f32 v31, v31, v18, v17
    v_mul_f32 v28, v116, v28
    v_mul_f32 v29, v117, v29
    v_mfma_f32_16x16x32_bf16 v[64:67], v[212:215], a[128:131], v[64:67]
    v_mul_f32 v30, v118, v30
    v_mul_f32 v31, v119, v31
    v_mfma_f32_16x16x32_bf16 v[68:71], v[212:215], a[132:135], v[68:71]
    s_add_u32 s11, s8, 126976
    buffer_load_dwordx4 v[208:211], v2, s[52:55], s11 offen offset:0 sc1
    v_mfma_f32_16x16x32_bf16 v[72:75], v[212:215], a[136:139], v[72:75]
    v_exp_f32 v28, v28
    v_exp_f32 v29, v29
    v_mfma_f32_16x16x32_bf16 v[76:79], v[212:215], a[140:143], v[76:79]
    v_exp_f32 v30, v30
    v_mfma_f32_16x16x32_bf16 v[48:51], v[216:219], a[144:147], v[48:51]
    v_exp_f32 v31, v31
    v_fma_f32 v28, v28, v19, v19
    v_mfma_f32_16x16x32_bf16 v[52:55], v[216:219], a[148:151], v[52:55]
    buffer_load_dwordx4 v[212:215], v3, s[52:55], s11 offen offset:0 sc1
    v_fma_f32 v29, v29, v19, v19
    v_fma_f32 v30, v30, v19, v19
    v_mfma_f32_16x16x32_bf16 v[56:59], v[216:219], a[152:155], v[56:59]
    v_fma_f32 v31, v31, v19, v19
    v_rcp_f32 v28, v28
    v_mfma_f32_16x16x32_bf16 v[60:63], v[216:219], a[156:159], v[60:63]
    v_rcp_f32 v29, v29
    v_mfma_f32_16x16x32_bf16 v[64:67], v[220:223], a[144:147], v[64:67]
    v_rcp_f32 v30, v30
    v_mfma_f32_16x16x32_bf16 v[68:71], v[220:223], a[148:151], v[68:71]
    buffer_load_dwordx4 v[216:219], v2, s[52:55], s11 offen offset:1024 sc1
    v_rcp_f32 v31, v31
    v_mfma_f32_16x16x32_bf16 v[72:75], v[220:223], a[152:155], v[72:75]
    v_mul_f32 v28, v116, v28
    v_mul_f32 v29, v117, v29
    v_mul_f32 v30, v118, v30
    v_mfma_f32_16x16x32_bf16 v[76:79], v[220:223], a[156:159], v[76:79]
    v_mul_f32 v31, v119, v31
    v_cvt_pk_bf16_f32 v36, v28, v29
    v_cvt_pk_bf16_f32 v37, v30, v31
    s_waitcnt vmcnt(11)
    v_mfma_f32_16x16x32_bf16 v[48:51], v[160:163], a[160:163], v[48:51]
    v_mul_f32 v32, v132, v132
    v_mul_f32 v33, v133, v133
    v_mfma_f32_16x16x32_bf16 v[52:55], v[160:163], a[164:167], v[52:55]
    buffer_load_dwordx4 v[220:223], v3, s[52:55], s11 offen offset:1024 sc1
    v_mul_f32 v34, v134, v134
    v_mfma_f32_16x16x32_bf16 v[56:59], v[160:163], a[168:171], v[56:59]
    v_mul_f32 v35, v135, v135
    v_fma_f32 v32, v32, v18, v17
    v_fma_f32 v33, v33, v18, v17
    v_mfma_f32_16x16x32_bf16 v[60:63], v[160:163], a[172:175], v[60:63]
    v_fma_f32 v34, v34, v18, v17
    v_fma_f32 v35, v35, v18, v17
    v_mul_f32 v32, v132, v32
    v_mfma_f32_16x16x32_bf16 v[64:67], v[164:167], a[160:163], v[64:67]
    v_mul_f32 v33, v133, v33
    v_mul_f32 v34, v134, v34
    v_mfma_f32_16x16x32_bf16 v[68:71], v[164:167], a[164:167], v[68:71]
    s_add_u32 s11, s8, 147456
    buffer_load_dwordx4 v[160:163], v2, s[52:55], s11 offen offset:0 sc1
    v_mul_f32 v35, v135, v35
    v_mfma_f32_16x16x32_bf16 v[72:75], v[164:167], a[168:171], v[72:75]
    v_exp_f32 v32, v32
    v_mfma_f32_16x16x32_bf16 v[76:79], v[164:167], a[172:175], v[76:79]
    v_exp_f32 v33, v33
    v_mfma_f32_16x16x32_bf16 v[48:51], v[168:171], a[176:179], v[48:51]
    v_exp_f32 v34, v34
    v_exp_f32 v35, v35
    v_mfma_f32_16x16x32_bf16 v[52:55], v[168:171], a[180:183], v[52:55]
    buffer_load_dwordx4 v[164:167], v2, s[52:55], s11 offen offset:1024 sc1
    v_fma_f32 v32, v32, v19, v19
    v_mfma_f32_16x16x32_bf16 v[56:59], v[168:171], a[184:187], v[56:59]
    v_fma_f32 v33, v33, v19, v19
    v_fma_f32 v34, v34, v19, v19
    v_fma_f32 v35, v35, v19, v19
    v_mfma_f32_16x16x32_bf16 v[60:63], v[168:171], a[188:191], v[60:63]
    v_rcp_f32 v32, v32
    v_mfma_f32_16x16x32_bf16 v[64:67], v[172:175], a[176:179], v[64:67]
    v_rcp_f32 v33, v33
    v_mfma_f32_16x16x32_bf16 v[68:71], v[172:175], a[180:183], v[68:71]
    buffer_load_dwordx4 v[168:171], v2, s[52:55], s11 offen offset:2048 sc1
    v_rcp_f32 v34, v34
    v_mfma_f32_16x16x32_bf16 v[72:75], v[172:175], a[184:187], v[72:75]
    v_rcp_f32 v35, v35
    v_mul_f32 v32, v132, v32
    v_mfma_f32_16x16x32_bf16 v[76:79], v[172:175], a[188:191], v[76:79]
    v_mul_f32 v33, v133, v33
    v_mul_f32 v34, v134, v34
    v_mul_f32 v35, v135, v35
    s_waitcnt vmcnt(11)
    v_mfma_f32_16x16x32_bf16 v[48:51], v[176:179], a[192:195], v[48:51]
    v_cvt_pk_bf16_f32 v38, v32, v33
    v_cvt_pk_bf16_f32 v39, v34, v35
    v_mfma_f32_16x16x32_bf16 v[52:55], v[176:179], a[196:199], v[52:55]
    buffer_load_dwordx4 v[172:175], v2, s[52:55], s11 offen offset:3072 sc1
    v_mul_f32 v28, v120, v120
    v_mfma_f32_16x16x32_bf16 v[56:59], v[176:179], a[200:203], v[56:59]
    ds_write_b128 v9, v[36:39] offset:33792
    v_mfma_f32_16x16x32_bf16 v[60:63], v[176:179], a[204:207], v[60:63]
    v_mul_f32 v29, v121, v121
    v_mul_f32 v30, v122, v122
    v_mfma_f32_16x16x32_bf16 v[64:67], v[180:183], a[192:195], v[64:67]
    v_mul_f32 v31, v123, v123
    v_fma_f32 v28, v28, v22, v21
    v_mfma_f32_16x16x32_bf16 v[68:71], v[180:183], a[196:199], v[68:71]
    s_add_u32 s11, s8, 151552
    buffer_load_dwordx4 v[176:179], v2, s[52:55], s11 offen offset:0 sc1
    v_fma_f32 v29, v29, v22, v21
    v_mfma_f32_16x16x32_bf16 v[72:75], v[180:183], a[200:203], v[72:75]
    v_fma_f32 v30, v30, v22, v21
    v_fma_f32 v31, v31, v22, v21
    v_mul_f32 v28, v120, v28
    v_mfma_f32_16x16x32_bf16 v[76:79], v[180:183], a[204:207], v[76:79]
    v_mul_f32 v29, v121, v29
    v_mul_f32 v30, v122, v30
    v_mul_f32 v31, v123, v31
    v_mfma_f32_16x16x32_bf16 v[48:51], v[184:187], a[208:211], v[48:51]
    v_exp_f32 v28, v28
    v_mfma_f32_16x16x32_bf16 v[52:55], v[184:187], a[212:215], v[52:55]
    buffer_load_dwordx4 v[180:183], v2, s[52:55], s11 offen offset:1024 sc1
    v_exp_f32 v29, v29
    v_mfma_f32_16x16x32_bf16 v[56:59], v[184:187], a[216:219], v[56:59]
    v_exp_f32 v30, v30
    v_mfma_f32_16x16x32_bf16 v[60:63], v[184:187], a[220:223], v[60:63]
    v_exp_f32 v31, v31
    v_fma_f32 v28, v28, v23, v23
    v_mfma_f32_16x16x32_bf16 v[64:67], v[188:191], a[208:211], v[64:67]
    v_fma_f32 v29, v29, v23, v23
    v_fma_f32 v30, v30, v23, v23
    v_fma_f32 v31, v31, v23, v23
    v_mfma_f32_16x16x32_bf16 v[68:71], v[188:191], a[212:215], v[68:71]
    buffer_load_dwordx4 v[184:187], v2, s[52:55], s11 offen offset:2048 sc1
    v_rcp_f32 v28, v28
    v_mfma_f32_16x16x32_bf16 v[72:75], v[188:191], a[216:219], v[72:75]
    v_rcp_f32 v29, v29
    v_mfma_f32_16x16x32_bf16 v[76:79], v[188:191], a[220:223], v[76:79]
    v_rcp_f32 v30, v30
    s_waitcnt vmcnt(11)
    v_mfma_f32_16x16x32_bf16 v[48:51], v[192:195], a[224:227], v[48:51]
    v_rcp_f32 v31, v31
    v_mul_f32 v28, v120, v28
    v_mfma_f32_16x16x32_bf16 v[52:55], v[192:195], a[228:231], v[52:55]
    buffer_load_dwordx4 v[188:191], v2, s[52:55], s11 offen offset:3072 sc1
    v_mul_f32 v29, v121, v29
    v_mul_f32 v30, v122, v30
    v_mfma_f32_16x16x32_bf16 v[56:59], v[192:195], a[232:235], v[56:59]
    v_mul_f32 v31, v123, v31
    v_cvt_pk_bf16_f32 v36, v28, v29
    v_mfma_f32_16x16x32_bf16 v[60:63], v[192:195], a[236:239], v[60:63]
    v_cvt_pk_bf16_f32 v37, v30, v31
    v_mul_f32 v32, v136, v136
    v_mul_f32 v33, v137, v137
    v_mfma_f32_16x16x32_bf16 v[64:67], v[196:199], a[224:227], v[64:67]
    v_mul_f32 v34, v138, v138
    v_mul_f32 v35, v139, v139
    v_fma_f32 v32, v32, v22, v21
    v_mfma_f32_16x16x32_bf16 v[68:71], v[196:199], a[228:231], v[68:71]
    s_add_u32 s11, s8, 155648
    buffer_load_dwordx4 v[192:195], v2, s[52:55], s11 offen offset:0 sc1
    v_mfma_f32_16x16x32_bf16 v[72:75], v[196:199], a[232:235], v[72:75]
    v_fma_f32 v33, v33, v22, v21
    v_fma_f32 v34, v34, v22, v21
    v_fma_f32 v35, v35, v22, v21
    v_mfma_f32_16x16x32_bf16 v[76:79], v[196:199], a[236:239], v[76:79]
    v_mul_f32 v32, v136, v32
    v_mul_f32 v33, v137, v33
    v_mul_f32 v34, v138, v34
    v_mfma_f32_16x16x32_bf16 v[48:51], v[200:203], a[240:243], v[48:51]
    v_mul_f32 v35, v139, v35
    v_exp_f32 v32, v32
    v_mfma_f32_16x16x32_bf16 v[52:55], v[200:203], a[244:247], v[52:55]
    buffer_load_dwordx4 v[196:199], v2, s[52:55], s11 offen offset:1024 sc1
    v_exp_f32 v33, v33
    v_mfma_f32_16x16x32_bf16 v[56:59], v[200:203], a[248:251], v[56:59]
    v_exp_f32 v34, v34
    v_mfma_f32_16x16x32_bf16 v[60:63], v[200:203], a[252:255], v[60:63]
    v_exp_f32 v35, v35
    v_fma_f32 v32, v32, v23, v23
    v_mfma_f32_16x16x32_bf16 v[64:67], v[204:207], a[240:243], v[64:67]
    v_fma_f32 v33, v33, v23, v23
    v_fma_f32 v34, v34, v23, v23
    v_mfma_f32_16x16x32_bf16 v[68:71], v[204:207], a[244:247], v[68:71]
    buffer_load_dwordx4 v[200:203], v2, s[52:55], s11 offen offset:2048 sc1
    v_fma_f32 v35, v35, v23, v23
    v_mfma_f32_16x16x32_bf16 v[72:75], v[204:207], a[248:251], v[72:75]
    v_rcp_f32 v32, v32
    v_rcp_f32 v33, v33
    v_mfma_f32_16x16x32_bf16 v[76:79], v[204:207], a[252:255], v[76:79]
    v_rcp_f32 v34, v34
    s_waitcnt vmcnt(11)
    v_mfma_f32_16x16x32_bf16 v[48:51], v[208:211], v[224:227], v[48:51]
    v_rcp_f32 v35, v35
    v_mfma_f32_16x16x32_bf16 v[52:55], v[208:211], v[228:231], v[52:55]
    buffer_load_dwordx4 v[204:207], v2, s[52:55], s11 offen offset:3072 sc1
    v_mul_f32 v32, v136, v32
    v_mul_f32 v33, v137, v33
    v_mfma_f32_16x16x32_bf16 v[56:59], v[208:211], v[232:235], v[56:59]
    v_mul_f32 v34, v138, v34
    v_mul_f32 v35, v139, v35
    v_mfma_f32_16x16x32_bf16 v[60:63], v[208:211], v[236:239], v[60:63]
    v_cvt_pk_bf16_f32 v38, v32, v33
    v_cvt_pk_bf16_f32 v39, v34, v35
    v_mfma_f32_16x16x32_bf16 v[64:67], v[212:215], v[224:227], v[64:67]
    v_mul_f32 v28, v124, v124
    v_mul_f32 v29, v125, v125
    v_mul_f32 v30, v126, v126
    v_mul_f32 v31, v127, v127
    v_mfma_f32_16x16x32_bf16 v[68:71], v[212:215], v[228:231], v[68:71]
    s_add_u32 s11, s8, 159744
    buffer_load_dwordx4 v[208:211], v2, s[52:55], s11 offen offset:0 sc1
    v_mfma_f32_16x16x32_bf16 v[72:75], v[212:215], v[232:235], v[72:75]
    ds_write_b128 v9, v[36:39] offset:34816
    v_mfma_f32_16x16x32_bf16 v[76:79], v[212:215], v[236:239], v[76:79]
    v_fma_f32 v28, v28, v26, v25
    v_fma_f32 v29, v29, v26, v25
    v_mfma_f32_16x16x32_bf16 v[48:51], v[216:219], v[240:243], v[48:51]
    v_fma_f32 v30, v30, v26, v25
    v_fma_f32 v31, v31, v26, v25
    v_mfma_f32_16x16x32_bf16 v[52:55], v[216:219], v[244:247], v[52:55]
    buffer_load_dwordx4 v[212:215], v2, s[52:55], s11 offen offset:1024 sc1
    v_mul_f32 v28, v124, v28
    v_mul_f32 v29, v125, v29
    v_mfma_f32_16x16x32_bf16 v[56:59], v[216:219], v[248:251], v[56:59]
    v_mul_f32 v30, v126, v30
    v_mul_f32 v31, v127, v31
    v_mfma_f32_16x16x32_bf16 v[60:63], v[216:219], v[252:255], v[60:63]
    v_exp_f32 v28, v28
    v_mfma_f32_16x16x32_bf16 v[64:67], v[220:223], v[240:243], v[64:67]
    v_exp_f32 v29, v29
    v_exp_f32 v30, v30
    v_mfma_f32_16x16x32_bf16 v[68:71], v[220:223], v[244:247], v[68:71]
    buffer_load_dwordx4 v[216:219], v2, s[52:55], s11 offen offset:2048 sc1
    v_exp_f32 v31, v31
    v_mfma_f32_16x16x32_bf16 v[72:75], v[220:223], v[248:251], v[72:75]
    v_fma_f32 v28, v28, v27, v27
    v_fma_f32 v29, v29, v27, v27
    v_mfma_f32_16x16x32_bf16 v[76:79], v[220:223], v[252:255], v[76:79]
    v_fma_f32 v30, v30, v27, v27
    v_fma_f32 v31, v31, v27, v27
    v_add_u32 v6, 36864, v2
    v_subrev_u32 v5, s90, v5
    v_subrev_u32 v4, s90, v4
    v_max_u32 v4, v4, v5
    v_subrev_u32 v4, 0, v4
    v_cmp_lt_u32 vcc, 0, v4
    s_mov_b32 s91, 20000
    s_nop 0
    s_cbranch_vccz ck8
cr8:
    s_sleep 2
    buffer_load_dwordx2 v[4:5], v0, s[68:71], s93 offen sc1
    s_sub_u32 s91, s91, 1
    s_waitcnt vmcnt(0)
    v_subrev_u32 v5, s90, v5
    v_subrev_u32 v4, s90, v4
    v_max_u32 v4, v4, v5
    v_subrev_u32 v4, 0, v4
    v_cmp_lt_u32 vcc, 0, v4
    s_cbranch_scc1 ck8
    s_nop 0
    s_cbranch_vccnz cr8
ck8:
    s_waitcnt vmcnt(12)
    v_mfma_f32_16x16x32_bf16 v[144:147], v[160:163], a[0:3], v[144:147]
    v_rcp_f32 v28, v28
    v_mfma_f32_16x16x32_bf16 v[148:151], v[160:163], a[4:7], v[148:151]
    buffer_load_dwordx4 v[220:223], v2, s[52:55], s11 offen offset:3072 sc1
    v_rcp_f32 v29, v29
    v_mfma_f32_16x16x32_bf16 v[152:155], v[160:163], a[8:11], v[152:155]
    v_rcp_f32 v30, v30
    v_mfma_f32_16x16x32_bf16 v[156:159], v[160:163], a[12:15], v[156:159]
    v_rcp_f32 v31, v31
    v_mul_f32 v28, v124, v28
    v_mfma_f32_16x16x32_bf16 v[144:147], v[164:167], a[16:19], v[144:147]
    v_mul_f32 v29, v125, v29
    v_mul_f32 v30, v126, v30
    v_mul_f32 v31, v127, v31
    v_mfma_f32_16x16x32_bf16 v[148:151], v[164:167], a[20:23], v[148:151]
    s_add_u32 s11, s8, 163840
    buffer_load_dwordx4 v[160:163], v2, s[52:55], s11 offen offset:0 sc1
    v_cvt_pk_bf16_f32 v36, v28, v29
    v_mfma_f32_16x16x32_bf16 v[152:155], v[164:167], a[24:27], v[152:155]
    v_cvt_pk_bf16_f32 v37, v30, v31
    v_mul_f32 v32, v140, v140
    v_mul_f32 v33, v141, v141
    v_mfma_f32_16x16x32_bf16 v[156:159], v[164:167], a[28:31], v[156:159]
    v_mul_f32 v34, v142, v142
    v_mul_f32 v35, v143, v143
    v_mfma_f32_16x16x32_bf16 v[144:147], v[168:171], a[32:35], v[144:147]
    v_fma_f32 v32, v32, v26, v25
    v_fma_f32 v33, v33, v26, v25
    v_fma_f32 v34, v34, v26, v25
    v_mfma_f32_16x16x32_bf16 v[148:151], v[168:171], a[36:39], v[148:151]
    buffer_load_dwordx4 v[164:167], v2, s[52:55], s11 offen offset:1024 sc1
    v_fma_f32 v35, v35, v26, v25
    v_mul_f32 v32, v140, v32
    v_mfma_f32_16x16x32_bf16 v[152:155], v[168:171], a[40:43], v[152:155]
    v_mul_f32 v33, v141, v33
    v_mul_f32 v34, v142, v34
    v_mfma_f32_16x16x32_bf16 v[156:159], v[168:171], a[44:47], v[156:159]
    v_mul_f32 v35, v143, v35
    v_exp_f32 v32, v32
    s_waitcnt vmcnt(12)
    v_mfma_f32_16x16x32_bf16 v[144:147], v[172:175], a[48:51], v[144:147]
    v_exp_f32 v33, v33
    v_mfma_f32_16x16x32_bf16 v[148:151], v[172:175], a[52:55], v[148:151]
    s_add_u32 s11, s8, 165888
    buffer_load_dwordx4 v[168:171], v2, s[52:55], s11 offen offset:0 sc1
    v_mfma_f32_16x16x32_bf16 v[152:155], v[172:175], a[56:59], v[152:155]
    v_exp_f32 v34, v34
    v_mfma_f32_16x16x32_bf16 v[156:159], v[172:175], a[60:63], v[156:159]
    v_exp_f32 v35, v35
    v_fma_f32 v32, v32, v27, v27
    v_fma_f32 v33, v33, v27, v27
    v_mfma_f32_16x16x32_bf16 v[144:147], v[176:179], a[64:67], v[144:147]
    v_fma_f32 v34, v34, v27, v27
    v_fma_f32 v35, v35, v27, v27
    v_mfma_f32_16x16x32_bf16 v[148:151], v[176:179], a[68:71], v[148:151]
    buffer_load_dwordx4 v[172:175], v3, s[52:55], s11 offen offset:0 sc1
    v_rcp_f32 v32, v32
    v_mfma_f32_16x16x32_bf16 v[152:155], v[176:179], a[72:75], v[152:155]
    v_rcp_f32 v33, v33
    v_mfma_f32_16x16x32_bf16 v[156:159], v[176:179], a[76:79], v[156:159]
    v_rcp_f32 v34, v34
    v_mfma_f32_16x16x32_bf16 v[144:147], v[180:183], a[80:83], v[144:147]
    v_rcp_f32 v35, v35
    v_mul_f32 v32, v140, v32
    v_mul_f32 v33, v141, v33
    v_mfma_f32_16x16x32_bf16 v[148:151], v[180:183], a[84:87], v[148:151]
    buffer_load_dwordx4 v[176:179], v2, s[52:55], s11 offen offset:1024 sc1
    v_mul_f32 v34, v142, v34
    v_mfma_f32_16x16x32_bf16 v[152:155], v[180:183], a[88:91], v[152:155]
    v_mul_f32 v35, v143, v35
    v_cvt_pk_bf16_f32 v38, v32, v33
    v_cvt_pk_bf16_f32 v39, v34, v35
    v_mfma_f32_16x16x32_bf16 v[156:159], v[180:183], a[92:95], v[156:159]
    v_fmac_f32 v48, v12, v40
    v_fmac_f32 v49, v12, v41
    v_fmac_f32 v50, v12, v42
    s_waitcnt vmcnt(12)
    v_mfma_f32_16x16x32_bf16 v[144:147], v[184:187], a[96:99], v[144:147]
    ds_write_b128 v9, v[36:39] offset:35840
    v_mfma_f32_16x16x32_bf16 v[148:151], v[184:187], a[100:103], v[148:151]
    buffer_load_dwordx4 v[180:183], v3, s[52:55], s11 offen offset:1024 sc1
    v_fmac_f32 v51, v12, v43
    v_mfma_f32_16x16x32_bf16 v[152:155], v[184:187], a[104:107], v[152:155]
    v_mul_f32 v28, v48, v48
    v_mul_f32 v29, v49, v49
    v_mfma_f32_16x16x32_bf16 v[156:159], v[184:187], a[108:111], v[156:159]
    v_mul_f32 v30, v50, v50
    v_mul_f32 v31, v51, v51
    v_mfma_f32_16x16x32_bf16 v[144:147], v[188:191], a[112:115], v[144:147]
    v_fma_f32 v28, v28, v14, v13
    v_fma_f32 v29, v29, v14, v13
    v_mfma_f32_16x16x32_bf16 v[148:151], v[188:191], a[116:119], v[148:151]
    buffer_load_dwordx4 v[184:187], v2, s[52:55], s11 offen offset:2048 sc1
    v_fma_f32 v30, v30, v14, v13
    v_fma_f32 v31, v31, v14, v13
    v_mfma_f32_16x16x32_bf16 v[152:155], v[188:191], a[120:123], v[152:155]
    v_mul_f32 v28, v48, v28
    v_mul_f32 v29, v49, v29
    v_mul_f32 v30, v50, v30
    v_mfma_f32_16x16x32_bf16 v[156:159], v[188:191], a[124:127], v[156:159]
    v_mul_f32 v31, v51, v31
    v_exp_f32 v28, v28
    v_mfma_f32_16x16x32_bf16 v[144:147], v[192:195], a[128:131], v[144:147]
    v_exp_f32 v29, v29
    v_mfma_f32_16x16x32_bf16 v[148:151], v[192:195], a[132:135], v[148:151]
    buffer_load_dwordx4 v[188:191], v3, s[52:55], s11 offen offset:2048 sc1
    s_waitcnt lgkmcnt(0)
    s_barrier
    v_mfma_f32_16x16x32_bf16 v[152:155], v[192:195], a[136:139], v[152:155]
    v_exp_f32 v30, v30
    v_mfma_f32_16x16x32_bf16 v[156:159], v[192:195], a[140:143], v[156:159]
    v_exp_f32 v31, v31
    v_fma_f32 v28, v28, v15, v15
    s_waitcnt vmcnt(12)
    v_mfma_f32_16x16x32_bf16 v[144:147], v[196:199], a[144:147], v[144:147]
    v_fma_f32 v29, v29, v15, v15
    v_fma_f32 v30, v30, v15, v15
    v_mfma_f32_16x16x32_bf16 v[148:151], v[196:199], a[148:151], v[148:151]
    buffer_load_dwordx4 v[192:195], v2, s[52:55], s11 offen offset:3072 sc1
    v_fma_f32 v31, v31, v15, v15
    v_mfma_f32_16x16x32_bf16 v[152:155], v[196:199], a[152:155], v[152:155]
    v_rcp_f32 v28, v28
    v_mfma_f32_16x16x32_bf16 v[156:159], v[196:199], a[156:159], v[156:159]
    v_rcp_f32 v29, v29
    v_rcp_f32 v30, v30
    v_mfma_f32_16x16x32_bf16 v[144:147], v[200:203], a[160:163], v[144:147]
    v_rcp_f32 v31, v31
    v_mfma_f32_16x16x32_bf16 v[148:151], v[200:203], a[164:167], v[148:151]
    buffer_load_dwordx4 v[196:199], v3, s[52:55], s11 offen offset:3072 sc1
    v_mul_f32 v28, v48, v28
    v_mul_f32 v29, v49, v29
    v_mfma_f32_16x16x32_bf16 v[152:155], v[200:203], a[168:171], v[152:155]
    v_mul_f32 v30, v50, v30
    v_mul_f32 v31, v51, v31
    v_cvt_pk_bf16_f32 v36, v28, v29
    v_mfma_f32_16x16x32_bf16 v[156:159], v[200:203], a[172:175], v[156:159]
    v_cvt_pk_bf16_f32 v37, v30, v31
    v_fmac_f32 v64, v12, v44
    v_mfma_f32_16x16x32_bf16 v[144:147], v[204:207], a[176:179], v[144:147]
    v_fmac_f32 v65, v12, v45
    v_fmac_f32 v66, v12, v46
    v_fmac_f32 v67, v12, v47
    v_mfma_f32_16x16x32_bf16 v[148:151], v[204:207], a[180:183], v[148:151]
    s_add_u32 s11, s8, 169984
    buffer_load_dwordx4 v[200:203], v2, s[52:55], s11 offen offset:0 sc1
    v_mul_f32 v32, v64, v64
    v_mfma_f32_16x16x32_bf16 v[152:155], v[204:207], a[184:187], v[152:155]
    v_mul_f32 v33, v65, v65
    v_mul_f32 v34, v66, v66
    v_mfma_f32_16x16x32_bf16 v[156:159], v[204:207], a[188:191], v[156:159]
    v_mul_f32 v35, v67, v67
    v_fma_f32 v32, v32, v14, v13
    v_fma_f32 v33, v33, v14, v13
    s_waitcnt vmcnt(12)
    v_mfma_f32_16x16x32_bf16 v[144:147], v[208:211], a[192:195], v[144:147]
    v_fma_f32 v34, v34, v14, v13
    v_fma_f32 v35, v35, v14, v13
    v_mfma_f32_16x16x32_bf16 v[148:151], v[208:211], a[196:199], v[148:151]
    buffer_load_dwordx4 v[204:207], v3, s[52:55], s11 offen offset:0 sc1
    v_mul_f32 v32, v64, v32
    v_mul_f32 v33, v65, v33
    v_mfma_f32_16x16x32_bf16 v[152:155], v[208:211], a[200:203], v[152:155]
    v_mul_f32 v34, v66, v34
    v_mul_f32 v35, v67, v35
    v_mfma_f32_16x16x32_bf16 v[156:159], v[208:211], a[204:207], v[156:159]
    v_exp_f32 v32, v32
    v_mfma_f32_16x16x32_bf16 v[144:147], v[212:215], a[208:211], v[144:147]
    v_exp_f32 v33, v33
    v_exp_f32 v34, v34
    v_mfma_f32_16x16x32_bf16 v[148:151], v[212:215], a[212:215], v[148:151]
    buffer_load_dwordx4 v[208:211], v2, s[52:55], s11 offen offset:1024 sc1
    v_exp_f32 v35, v35
    v_mfma_f32_16x16x32_bf16 v[152:155], v[212:215], a[216:219], v[152:155]
    v_fma_f32 v32, v32, v15, v15
    v_fma_f32 v33, v33, v15, v15
    v_mfma_f32_16x16x32_bf16 v[156:159], v[212:215], a[220:223], v[156:159]
    v_fma_f32 v34, v34, v15, v15
    v_fma_f32 v35, v35, v15, v15
    v_mfma_f32_16x16x32_bf16 v[144:147], v[216:219], a[224:227], v[144:147]
    v_rcp_f32 v32, v32
    v_mfma_f32_16x16x32_bf16 v[148:151], v[216:219], a[228:231], v[148:151]
    buffer_load_dwordx4 v[212:215], v3, s[52:55], s11 offen offset:1024 sc1
    v_rcp_f32 v33, v33
    v_mfma_f32_16x16x32_bf16 v[152:155], v[216:219], a[232:235], v[152:155]
    v_rcp_f32 v34, v34
    v_mfma_f32_16x16x32_bf16 v[156:159], v[216:219], a[236:239], v[156:159]
    v_rcp_f32 v35, v35
    v_mul_f32 v32, v64, v32
    v_mul_f32 v33, v65, v33
    s_waitcnt vmcnt(12)
    v_mfma_f32_16x16x32_bf16 v[144:147], v[220:223], a[240:243], v[144:147]
    ds_read_b128 a[0:3], v7 offset:8192
    v_mul_f32 v34, v66, v34
    v_mfma_f32_16x16x32_bf16 v[148:151], v[220:223], a[244:247], v[148:151]
    buffer_load_dwordx4 v[216:219], v2, s[52:55], s11 offen offset:2048 sc1
    ds_read_b128 a[4:7], v7 offset:9216
    v_mfma_f32_16x16x32_bf16 v[152:155], v[220:223], a[248:251], v[152:155]
    ds_read_b128 a[8:11], v7 offset:10240
    v_mul_f32 v35, v67, v35
    v_cvt_pk_bf16_f32 v38, v32, v33
    v_mfma_f32_16x16x32_bf16 v[156:159], v[220:223], a[252:255], v[156:159]
    ds_read_b128 a[12:15], v7 offset:11264
    v_cvt_pk_bf16_f32 v39, v34, v35
    v_mfma_f32_16x16x32_bf16 v[144:147], v[160:163], v[224:227], v[144:147]
    v_fmac_f32 v52, v16, v40
    v_fmac_f32 v53, v16, v41
    v_fmac_f32 v54, v16, v42
    v_mfma_f32_16x16x32_bf16 v[148:151], v[160:163], v[228:231], v[148:151]
    buffer_load_dwordx4 v[220:223], v3, s[52:55], s11 offen offset:2048 sc1
    ds_write_b128 v9, v[36:39] offset:49152
    v_mfma_f32_16x16x32_bf16 v[152:155], v[160:163], v[232:235], v[152:155]
    v_fmac_f32 v55, v16, v43
    v_mul_f32 v28, v52, v52
    v_mfma_f32_16x16x32_bf16 v[156:159], v[160:163], v[236:239], v[156:159]
    v_mul_f32 v29, v53, v53
    v_mul_f32 v30, v54, v54
    v_mfma_f32_16x16x32_bf16 v[144:147], v[164:167], v[240:243], v[144:147]
    v_mul_f32 v31, v55, v55
    v_fma_f32 v28, v28, v18, v17
    v_mfma_f32_16x16x32_bf16 v[148:151], v[164:167], v[244:247], v[148:151]
    buffer_load_dwordx4 v[160:163], v2, s[52:55], s11 offen offset:3072 sc1
    v_fma_f32 v29, v29, v18, v17
    v_fma_f32 v30, v30, v18, v17
    v_mfma_f32_16x16x32_bf16 v[152:155], v[164:167], v[248:251], v[152:155]
    v_fma_f32 v31, v31, v18, v17
    v_mul_f32 v28, v52, v28
    v_mfma_f32_16x16x32_bf16 v[156:159], v[164:167], v[252:255], v[156:159]
    v_mul_f32 v29, v53, v29
    v_mul_f32 v30, v54, v30
    v_mul_f32 v31, v55, v31
    s_waitcnt vmcnt(11)
    s_waitcnt lgkmcnt(1)
    v_mfma_f32_16x16x32_bf16 v[80:83], v[168:171], a[0:3], 0
    ds_read_b128 a[16:19], v7 offset:12288
    v_exp_f32 v28, v28
    v_mfma_f32_16x16x32_bf16 v[84:87], v[168:171], a[4:7], 0
    buffer_load_dwordx4 v[164:167], v3, s[52:55], s11 offen offset:3072 sc1
    v_exp_f32 v29, v29
    v_mfma_f32_16x16x32_bf16 v[88:91], v[168:171], a[8:11], 0
    ds_read_b128 a[20:23], v7 offset:13312
    v_exp_f32 v30, v30
    v_mfma_f32_16x16x32_bf16 v[92:95], v[168:171], a[12:15], 0
    ds_read_b128 a[24:27], v7 offset:14336
    v_exp_f32 v31, v31
    v_mfma_f32_16x16x32_bf16 v[96:99], v[172:175], a[0:3], 0
    ds_read_b128 a[28:31], v7 offset:15360
    v_fma_f32 v28, v28, v19, v19
    v_mfma_f32_16x16x32_bf16 v[100:103], v[172:175], a[4:7], 0
    s_add_u32 s11, s8, 174080
    buffer_load_dwordx4 v[168:171], v2, s[52:55], s11 offen offset:0 sc1
    v_mfma_f32_16x16x32_bf16 v[104:107], v[172:175], a[8:11], 0
    v_fma_f32 v29, v29, v19, v19
    v_fma_f32 v30, v30, v19, v19
    v_mfma_f32_16x16x32_bf16 v[108:111], v[172:175], a[12:15], 0
    v_fma_f32 v31, v31, v19, v19
    v_rcp_f32 v28, v28
    s_waitcnt lgkmcnt(0)
    v_mfma_f32_16x16x32_bf16 v[80:83], v[176:179], a[16:19], v[80:83]
    ds_read_b128 a[32:35], v7 offset:16384
    v_rcp_f32 v29, v29
    v_mfma_f32_16x16x32_bf16 v[84:87], v[176:179], a[20:23], v[84:87]
    buffer_load_dwordx4 v[172:175], v3, s[52:55], s11 offen offset:0 sc1
    v_rcp_f32 v30, v30
    v_mfma_f32_16x16x32_bf16 v[88:91], v[176:179], a[24:27], v[88:91]
    ds_read_b128 a[36:39], v7 offset:17408
    v_rcp_f32 v31, v31
    v_mfma_f32_16x16x32_bf16 v[92:95], v[176:179], a[28:31], v[92:95]
    ds_read_b128 a[40:43], v7 offset:18432
    v_mul_f32 v28, v52, v28
    v_mfma_f32_16x16x32_bf16 v[96:99], v[180:183], a[16:19], v[96:99]
    ds_read_b128 a[44:47], v7 offset:19456
    v_mul_f32 v29, v53, v29
    v_mfma_f32_16x16x32_bf16 v[100:103], v[180:183], a[20:23], v[100:103]
    buffer_load_dwordx4 v[176:179], v2, s[52:55], s11 offen offset:1024 sc1
    v_mul_f32 v30, v54, v30
    v_mfma_f32_16x16x32_bf16 v[104:107], v[180:183], a[24:27], v[104:107]
    v_mul_f32 v31, v55, v31
    v_cvt_pk_bf16_f32 v36, v28, v29
    v_mfma_f32_16x16x32_bf16 v[108:111], v[180:183], a[28:31], v[108:111]
    v_cvt_pk_bf16_f32 v37, v30, v31
    v_fmac_f32 v68, v16, v44
    s_waitcnt vmcnt(11)
    s_waitcnt lgkmcnt(0)
    v_mfma_f32_16x16x32_bf16 v[80:83], v[184:187], a[32:35], v[80:83]
    ds_read_b128 a[48:51], v7 offset:20480
    v_fmac_f32 v69, v16, v45
    v_mfma_f32_16x16x32_bf16 v[84:87], v[184:187], a[36:39], v[84:87]
    buffer_load_dwordx4 v[180:183], v3, s[52:55], s11 offen offset:1024 sc1
    v_fmac_f32 v70, v16, v46
    v_mfma_f32_16x16x32_bf16 v[88:91], v[184:187], a[40:43], v[88:91]
    ds_read_b128 a[52:55], v7 offset:21504
    v_fmac_f32 v71, v16, v47
    v_mfma_f32_16x16x32_bf16 v[92:95], v[184:187], a[44:47], v[92:95]
    ds_read_b128 a[56:59], v7 offset:22528
    v_mul_f32 v32, v68, v68
    v_mul_f32 v33, v69, v69
    v_mfma_f32_16x16x32_bf16 v[96:99], v[188:191], a[32:35], v[96:99]
    ds_read_b128 a[60:63], v7 offset:23552
    v_mul_f32 v34, v70, v70
    v_mul_f32 v35, v71, v71
    v_mfma_f32_16x16x32_bf16 v[100:103], v[188:191], a[36:39], v[100:103]
    buffer_load_dwordx4 v[184:187], v2, s[52:55], s11 offen offset:2048 sc1
    v_fma_f32 v32, v32, v18, v17
    v_mfma_f32_16x16x32_bf16 v[104:107], v[188:191], a[40:43], v[104:107]
    v_fma_f32 v33, v33, v18, v17
    v_fma_f32 v34, v34, v18, v17
    v_fma_f32 v35, v35, v18, v17
    v_mfma_f32_16x16x32_bf16 v[108:111], v[188:191], a[44:47], v[108:111]
    v_mul_f32 v32, v68, v32
    v_mul_f32 v33, v69, v33
    v_mul_f32 v34, v70, v34
    s_waitcnt lgkmcnt(0)
    v_mfma_f32_16x16x32_bf16 v[80:83], v[192:195], a[48:51], v[80:83]
    ds_read_b128 a[64:67], v7 offset:24576
    v_mul_f32 v35, v71, v35
    v_mfma_f32_16x16x32_bf16 v[84:87], v[192:195], a[52:55], v[84:87]
    buffer_load_dwordx4 v[188:191], v3, s[52:55], s11 offen offset:2048 sc1
    v_exp_f32 v32, v32
    v_mfma_f32_16x16x32_bf16 v[88:91], v[192:195], a[56:59], v[88:91]
    ds_read_b128 a[68:71], v7 offset:25600
    v_exp_f32 v33, v33
    v_mfma_f32_16x16x32_bf16 v[92:95], v[192:195], a[60:63], v[92:95]
    ds_read_b128 a[72:75], v7 offset:26624
    v_exp_f32 v34, v34
    v_mfma_f32_16x16x32_bf16 v[96:99], v[196:199], a[48:51], v[96:99]
    ds_read_b128 a[76:79], v7 offset:27648
    v_exp_f32 v35, v35
    v_mfma_f32_16x16x32_bf16 v[100:103], v[196:199], a[52:55], v[100:103]
    buffer_load_dwordx4 v[192:195], v2, s[52:55], s11 offen offset:3072 sc1
    v_fma_f32 v32, v32, v19, v19
    v_mfma_f32_16x16x32_bf16 v[104:107], v[196:199], a[56:59], v[104:107]
    v_fma_f32 v33, v33, v19, v19
    v_fma_f32 v34, v34, v19, v19
    v_mfma_f32_16x16x32_bf16 v[108:111], v[196:199], a[60:63], v[108:111]
    v_fma_f32 v35, v35, v19, v19
    v_rcp_f32 v32, v32
    s_waitcnt vmcnt(11)
    s_waitcnt lgkmcnt(0)
    v_mfma_f32_16x16x32_bf16 v[80:83], v[200:203], a[64:67], v[80:83]
    ds_read_b128 a[80:83], v7 offset:28672
    v_rcp_f32 v33, v33
    v_mfma_f32_16x16x32_bf16 v[84:87], v[200:203], a[68:71], v[84:87]
    buffer_load_dwordx4 v[196:199], v3, s[52:55], s11 offen offset:3072 sc1
    v_rcp_f32 v34, v34
    v_mfma_f32_16x16x32_bf16 v[88:91], v[200:203], a[72:75], v[88:91]
    ds_read_b128 a[84:87], v7 offset:29696
    v_rcp_f32 v35, v35
    v_mfma_f32_16x16x32_bf16 v[92:95], v[200:203], a[76:79], v[92:95]
    ds_read_b128 a[88:91], v7 offset:30720
    v_mul_f32 v32, v68, v32
    v_mfma_f32_16x16x32_bf16 v[96:99], v[204:207], a[64:67], v[96:99]
    ds_read_b128 a[92:95], v7 offset:31744
    v_mul_f32 v33, v69, v33
    v_mfma_f32_16x16x32_bf16 v[100:103], v[204:207], a[68:71], v[100:103]
    s_add_u32 s11, s8, 178176
    buffer_load_dwordx4 v[200:203], v2, s[52:55], s11 offen offset:0 sc1
    v_mfma_f32_16x16x32_bf16 v[104:107], v[204:207], a[72:75], v[104:107]
    v_mul_f32 v34, v70, v34
    v_mul_f32 v35, v71, v35
    v_mfma_f32_16x16x32_bf16 v[108:111], v[204:207], a[76:79], v[108:111]
    v_cvt_pk_bf16_f32 v38, v32, v33
    v_cvt_pk_bf16_f32 v39, v34, v35
    s_waitcnt lgkmcnt(0)
    v_mfma_f32_16x16x32_bf16 v[80:83], v[208:211], a[80:83], v[80:83]
    ds_read_b128 a[96:99], v7 offset:32768
    v_fmac_f32 v56, v20, v40
    v_mfma_f32_16x16x32_bf16 v[84:87], v[208:211], a[84:87], v[84:87]
    buffer_load_dwordx4 v[204:207], v3, s[52:55], s11 offen offset:0 sc1
    ds_write_b128 v9, v[36:39] offset:50176
    v_mfma_f32_16x16x32_bf16 v[88:91], v[208:211], a[88:91], v[88:91]
    ds_read_b128 a[100:103], v7 offset:33792
    v_fmac_f32 v57, v20, v41
    v_mfma_f32_16x16x32_bf16 v[92:95], v[208:211], a[92:95], v[92:95]
    ds_read_b128 a[104:107], v7 offset:34816
    v_fmac_f32 v58, v20, v42
    v_mfma_f32_16x16x32_bf16 v[96:99], v[212:215], a[80:83], v[96:99]
    ds_read_b128 a[108:111], v7 offset:35840
    v_fmac_f32 v59, v20, v43
    v_mfma_f32_16x16x32_bf16 v[100:103], v[212:215], a[84:87], v[100:103]
    buffer_load_dwordx4 v[208:211], v2, s[52:55], s11 offen offset:1024 sc1
    v_mul_f32 v28, v56, v56
    v_mfma_f32_16x16x32_bf16 v[104:107], v[212:215], a[88:91], v[104:107]
    v_mul_f32 v29, v57, v57
    v_mul_f32 v30, v58, v58
    v_mul_f32 v31, v59, v59
    v_mfma_f32_16x16x32_bf16 v[108:111], v[212:215], a[92:95], v[108:111]
    v_fma_f32 v28, v28, v22, v21
    v_fma_f32 v29, v29, v22, v21
    v_fma_f32 v30, v30, v22, v21
    s_waitcnt vmcnt(11)
    s_waitcnt lgkmcnt(0)
    v_mfma_f32_16x16x32_bf16 v[80:83], v[216:219], a[96:99], v[80:83]
    ds_read_b128 a[112:115], v7 offset:36864
    v_fma_f32 v31, v31, v22, v21
    v_mfma_f32_16x16x32_bf16 v[84:87], v[216:219], a[100:103], v[84:87]
    buffer_load_dwordx4 v[212:215], v3, s[52:55], s11 offen offset:1024 sc1
    v_mul_f32 v28, v56, v28
    v_mfma_f32_16x16x32_bf16 v[88:91], v[216:219], a[104:107], v[88:91]
    ds_read_b128 a[116:119], v7 offset:37888
    v_mul_f32 v29, v57, v29
    v_mfma_f32_16x16x32_bf16 v[92:95], v[216:219], a[108:111], v[92:95]
    ds_read_b128 a[120:123], v7 offset:38912
    v_mul_f32 v30, v58, v30
    v_mfma_f32_16x16x32_bf16 v[96:99], v[220:223], a[96:99], v[96:99]
    ds_read_b128 a[124:127], v7 offset:39936
    v_mul_f32 v31, v59, v31
    v_mfma_f32_16x16x32_bf16 v[100:103], v[220:223], a[100:103], v[100:103]
    buffer_load_dwordx4 v[216:219], v2, s[52:55], s11 offen offset:2048 sc1
    v_exp_f32 v28, v28
    v_mfma_f32_16x16x32_bf16 v[104:107], v[220:223], a[104:107], v[104:107]
    v_exp_f32 v29, v29
    v_mfma_f32_16x16x32_bf16 v[108:111], v[220:223], a[108:111], v[108:111]
    v_exp_f32 v30, v30
    v_exp_f32 v31, v31
    s_waitcnt lgkmcnt(0)
    v_mfma_f32_16x16x32_bf16 v[80:83], v[160:163], a[112:115], v[80:83]
    ds_read_b128 a[128:131], v7 offset:40960
    v_fma_f32 v28, v28, v23, v23
    v_mfma_f32_16x16x32_bf16 v[84:87], v[160:163], a[116:119], v[84:87]
    buffer_load_dwordx4 v[220:223], v3, s[52:55], s11 offen offset:2048 sc1
    v_fma_f32 v29, v29, v23, v23
    v_mfma_f32_16x16x32_bf16 v[88:91], v[160:163], a[120:123], v[88:91]
    ds_read_b128 a[132:135], v7 offset:41984
    v_fma_f32 v30, v30, v23, v23
    v_fma_f32 v31, v31, v23, v23
    v_mfma_f32_16x16x32_bf16 v[92:95], v[160:163], a[124:127], v[92:95]
    ds_read_b128 a[136:139], v7 offset:43008
    v_rcp_f32 v28, v28
    v_mfma_f32_16x16x32_bf16 v[96:99], v[164:167], a[112:115], v[96:99]
    ds_read_b128 a[140:143], v7 offset:44032
    v_rcp_f32 v29, v29
    v_mfma_f32_16x16x32_bf16 v[100:103], v[164:167], a[116:119], v[100:103]
    buffer_load_dwordx4 v[160:163], v2, s[52:55], s11 offen offset:3072 sc1
    v_rcp_f32 v30, v30
    v_mfma_f32_16x16x32_bf16 v[104:107], v[164:167], a[120:123], v[104:107]
    v_rcp_f32 v31, v31
    v_mfma_f32_16x16x32_bf16 v[108:111], v[164:167], a[124:127], v[108:111]
    v_mul_f32 v28, v56, v28
    v_mul_f32 v29, v57, v29
    s_waitcnt vmcnt(11)
    s_waitcnt lgkmcnt(0)
    v_mfma_f32_16x16x32_bf16 v[80:83], v[168:171], a[128:131], v[80:83]
    ds_read_b128 a[144:147], v7 offset:45056
    v_mul_f32 v30, v58, v30
    v_mfma_f32_16x16x32_bf16 v[84:87], v[168:171], a[132:135], v[84:87]
    buffer_load_dwordx4 v[164:167], v3, s[52:55], s11 offen offset:3072 sc1
    v_mul_f32 v31, v59, v31
    v_mfma_f32_16x16x32_bf16 v[88:91], v[168:171], a[136:139], v[88:91]
    ds_read_b128 a[148:151], v7 offset:46080
    v_cvt_pk_bf16_f32 v36, v28, v29
    v_mfma_f32_16x16x32_bf16 v[92:95], v[168:171], a[140:143], v[92:95]
    ds_read_b128 a[152:155], v7 offset:47104
    v_cvt_pk_bf16_f32 v37, v30, v31
    v_fmac_f32 v72, v20, v44
    v_mfma_f32_16x16x32_bf16 v[96:99], v[172:175], a[128:131], v[96:99]
    ds_read_b128 a[156:159], v7 offset:48128
    v_fmac_f32 v73, v20, v45
    v_fmac_f32 v74, v20, v46
    v_mfma_f32_16x16x32_bf16 v[100:103], v[172:175], a[132:135], v[100:103]
    s_add_u32 s11, s8, 182272
    buffer_load_dwordx4 v[168:171], v2, s[52:55], s11 offen offset:0 sc1
    v_mfma_f32_16x16x32_bf16 v[104:107], v[172:175], a[136:139], v[104:107]
    v_fmac_f32 v75, v20, v47
    v_mul_f32 v32, v72, v72
    v_mul_f32 v33, v73, v73
    v_mfma_f32_16x16x32_bf16 v[108:111], v[172:175], a[140:143], v[108:111]
    v_mul_f32 v34, v74, v74
    v_mul_f32 v35, v75, v75
    v_fma_f32 v32, v32, v22, v21
    s_waitcnt lgkmcnt(0)
    v_mfma_f32_16x16x32_bf16 v[80:83], v[176:179], a[144:147], v[80:83]
    ds_read_b128 a[160:163], v7 offset:49152
    v_fma_f32 v33, v33, v22, v21
    v_mfma_f32_16x16x32_bf16 v[84:87], v[176:179], a[148:151], v[84:87]
    buffer_load_dwordx4 v[172:175], v3, s[52:55], s11 offen offset:0 sc1
    v_fma_f32 v34, v34, v22, v21
    v_mfma_f32_16x16x32_bf16 v[88:91], v[176:179], a[152:155], v[88:91]
    ds_read_b128 a[164:167], v7 offset:50176
    v_fma_f32 v35, v35, v22, v21
    v_mul_f32 v32, v72, v32
    v_mfma_f32_16x16x32_bf16 v[92:95], v[176:179], a[156:159], v[92:95]
    ds_read_b128 a[168:171], v7 offset:51200
    v_mul_f32 v33, v73, v33
    v_mul_f32 v34, v74, v34
    v_mfma_f32_16x16x32_bf16 v[96:99], v[180:183], a[144:147], v[96:99]
    ds_read_b128 a[172:175], v7 offset:52224
    v_mul_f32 v35, v75, v35
    v_mfma_f32_16x16x32_bf16 v[100:103], v[180:183], a[148:151], v[100:103]
    buffer_load_dwordx4 v[176:179], v2, s[52:55], s11 offen offset:1024 sc1
    v_exp_f32 v32, v32
    v_mfma_f32_16x16x32_bf16 v[104:107], v[180:183], a[152:155], v[104:107]
    v_exp_f32 v33, v33
    v_mfma_f32_16x16x32_bf16 v[108:111], v[180:183], a[156:159], v[108:111]
    v_exp_f32 v34, v34
    s_waitcnt vmcnt(11)
    s_waitcnt lgkmcnt(0)
    v_mfma_f32_16x16x32_bf16 v[80:83], v[184:187], a[160:163], v[80:83]
    ds_read_b128 a[176:179], v7 offset:53248
    v_exp_f32 v35, v35
    v_mfma_f32_16x16x32_bf16 v[84:87], v[184:187], a[164:167], v[84:87]
    buffer_load_dwordx4 v[180:183], v3, s[52:55], s11 offen offset:1024 sc1
    v_fma_f32 v32, v32, v23, v23
    v_mfma_f32_16x16x32_bf16 v[88:91], v[184:187], a[168:171], v[88:91]
    ds_read_b128 a[180:183], v7 offset:54272
    v_fma_f32 v33, v33, v23, v23
    v_mfma_f32_16x16x32_bf16 v[92:95], v[184:187], a[172:175], v[92:95]
    ds_read_b128 a[184:187], v7 offset:55296
    v_fma_f32 v34, v34, v23, v23
    v_fma_f32 v35, v35, v23, v23
    v_mfma_f32_16x16x32_bf16 v[96:99], v[188:191], a[160:163], v[96:99]
    ds_read_b128 a[188:191], v7 offset:56320
    v_rcp_f32 v32, v32
    v_mfma_f32_16x16x32_bf16 v[100:103], v[188:191], a[164:167], v[100:103]
    s_add_u32 s11, s8, 202752
    buffer_load_dwordx4 v[184:187], v2, s[52:55], s11 offen offset:0 sc1
    v_mfma_f32_16x16x32_bf16 v[104:107], v[188:191], a[168:171], v[104:107]
    v_rcp_f32 v33, v33
    v_mfma_f32_16x16x32_bf16 v[108:111], v[188:191], a[172:175], v[108:111]
    v_rcp_f32 v34, v34
    v_rcp_f32 v35, v35
    v_mul_f32 v32, v72, v32
    v_mul_f32 v33, v73, v33
    v_mul_f32 v34, v74, v34
    v_mul_f32 v35, v75, v35
    v_cvt_pk_bf16_f32 v38, v32, v33
    v_cvt_pk_bf16_f32 v39, v34, v35
    ds_write_b128 v9, v[36:39] offset:51200
    v_fmac_f32 v60, v24, v40
    v_fmac_f32 v61, v24, v41
    v_fmac_f32 v62, v24, v42
    v_fmac_f32 v63, v24, v43
    v_mul_f32 v28, v60, v60
    v_mul_f32 v29, v61, v61
    v_mul_f32 v30, v62, v62
    v_mul_f32 v31, v63, v63
    v_fma_f32 v28, v28, v26, v25
    v_fma_f32 v29, v29, v26, v25
    v_fma_f32 v30, v30, v26, v25
    v_fma_f32 v31, v31, v26, v25
    v_mul_f32 v28, v60, v28
    v_mul_f32 v29, v61, v29
    v_mul_f32 v30, v62, v30
    v_mul_f32 v31, v63, v31
    v_exp_f32 v28, v28
    v_exp_f32 v29, v29
    v_exp_f32 v30, v30
    v_exp_f32 v31, v31
    v_fma_f32 v28, v28, v27, v27
    v_fma_f32 v29, v29, v27, v27
    v_fma_f32 v30, v30, v27, v27
    v_fma_f32 v31, v31, v27, v27
    v_rcp_f32 v28, v28
    v_rcp_f32 v29, v29
    v_rcp_f32 v30, v30
    v_rcp_f32 v31, v31
    v_mul_f32 v28, v60, v28
    v_mul_f32 v29, v61, v29
    v_mul_f32 v30, v62, v30
    v_mul_f32 v31, v63, v31
    v_cvt_pk_bf16_f32 v36, v28, v29
    v_cvt_pk_bf16_f32 v37, v30, v31
    v_fmac_f32 v76, v24, v44
    v_fmac_f32 v77, v24, v45
    v_fmac_f32 v78, v24, v46
    v_fmac_f32 v79, v24, v47
    v_mul_f32 v32, v76, v76
    v_mul_f32 v33, v77, v77
    v_mul_f32 v34, v78, v78
    v_mul_f32 v35, v79, v79
    v_fma_f32 v32, v32, v26, v25
    v_fma_f32 v33, v33, v26, v25
    v_fma_f32 v34, v34, v26, v25
    v_fma_f32 v35, v35, v26, v25
    v_mul_f32 v32, v76, v32
    v_mul_f32 v33, v77, v33
    v_mul_f32 v34, v78, v34
    v_mul_f32 v35, v79, v35
    v_exp_f32 v32, v32
    v_exp_f32 v33, v33
    v_exp_f32 v34, v34
    v_exp_f32 v35, v35
    v_fma_f32 v32, v32, v27, v27
    v_fma_f32 v33, v33, v27, v27
    v_fma_f32 v34, v34, v27, v27
    v_fma_f32 v35, v35, v27, v27
    v_rcp_f32 v32, v32
    v_rcp_f32 v33, v33
    v_rcp_f32 v34, v34
    v_rcp_f32 v35, v35
    v_mul_f32 v32, v76, v32
    v_mul_f32 v33, v77, v33
    v_mul_f32 v34, v78, v34
    v_mul_f32 v35, v79, v35
    v_cvt_pk_bf16_f32 v38, v32, v33
    v_cvt_pk_bf16_f32 v39, v34, v35
    ds_write_b128 v9, v[36:39] offset:52224
    s_waitcnt lgkmcnt(0)
    s_barrier
    v_mfma_f32_16x16x32_bf16 v[80:83], v[192:195], a[176:179], v[80:83]
    ds_read_b128 a[192:195], v7 offset:57344
    v_mul_f32 v28, v144, v144
    v_mfma_f32_16x16x32_bf16 v[84:87], v[192:195], a[180:183], v[84:87]
    buffer_load_dwordx4 v[188:191], v2, s[52:55], s11 offen offset:1024 sc1
    v_mul_f32 v29, v145, v145
    v_mul_f32 v30, v146, v146
    v_mfma_f32_16x16x32_bf16 v[88:91], v[192:195], a[184:187], v[88:91]
    ds_read_b128 a[196:199], v7 offset:58368
    v_mul_f32 v31, v147, v147
    v_fma_f32 v28, v28, v14, v13
    v_mfma_f32_16x16x32_bf16 v[92:95], v[192:195], a[188:191], v[92:95]
    ds_read_b128 a[200:203], v7 offset:59392
    v_fma_f32 v29, v29, v14, v13
    v_mfma_f32_16x16x32_bf16 v[96:99], v[196:199], a[176:179], v[96:99]
    ds_read_b128 a[204:207], v7 offset:60416
    v_fma_f32 v30, v30, v14, v13
    v_fma_f32 v31, v31, v14, v13
    v_mfma_f32_16x16x32_bf16 v[100:103], v[196:199], a[180:183], v[100:103]
    buffer_load_dwordx4 v[192:195], v2, s[52:55], s11 offen offset:2048 sc1
    v_mul_f32 v28, v144, v28
    v_mul_f32 v29, v145, v29
    v_mfma_f32_16x16x32_bf16 v[104:107], v[196:199], a[184:187], v[104:107]
    v_mul_f32 v30, v146, v30
    v_mul_f32 v31, v147, v31
    v_mfma_f32_16x16x32_bf16 v[108:111], v[196:199], a[188:191], v[108:111]
    v_exp_f32 v28, v28
    s_waitcnt vmcnt(11)
    s_waitcnt lgkmcnt(0)
    v_mfma_f32_16x16x32_bf16 v[80:83], v[200:203], a[192:195], v[80:83]
    ds_read_b128 a[208:211], v7 offset:61440
    v_exp_f32 v29, v29
    v_mfma_f32_16x16x32_bf16 v[84:87], v[200:203], a[196:199], v[84:87]
    buffer_load_dwordx4 v[196:199], v2, s[52:55], s11 offen offset:3072 sc1
    v_exp_f32 v30, v30
    v_mfma_f32_16x16x32_bf16 v[88:91], v[200:203], a[200:203], v[88:91]
    ds_read_b128 a[212:215], v7 offset:62464
    v_exp_f32 v31, v31
    v_mfma_f32_16x16x32_bf16 v[92:95], v[200:203], a[204:207], v[92:95]
    ds_read_b128 a[216:219], v7 offset:63488
    v_fma_f32 v28, v28, v15, v15
    v_mfma_f32_16x16x32_bf16 v[96:99], v[204:207], a[192:195], v[96:99]
    ds_read_b128 a[220:223], v7 offset:64512
    v_fma_f32 v29, v29, v15, v15
    v_mfma_f32_16x16x32_bf16 v[100:103], v[204:207], a[196:199], v[100:103]
    s_add_u32 s11, s8, 206848
    buffer_load_dwordx4 v[200:203], v2, s[52:55], s11 offen offset:0 sc1
    v_mfma_f32_16x16x32_bf16 v[104:107], v[204:207], a[200:203], v[104:107]
    v_fma_f32 v30, v30, v15, v15
    v_fma_f32 v31, v31, v15, v15
    v_mfma_f32_16x16x32_bf16 v[108:111], v[204:207], a[204:207], v[108:111]
    v_rcp_f32 v28, v28
    v_rcp_f32 v29, v29
    s_waitcnt lgkmcnt(0)
    v_mfma_f32_16x16x32_bf16 v[80:83], v[208:211], a[208:211], v[80:83]
    ds_read_b128 a[224:227], v8 offset:0
    v_rcp_f32 v30, v30
    v_mfma_f32_16x16x32_bf16 v[84:87], v[208:211], a[212:215], v[84:87]
    buffer_load_dwordx4 v[204:207], v2, s[52:55], s11 offen offset:1024 sc1
    v_rcp_f32 v31, v31
    v_mfma_f32_16x16x32_bf16 v[88:91], v[208:211], a[216:219], v[88:91]
    ds_read_b128 a[228:231], v8 offset:1024
    v_mul_f32 v28, v144, v28
    v_mfma_f32_16x16x32_bf16 v[92:95], v[208:211], a[220:223], v[92:95]
    ds_read_b128 a[232:235], v8 offset:2048
    v_mul_f32 v29, v145, v29
    v_mfma_f32_16x16x32_bf16 v[96:99], v[212:215], a[208:211], v[96:99]
    ds_read_b128 a[236:239], v8 offset:3072
    v_mul_f32 v30, v146, v30
    v_mfma_f32_16x16x32_bf16 v[100:103], v[212:215], a[212:215], v[100:103]
    buffer_load_dwordx4 v[208:211], v2, s[52:55], s11 offen offset:2048 sc1
    v_mul_f32 v31, v147, v31
    v_cvt_pk_bf16_f32 v36, v28, v29
    v_mfma_f32_16x16x32_bf16 v[104:107], v[212:215], a[216:219], v[104:107]
    v_cvt_pk_bf16_f32 v37, v30, v31
    v_mul_f32 v32, v148, v148
    v_mfma_f32_16x16x32_bf16 v[108:111], v[212:215], a[220:223], v[108:111]
    ds_write_b64 v10, v[36:37] offset:0
    v_mul_f32 v33, v149, v149
    s_waitcnt vmcnt(11)
    s_waitcnt lgkmcnt(1)
    v_mfma_f32_16x16x32_bf16 v[80:83], v[216:219], a[224:227], v[80:83]
    ds_read_b128 a[240:243], v8 offset:4096
    v_mul_f32 v34, v150, v150
    v_mfma_f32_16x16x32_bf16 v[84:87], v[216:219], a[228:231], v[84:87]
    buffer_load_dwordx4 v[212:215], v2, s[52:55], s11 offen offset:3072 sc1
    v_mul_f32 v35, v151, v151
    v_mfma_f32_16x16x32_bf16 v[88:91], v[216:219], a[232:235], v[88:91]
    ds_read_b128 a[244:247], v8 offset:5120
    v_fma_f32 v32, v32, v18, v17
    v_mfma_f32_16x16x32_bf16 v[92:95], v[216:219], a[236:239], v[92:95]
    ds_read_b128 a[248:251], v8 offset:6144
    v_fma_f32 v33, v33, v18, v17
    v_fma_f32 v34, v34, v18, v17
    v_mfma_f32_16x16x32_bf16 v[96:99], v[220:223], a[224:227], v[96:99]
    ds_read_b128 a[252:255], v8 offset:7168
    v_fma_f32 v35, v35, v18, v17
    v_mul_f32 v32, v148, v32
    v_mfma_f32_16x16x32_bf16 v[100:103], v[220:223], a[228:231], v[100:103]
    s_add_u32 s11, s8, 210944
    buffer_load_dwordx4 v[216:219], v2, s[52:55], s11 offen offset:0 sc1
    v_mfma_f32_16x16x32_bf16 v[104:107], v[220:223], a[232:235], v[104:107]
    v_mul_f32 v33, v149, v33
    v_mul_f32 v34, v150, v34
    v_mul_f32 v35, v151, v35
    v_mfma_f32_16x16x32_bf16 v[108:111], v[220:223], a[236:239], v[108:111]
    v_exp_f32 v32, v32
    v_exp_f32 v33, v33
    v_exp_f32 v34, v34
    v_exp_f32 v35, v35
    v_fma_f32 v32, v32, v19, v19
    v_fma_f32 v33, v33, v19, v19
    v_fma_f32 v34, v34, v19, v19
    v_fma_f32 v35, v35, v19, v19
    v_rcp_f32 v32, v32
    v_rcp_f32 v33, v33
    v_rcp_f32 v34, v34
    v_rcp_f32 v35, v35
    v_mul_f32 v32, v148, v32
    v_mul_f32 v33, v149, v33
    v_mul_f32 v34, v150, v34
    v_mul_f32 v35, v151, v35
    v_cvt_pk_bf16_f32 v36, v32, v33
    v_cvt_pk_bf16_f32 v37, v34, v35
    ds_write_b64 v10, v[36:37] offset:1024
    v_mul_f32 v28, v152, v152
    v_mul_f32 v29, v153, v153
    v_mul_f32 v30, v154, v154
    v_mul_f32 v31, v155, v155
    v_fma_f32 v28, v28, v22, v21
    v_fma_f32 v29, v29, v22, v21
    v_fma_f32 v30, v30, v22, v21
    v_fma_f32 v31, v31, v22, v21
    v_mul_f32 v28, v152, v28
    v_mul_f32 v29, v153, v29
    v_mul_f32 v30, v154, v30
    v_mul_f32 v31, v155, v31
    v_exp_f32 v28, v28
    v_exp_f32 v29, v29
    v_exp_f32 v30, v30
    v_exp_f32 v31, v31
    v_fma_f32 v28, v28, v23, v23
    v_fma_f32 v29, v29, v23, v23
    v_fma_f32 v30, v30, v23, v23
    v_fma_f32 v31, v31, v23, v23
    v_rcp_f32 v28, v28
    v_rcp_f32 v29, v29
    v_rcp_f32 v30, v30
    v_rcp_f32 v31, v31
    v_mul_f32 v28, v152, v28
    v_mul_f32 v29, v153, v29
    v_mul_f32 v30, v154, v30
    v_mul_f32 v31, v155, v31
    v_cvt_pk_bf16_f32 v36, v28, v29
    v_cvt_pk_bf16_f32 v37, v30, v31
    ds_write_b64 v10, v[36:37] offset:2048
    v_mul_f32 v32, v156, v156
    v_mul_f32 v33, v157, v157
    v_mul_f32 v34, v158, v158
    v_mul_f32 v35, v159, v159
    v_fma_f32 v32, v32, v26, v25
    v_fma_f32 v33, v33, v26, v25
    v_fma_f32 v34, v34, v26, v25
    v_fma_f32 v35, v35, v26, v25
    v_mul_f32 v32, v156, v32
    v_mul_f32 v33, v157, v33
    v_mul_f32 v34, v158, v34
    v_mul_f32 v35, v159, v35
    v_exp_f32 v32, v32
    v_exp_f32 v33, v33
    v_exp_f32 v34, v34
    v_exp_f32 v35, v35
    v_fma_f32 v32, v32, v27, v27
    v_fma_f32 v33, v33, v27, v27
    v_fma_f32 v34, v34, v27, v27
    v_fma_f32 v35, v35, v27, v27
    v_rcp_f32 v32, v32
    v_rcp_f32 v33, v33
    v_rcp_f32 v34, v34
    v_rcp_f32 v35, v35
    v_mul_f32 v32, v156, v32
    v_mul_f32 v33, v157, v33
    v_mul_f32 v34, v158, v34
    v_mul_f32 v35, v159, v35
    v_cvt_pk_bf16_f32 v36, v32, v33
    v_cvt_pk_bf16_f32 v37, v34, v35
    ds_write_b64 v10, v[36:37] offset:3072
    s_waitcnt lgkmcnt(0)
    s_barrier
    v_mfma_f32_16x16x32_bf16 v[80:83], v[160:163], a[240:243], v[80:83]
    ds_read_b128 v[224:227], v8 offset:8192
    v_mfma_f32_16x16x32_bf16 v[84:87], v[160:163], a[244:247], v[84:87]
    buffer_load_dwordx4 v[220:223], v2, s[52:55], s11 offen offset:1024 sc1
    v_mfma_f32_16x16x32_bf16 v[88:91], v[160:163], a[248:251], v[88:91]
    ds_read_b128 v[228:231], v8 offset:9216
    v_mfma_f32_16x16x32_bf16 v[92:95], v[160:163], a[252:255], v[92:95]
    ds_read_b128 v[232:235], v8 offset:10240
    v_mfma_f32_16x16x32_bf16 v[96:99], v[164:167], a[240:243], v[96:99]
    ds_read_b128 v[236:239], v8 offset:11264
    v_mfma_f32_16x16x32_bf16 v[100:103], v[164:167], a[244:247], v[100:103]
    buffer_load_dwordx4 v[160:163], v2, s[52:55], s11 offen offset:2048 sc1
    v_mfma_f32_16x16x32_bf16 v[104:107], v[164:167], a[248:251], v[104:107]
    v_mfma_f32_16x16x32_bf16 v[108:111], v[164:167], a[252:255], v[108:111]
    s_waitcnt vmcnt(11)
    s_waitcnt lgkmcnt(0)
    v_mfma_f32_16x16x32_bf16 v[80:83], v[168:171], v[224:227], v[80:83]
    ds_read_b128 v[240:243], v8 offset:12288
    v_mfma_f32_16x16x32_bf16 v[84:87], v[168:171], v[228:231], v[84:87]
    buffer_load_dwordx4 v[164:167], v2, s[52:55], s11 offen offset:3072 sc1
    v_mfma_f32_16x16x32_bf16 v[88:91], v[168:171], v[232:235], v[88:91]
    ds_read_b128 v[244:247], v8 offset:13312
    v_mfma_f32_16x16x32_bf16 v[92:95], v[168:171], v[236:239], v[92:95]
    ds_read_b128 v[248:251], v8 offset:14336
    v_mfma_f32_16x16x32_bf16 v[96:99], v[172:175], v[224:227], v[96:99]
    ds_read_b128 v[252:255], v8 offset:15360
    v_mfma_f32_16x16x32_bf16 v[100:103], v[172:175], v[228:231], v[100:103]
    s_add_u32 s11, s8, 215040
    buffer_load_dwordx4 v[168:171], v2, s[52:55], s11 offen offset:0 sc1
    v_mfma_f32_16x16x32_bf16 v[104:107], v[172:175], v[232:235], v[104:107]
    v_mfma_f32_16x16x32_bf16 v[108:111], v[172:175], v[236:239], v[108:111]
    s_waitcnt lgkmcnt(0)
    v_mfma_f32_16x16x32_bf16 v[80:83], v[176:179], v[240:243], v[80:83]
    v_mfma_f32_16x16x32_bf16 v[84:87], v[176:179], v[244:247], v[84:87]
    buffer_load_dwordx4 v[172:175], v2, s[52:55], s11 offen offset:1024 sc1
    v_mfma_f32_16x16x32_bf16 v[88:91], v[176:179], v[248:251], v[88:91]
    v_mfma_f32_16x16x32_bf16 v[92:95], v[176:179], v[252:255], v[92:95]
    v_mfma_f32_16x16x32_bf16 v[96:99], v[180:183], v[240:243], v[96:99]
    v_mfma_f32_16x16x32_bf16 v[100:103], v[180:183], v[244:247], v[100:103]
    buffer_load_dwordx4 v[176:179], v2, s[52:55], s11 offen offset:2048 sc1
    v_mfma_f32_16x16x32_bf16 v[104:107], v[180:183], v[248:251], v[104:107]
    v_mfma_f32_16x16x32_bf16 v[108:111], v[180:183], v[252:255], v[108:111]
    s_waitcnt vmcnt(12)
    v_mfma_f32_16x16x32_bf16 v[48:51], v[184:187], a[0:3], 0
    v_cvt_pk_bf16_f32 v80, v80, v81
    v_cvt_pk_bf16_f32 v81, v82, v83
    v_cvt_pk_bf16_f32 v82, v84, v85
    v_cvt_pk_bf16_f32 v83, v86, v87
    v_mfma_f32_16x16x32_bf16 v[52:55], v[184:187], a[4:7], 0
    buffer_load_dwordx4 v[112:115], v2, s[52:55], s11 offen offset:3072 sc1
    buffer_store_dwordx4 v[80:83], v2, s[56:59], s32 offen offset:0 sc1
    v_mfma_f32_16x16x32_bf16 v[56:59], v[184:187], a[8:11], 0
    v_cvt_pk_bf16_f32 v88, v88, v89
    v_cvt_pk_bf16_f32 v89, v90, v91
    v_cvt_pk_bf16_f32 v90, v92, v93
    v_mfma_f32_16x16x32_bf16 v[60:63], v[184:187], a[12:15], 0
    v_cvt_pk_bf16_f32 v91, v94, v95
    v_cvt_pk_bf16_f32 v96, v96, v97
    v_cvt_pk_bf16_f32 v97, v98, v99
    v_mfma_f32_16x16x32_bf16 v[48:51], v[188:191], a[16:19], v[48:51]
    v_cvt_pk_bf16_f32 v98, v100, v101
    v_cvt_pk_bf16_f32 v99, v102, v103
    v_cvt_pk_bf16_f32 v104, v104, v105
    v_mfma_f32_16x16x32_bf16 v[52:55], v[188:191], a[20:23], v[52:55]
    s_add_u32 s11, s8, 219136
    buffer_load_dwordx4 v[116:119], v2, s[52:55], s11 offen offset:0 sc1
    v_mfma_f32_16x16x32_bf16 v[56:59], v[188:191], a[24:27], v[56:59]
    v_cvt_pk_bf16_f32 v105, v106, v107
    v_cvt_pk_bf16_f32 v106, v108, v109
    v_cvt_pk_bf16_f32 v107, v110, v111
    v_mfma_f32_16x16x32_bf16 v[60:63], v[188:191], a[28:31], v[60:63]
    buffer_load_dwordx4 v[120:123], v2, s[52:55], s11 offen offset:1024 sc1
    buffer_store_dwordx4 v[88:91], v2, s[56:59], s32 offen offset:1024 sc1
    v_lshlrev_b32 v9, 20, v1
    v_mfma_f32_16x16x32_bf16 v[48:51], v[192:195], a[32:35], v[48:51]
    v_and_b32 v10, 7, v1
    v_sub_u32 v11, s4, v10
    v_and_b32 v11, 7, v11
    v_mfma_f32_16x16x32_bf16 v[52:55], v[192:195], a[36:39], v[52:55]
    s_add_u32 s11, s8, 221184
    buffer_load_dwordx4 v[124:127], v2, s[52:55], s11 offen offset:0 sc1
    v_lshlrev_b32 v11, 2, v11
    v_mfma_f32_16x16x32_bf16 v[56:59], v[192:195], a[40:43], v[56:59]
    v_lshlrev_b32 v10, 2, v10
    v_lshrrev_b32 v154, 2, v1
    v_mfma_f32_16x16x32_bf16 v[60:63], v[192:195], a[44:47], v[60:63]
    buffer_load_dwordx4 v[180:183], v2, s[52:55], s11 offen offset:1024 sc1
    s_lshr_b32 s13, s4, 1
    s_mov_b32 s14, s60
    s_waitcnt vmcnt(16)
    v_mfma_f32_16x16x32_bf16 v[48:51], v[196:199], a[48:51], v[48:51]
    s_mul_i32 s46, s5, 73728
    v_and_b32 v159, 15, v1
    v_mfma_f32_16x16x32_bf16 v[52:55], v[196:199], a[52:55], v[52:55]
    buffer_load_dwordx4 v[184:187], v2, s[52:55], s11 offen offset:2048 sc1
    buffer_store_dwordx4 v[96:99], v2, s[56:59], s33 offen offset:0 sc1
    v_mul_u32_u24 v159, 1152, v159
    v_mfma_f32_16x16x32_bf16 v[56:59], v[196:199], a[56:59], v[56:59]
    v_lshrrev_b32 v152, 4, v1
    v_lshl_add_u32 v159, v152, 3, v159
    v_add_u32 v159, s14, v159
    v_mfma_f32_16x16x32_bf16 v[60:63], v[196:199], a[60:63], v[60:63]
    s_mul_i32 s6, s41, 36864
    s_add_u32 s46, s46, s6
    v_mfma_f32_16x16x32_bf16 v[48:51], v[200:203], a[64:67], v[48:51]
    s_lshl_b32 s6, s13, 5
    s_add_u32 s46, s46, s6
    s_add_u32 s46, s46, 1024
    v_mfma_f32_16x16x32_bf16 v[52:55], v[200:203], a[68:71], v[52:55]
    buffer_load_dwordx4 v[100:103], v2, s[52:55], s11 offen offset:3072 sc1
    s_add_u32 s47, s46, 18432
    s_lshl_b32 s6, s4, 13
    v_mfma_f32_16x16x32_bf16 v[56:59], v[200:203], a[72:75], v[56:59]
    s_add_u32 s6, s6, s18
    v_add_u32 v155, s6, v2
    s_lshr_b32 s6, s13, 1
    v_mfma_f32_16x16x32_bf16 v[60:63], v[200:203], a[76:79], v[60:63]
    s_add_u32 s11, s8, 225280
    buffer_load_dwordx4 v[108:111], v2, s[52:55], s11 offen offset:0 sc1
    s_lshl_b32 s6, s6, 12
    v_mfma_f32_16x16x32_bf16 v[48:51], v[204:207], a[80:83], v[48:51]
    buffer_store_dwordx4 v[104:107], v2, s[56:59], s33 offen offset:1024 sc1
    s_and_b32 s7, s13, 1
    v_mfma_f32_16x16x32_bf16 v[52:55], v[204:207], a[84:87], v[52:55]
    buffer_load_dwordx4 v[188:191], v2, s[52:55], s11 offen offset:1024 sc1
    s_lshl_b32 s7, s7, 3
    s_add_u32 s6, s6, s7
    v_mfma_f32_16x16x32_bf16 v[56:59], v[204:207], a[88:91], v[56:59]
    s_lshl_b32 s7, s41, 11
    s_add_u32 s6, s6, s7
    v_add_u32 v157, s6, v7
    v_mfma_f32_16x16x32_bf16 v[60:63], v[204:207], a[92:95], v[60:63]
    buffer_load_dwordx4 v[192:195], v2, s[52:55], s11 offen offset:2048 sc1
    v_and_b32 v153, 15, v1
    v_lshlrev_b32 v153, 2, v153
    s_waitcnt vmcnt(20)
    v_mfma_f32_16x16x32_bf16 v[48:51], v[208:211], a[96:99], v[48:51]
    buffer_load_dwordx2 v[140:141], v159, s[20:23], s46 offen
    buffer_load_dwordx2 v[142:143], v159, s[20:23], s47 offen
    v_mfma_f32_16x16x32_bf16 v[52:55], v[208:211], a[100:103], v[52:55]
    buffer_load_dwordx4 v[96:99], v2, s[52:55], s11 offen offset:3072 sc1
    ds_read_b64 v[144:145], v155 offset:0
    v_mfma_f32_16x16x32_bf16 v[56:59], v[208:211], a[104:107], v[56:59]
    ds_read_b64 v[146:147], v155 offset:1024
    ds_read_b64 v[148:149], v155 offset:2048
    v_add_u32 v153, 151552, v153
    v_mfma_f32_16x16x32_bf16 v[60:63], v[208:211], a[108:111], v[60:63]
    ds_read_b64 v[150:151], v155 offset:3072
    ds_read_b64 v[136:137], v157 offset:0
    v_mfma_f32_16x16x32_bf16 v[48:51], v[212:215], a[112:115], v[48:51]
    ds_read_b64 v[138:139], v157 offset:1024
    ds_read_b32 v44, v153 offset:0
    v_mfma_f32_16x16x32_bf16 v[52:55], v[212:215], a[116:119], v[52:55]
    s_add_u32 s11, s8, 229376
    buffer_load_dwordx4 v[196:199], v2, s[52:55], s11 offen offset:0 sc1
    v_mfma_f32_16x16x32_bf16 v[56:59], v[212:215], a[120:123], v[56:59]
    ds_read_b32 v45, v153 offset:64
    ds_read_b32 v46, v153 offset:128
    v_mfma_f32_16x16x32_bf16 v[60:63], v[212:215], a[124:127], v[60:63]
    ds_read_b32 v47, v153 offset:192
    v_mfma_f32_16x16x32_bf16 v[48:51], v[216:219], a[128:131], v[48:51]
    v_mfma_f32_16x16x32_bf16 v[52:55], v[216:219], a[132:135], v[52:55]
    buffer_load_dwordx4 v[200:203], v2, s[52:55], s11 offen offset:1024 sc1
    s_waitcnt lgkmcnt(0)
    v_lshlrev_b32 v12, 16, v144
    v_and_b32 v13, 0xffff0000, v144
    v_mfma_f32_16x16x32_bf16 v[56:59], v[216:219], a[136:139], v[56:59]
    v_lshlrev_b32 v14, 16, v145
    v_and_b32 v15, 0xffff0000, v145
    v_mfma_f32_16x16x32_bf16 v[60:63], v[216:219], a[140:143], v[60:63]
    v_lshlrev_b32 v16, 16, v146
    v_and_b32 v17, 0xffff0000, v146
    v_lshlrev_b32 v18, 16, v147
    s_waitcnt vmcnt(22)
    v_mfma_f32_16x16x32_bf16 v[48:51], v[220:223], a[144:147], v[48:51]
    v_and_b32 v19, 0xffff0000, v147
    v_lshlrev_b32 v20, 16, v148
    v_mfma_f32_16x16x32_bf16 v[52:55], v[220:223], a[148:151], v[52:55]
    buffer_load_dwordx4 v[104:107], v2, s[52:55], s11 offen offset:2048 sc1
    v_and_b32 v21, 0xffff0000, v148
    v_lshlrev_b32 v22, 16, v149
    v_mfma_f32_16x16x32_bf16 v[56:59], v[220:223], a[152:155], v[56:59]
    v_and_b32 v23, 0xffff0000, v149
    v_lshlrev_b32 v24, 16, v150
    v_mfma_f32_16x16x32_bf16 v[60:63], v[220:223], a[156:159], v[60:63]
    v_and_b32 v25, 0xffff0000, v150
    v_lshlrev_b32 v26, 16, v151
    v_and_b32 v27, 0xffff0000, v151
    v_mfma_f32_16x16x32_bf16 v[48:51], v[160:163], a[160:163], v[48:51]
    v_lshlrev_b32 v128, 16, v136
    v_and_b32 v129, 0xffff0000, v136
    v_lshlrev_b32 v130, 16, v137
    v_mfma_f32_16x16x32_bf16 v[52:55], v[160:163], a[164:167], v[52:55]
    buffer_load_dwordx4 v[204:207], v2, s[52:55], s11 offen offset:3072 sc1
    v_and_b32 v131, 0xffff0000, v137
    v_lshlrev_b32 v132, 16, v138
    v_mfma_f32_16x16x32_bf16 v[56:59], v[160:163], a[168:171], v[56:59]
    v_and_b32 v133, 0xffff0000, v138
    v_lshlrev_b32 v134, 16, v139
    v_and_b32 v135, 0xffff0000, v139
    v_mfma_f32_16x16x32_bf16 v[60:63], v[160:163], a[172:175], v[60:63]
    v_and_b32 v153, 15, v1
    v_lshlrev_b32 v153, 5, v153
    v_mfma_f32_16x16x32_bf16 v[48:51], v[164:167], a[176:179], v[48:51]
    v_lshl_add_u32 v153, v152, 3, v153
    v_add_u32 v153, s15, v153
    v_and_b32 v155, 3, v1
    v_mfma_f32_16x16x32_bf16 v[52:55], v[164:167], a[180:183], v[52:55]
    s_add_u32 s11, s8, 233472
    buffer_load_dwordx4 v[208:211], v2, s[52:55], s11 offen offset:0 sc1
    v_lshlrev_b32 v155, 3, v155
    v_mfma_f32_16x16x32_bf16 v[56:59], v[164:167], a[184:187], v[56:59]
    v_add_u32 v155, s15, v155
    v_lshl_add_u32 v157, v154, 6, v155
    v_lshl_add_u32 v155, v154, 7, v155
    v_mfma_f32_16x16x32_bf16 v[60:63], v[164:167], a[188:191], v[60:63]
    s_cmp_eq_u32 s41, 0
    s_cselect_b64 vcc, -1, 0
    v_cndmask_b32 v158, v46, v44, vcc
    v_cndmask_b32 v152, v47, v45, vcc
    s_waitcnt vmcnt(22)
    v_mfma_f32_16x16x32_bf16 v[48:51], v[168:171], a[192:195], v[48:51]
    v_mfma_f32_16x16x32_bf16 v[52:55], v[168:171], a[196:199], v[52:55]
    buffer_load_dwordx4 v[212:215], v2, s[52:55], s11 offen offset:1024 sc1
    ds_read_b64 v[144:145], v153 offset:0
    v_mfma_f32_16x16x32_bf16 v[56:59], v[168:171], a[200:203], v[56:59]
    ds_read_b64_tr_b16 v[148:149], v155 offset:2048
    ds_read_b64 v[146:147], v153 offset:512
    v_mfma_f32_16x16x32_bf16 v[60:63], v[168:171], a[204:207], v[60:63]
    ds_read_b64_tr_b16 v[150:151], v155 offset:2080
    v_mfma_f32_16x16x32_bf16 v[48:51], v[172:175], a[208:211], v[48:51]
    v_mfma_f32_16x16x32_bf16 v[52:55], v[172:175], a[212:215], v[52:55]
    buffer_load_dwordx4 v[216:219], v2, s[52:55], s11 offen offset:2048 sc1
    v_mfma_f32_16x16x32_bf16 v[56:59], v[172:175], a[216:219], v[56:59]
    s_waitcnt lgkmcnt(0)
    v_lshlrev_b32 v28, 16, v144
    v_and_b32 v29, 0xffff0000, v144
    v_lshlrev_b32 v144, 16, v148
    v_mfma_f32_16x16x32_bf16 v[60:63], v[172:175], a[220:223], v[60:63]
    v_and_b32 v148, 0xffff0000, v148
    v_mul_f32 v28, v28, v144
    v_mfma_f32_16x16x32_bf16 v[48:51], v[176:179], a[224:227], v[48:51]
    v_mul_f32 v29, v29, v148
    v_mul_f32 v28, v28, v44
    v_mul_f32 v29, v29, v44
    v_mfma_f32_16x16x32_bf16 v[52:55], v[176:179], a[228:231], v[52:55]
    buffer_load_dwordx4 v[220:223], v2, s[52:55], s11 offen offset:3072 sc1
    v_lshlrev_b32 v30, 16, v145
    v_and_b32 v31, 0xffff0000, v145
    v_mfma_f32_16x16x32_bf16 v[56:59], v[176:179], a[232:235], v[56:59]
    v_lshlrev_b32 v145, 16, v149
    v_and_b32 v149, 0xffff0000, v149
    v_mul_f32 v30, v30, v145
    v_mfma_f32_16x16x32_bf16 v[60:63], v[176:179], a[236:239], v[60:63]
    v_mul_f32 v31, v31, v149
    v_mul_f32 v30, v30, v44
    s_waitcnt vmcnt(21)
    v_mfma_f32_16x16x32_bf16 v[48:51], v[112:115], a[240:243], v[48:51]
    v_mul_f32 v31, v31, v44
    v_lshlrev_b32 v32, 16, v146
    v_mfma_f32_16x16x32_bf16 v[52:55], v[112:115], a[244:247], v[52:55]
    s_add_u32 s11, s8, 237568
    buffer_load_dwordx4 v[160:163], v2, s[52:55], s11 offen offset:0 sc1
    v_and_b32 v33, 0xffff0000, v146
    v_mfma_f32_16x16x32_bf16 v[56:59], v[112:115], a[248:251], v[56:59]
    v_lshlrev_b32 v146, 16, v150
    v_and_b32 v150, 0xffff0000, v150
    v_mul_f32 v32, v32, v146
    v_mfma_f32_16x16x32_bf16 v[60:63], v[112:115], a[252:255], v[60:63]
    v_mul_f32 v33, v33, v150
    v_mul_f32 v32, v32, v45
    v_mul_f32 v33, v33, v45
    v_mfma_f32_16x16x32_bf16 v[48:51], v[116:119], v[224:227], v[48:51]
    v_lshlrev_b32 v34, 16, v147
    v_and_b32 v35, 0xffff0000, v147
    v_mfma_f32_16x16x32_bf16 v[52:55], v[116:119], v[228:231], v[52:55]
    buffer_load_dwordx4 v[164:167], v2, s[52:55], s11 offen offset:1024 sc1
    v_lshlrev_b32 v147, 16, v151
    v_and_b32 v151, 0xffff0000, v151
    v_mfma_f32_16x16x32_bf16 v[56:59], v[116:119], v[232:235], v[56:59]
    v_mul_f32 v34, v34, v147
    v_mul_f32 v35, v35, v151
    v_mul_f32 v34, v34, v45
    v_mfma_f32_16x16x32_bf16 v[60:63], v[116:119], v[236:239], v[60:63]
    v_mul_f32 v35, v35, v45
    v_mfma_f32_16x16x32_bf16 v[48:51], v[120:123], v[240:243], v[48:51]
    ds_read_b64 v[144:145], v153 offset:1024
    ds_read_b64_tr_b16 v[148:149], v155 offset:2112
    v_mfma_f32_16x16x32_bf16 v[52:55], v[120:123], v[244:247], v[52:55]
    s_add_u32 s11, s8, 239616
    buffer_load_dwordx4 v[168:171], v2, s[52:55], s11 offen offset:0 sc1
    v_mfma_f32_16x16x32_bf16 v[56:59], v[120:123], v[248:251], v[56:59]
    ds_read_b64 v[146:147], v153 offset:1536
    ds_read_b64_tr_b16 v[150:151], v155 offset:2144
    v_mfma_f32_16x16x32_bf16 v[60:63], v[120:123], v[252:255], v[60:63]
    s_waitcnt vmcnt(20)
    v_mfma_f32_16x16x32_bf16 v[64:67], v[124:127], a[0:3], 0
    v_cvt_pk_bf16_f32 v48, v48, v49
    v_cvt_pk_bf16_f32 v49, v50, v51
    v_cvt_pk_bf16_f32 v50, v52, v53
    v_cvt_pk_bf16_f32 v51, v54, v55
    v_mfma_f32_16x16x32_bf16 v[68:71], v[124:127], a[4:7], 0
    buffer_load_dwordx4 v[172:175], v2, s[52:55], s11 offen offset:1024 sc1
    buffer_store_dwordx4 v[48:51], v2, s[56:59], s34 offen offset:0 sc1
    v_mfma_f32_16x16x32_bf16 v[72:75], v[124:127], a[8:11], 0
    v_cvt_pk_bf16_f32 v56, v56, v57
    v_cvt_pk_bf16_f32 v57, v58, v59
    v_cvt_pk_bf16_f32 v58, v60, v61
    v_mfma_f32_16x16x32_bf16 v[76:79], v[124:127], a[12:15], 0
    v_cvt_pk_bf16_f32 v59, v62, v63
    s_waitcnt lgkmcnt(0)
    v_lshlrev_b32 v36, 16, v144
    v_mfma_f32_16x16x32_bf16 v[64:67], v[180:183], a[16:19], v[64:67]
    v_and_b32 v37, 0xffff0000, v144
    v_lshlrev_b32 v144, 16, v148
    v_and_b32 v148, 0xffff0000, v148
    v_mfma_f32_16x16x32_bf16 v[68:71], v[180:183], a[20:23], v[68:71]
    buffer_load_dwordx4 v[176:179], v2, s[52:55], s11 offen offset:2048 sc1
    v_mul_f32 v36, v36, v144
    v_mfma_f32_16x16x32_bf16 v[72:75], v[180:183], a[24:27], v[72:75]
    v_mul_f32 v37, v37, v148
    v_mul_f32 v36, v36, v46
    v_mul_f32 v37, v37, v46
    v_mfma_f32_16x16x32_bf16 v[76:79], v[180:183], a[28:31], v[76:79]
    buffer_store_dwordx4 v[56:59], v2, s[56:59], s34 offen offset:1024 sc1
    v_lshlrev_b32 v38, 16, v145
    v_and_b32 v39, 0xffff0000, v145
    v_mfma_f32_16x16x32_bf16 v[64:67], v[184:187], a[32:35], v[64:67]
    v_lshlrev_b32 v145, 16, v149
    v_and_b32 v149, 0xffff0000, v149
    v_mul_f32 v38, v38, v145
    v_mfma_f32_16x16x32_bf16 v[68:71], v[184:187], a[36:39], v[68:71]
    buffer_load_dwordx4 v[112:115], v2, s[52:55], s11 offen offset:3072 sc1
    v_mul_f32 v39, v39, v149
    v_mul_f32 v38, v38, v46
    v_mfma_f32_16x16x32_bf16 v[72:75], v[184:187], a[40:43], v[72:75]
    v_mul_f32 v39, v39, v46
    v_lshlrev_b32 v40, 16, v146
    v_mfma_f32_16x16x32_bf16 v[76:79], v[184:187], a[44:47], v[76:79]
    v_and_b32 v41, 0xffff0000, v146
    v_lshlrev_b32 v146, 16, v150
    v_and_b32 v150, 0xffff0000, v150
    s_waitcnt vmcnt(20)
    v_mfma_f32_16x16x32_bf16 v[64:67], v[100:103], a[48:51], v[64:67]
    s_add_u32 s91, s90, 2
    v_mov_b32 v156, s91
    buffer_store_dword v156, v9, s[68:71], s43 offen sc1
    v_mfma_f32_16x16x32_bf16 v[68:71], v[100:103], a[52:55], v[68:71]
    s_add_u32 s11, s8, 243712
    buffer_load_dwordx4 v[116:119], v2, s[52:55], s11 offen offset:0 sc1
    v_mfma_f32_16x16x32_bf16 v[72:75], v[100:103], a[56:59], v[72:75]
    v_mul_f32 v40, v40, v146
    v_mul_f32 v41, v41, v150
    v_mfma_f32_16x16x32_bf16 v[76:79], v[100:103], a[60:63], v[76:79]
    v_mul_f32 v40, v40, v47
    v_mul_f32 v41, v41, v47
    v_mfma_f32_16x16x32_bf16 v[64:67], v[108:111], a[64:67], v[64:67]
    v_lshlrev_b32 v42, 16, v147
    v_and_b32 v43, 0xffff0000, v147
    v_lshlrev_b32 v147, 16, v151
    v_mfma_f32_16x16x32_bf16 v[68:71], v[108:111], a[68:71], v[68:71]
    buffer_load_dwordx4 v[120:123], v2, s[52:55], s11 offen offset:1024 sc1
    v_and_b32 v151, 0xffff0000, v151
    v_mul_f32 v42, v42, v147
    v_mfma_f32_16x16x32_bf16 v[72:75], v[108:111], a[72:75], v[72:75]
    v_mul_f32 v43, v43, v151
    v_mul_f32 v42, v42, v47
    v_mul_f32 v43, v43, v47
    v_mfma_f32_16x16x32_bf16 v[76:79], v[108:111], a[76:79], v[76:79]
    v_mfma_f32_16x16x32_bf16 v[64:67], v[188:191], a[80:83], v[64:67]
    ds_read_b64_tr_b16 v[148:149], v157 offset:4096
    ds_read_b64_tr_b16 v[150:151], v157 offset:4128
    v_mfma_f32_16x16x32_bf16 v[68:71], v[188:191], a[84:87], v[68:71]
    buffer_load_dwordx4 v[124:127], v2, s[52:55], s11 offen offset:2048 sc1
    v_mfma_f32_16x16x32_bf16 v[72:75], v[188:191], a[88:91], v[72:75]
    v_mfma_f32_16x16x32_bf16 v[76:79], v[188:191], a[92:95], v[76:79]
    s_waitcnt vmcnt(19)
    v_mfma_f32_16x16x32_bf16 v[64:67], v[192:195], a[96:99], v[64:67]
    v_mfma_f32_16x16x32_bf16 v[68:71], v[192:195], a[100:103], v[68:71]
    buffer_load_dwordx4 v[180:183], v2, s[52:55], s11 offen offset:3072 sc1
    v_mfma_f32_16x16x32_bf16 v[72:75], v[192:195], a[104:107], v[72:75]
    v_mfma_f32_16x16x32_bf16 v[76:79], v[192:195], a[108:111], v[76:79]
    v_mfma_f32_16x16x32_bf16 v[64:67], v[96:99], a[112:115], v[64:67]
    v_mfma_f32_16x16x32_bf16 v[68:71], v[96:99], a[116:119], v[68:71]
    s_add_u32 s11, s8, 247808
    buffer_load_dwordx4 v[184:187], v2, s[52:55], s11 offen offset:0 sc1
    v_mfma_f32_16x16x32_bf16 v[72:75], v[96:99], a[120:123], v[72:75]
    v_mfma_f32_16x16x32_bf16 v[76:79], v[96:99], a[124:127], v[76:79]
    v_mfma_f32_16x16x32_bf16 v[64:67], v[196:199], a[128:131], v[64:67]
    v_mfma_f32_16x16x32_bf16 v[68:71], v[196:199], a[132:135], v[68:71]
    buffer_load_dwordx4 v[100:103], v2, s[52:55], s11 offen offset:1024 sc1
    v_mfma_f32_16x16x32_bf16 v[72:75], v[196:199], a[136:139], v[72:75]
    v_mfma_f32_16x16x32_bf16 v[76:79], v[196:199], a[140:143], v[76:79]
    s_waitcnt vmcnt(19)
    v_mfma_f32_16x16x32_bf16 v[64:67], v[200:203], a[144:147], v[64:67]
    v_mfma_f32_16x16x32_bf16 v[68:71], v[200:203], a[148:151], v[68:71]
    buffer_load_dwordx4 v[108:111], v2, s[52:55], s11 offen offset:2048 sc1
    v_mfma_f32_16x16x32_bf16 v[72:75], v[200:203], a[152:155], v[72:75]
    v_mfma_f32_16x16x32_bf16 v[76:79], v[200:203], a[156:159], v[76:79]
    v_mfma_f32_16x16x32_bf16 v[64:67], v[104:107], a[160:163], v[64:67]
    v_mfma_f32_16x16x32_bf16 v[68:71], v[104:107], a[164:167], v[68:71]
    buffer_load_dwordx4 v[188:191], v2, s[52:55], s11 offen offset:3072 sc1
    v_mfma_f32_16x16x32_bf16 v[72:75], v[104:107], a[168:171], v[72:75]
    v_mfma_f32_16x16x32_bf16 v[76:79], v[104:107], a[172:175], v[76:79]
    v_mfma_f32_16x16x32_bf16 v[64:67], v[204:207], a[176:179], v[64:67]
    v_mfma_f32_16x16x32_bf16 v[68:71], v[204:207], a[180:183], v[68:71]
    s_add_u32 s11, s8, 251904
    buffer_load_dwordx4 v[192:195], v2, s[52:55], s11 offen offset:0 sc1
    v_mfma_f32_16x16x32_bf16 v[72:75], v[204:207], a[184:187], v[72:75]
    v_mfma_f32_16x16x32_bf16 v[76:79], v[204:207], a[188:191], v[76:79]
    s_waitcnt vmcnt(19)
    v_mfma_f32_16x16x32_bf16 v[64:67], v[208:211], a[192:195], v[64:67]
    v_mfma_f32_16x16x32_bf16 v[68:71], v[208:211], a[196:199], v[68:71]
    buffer_load_dwordx4 v[96:99], v2, s[52:55], s11 offen offset:1024 sc1
    v_mov_b32 v144, v140
    v_mov_b32 v145, v141
    v_mov_b32 v146, v142
    v_mfma_f32_16x16x32_bf16 v[72:75], v[208:211], a[200:203], v[72:75]
    v_mov_b32 v147, v143
    v_mfma_f32_16x16x32_bf16 v[76:79], v[208:211], a[204:207], v[76:79]
    v_mfma_f32_16x16x32_bf16 v[64:67], v[212:215], a[208:211], v[64:67]
    v_mfma_f32_16x16x32_bf16 v[68:71], v[212:215], a[212:215], v[68:71]
    buffer_load_dwordx4 v[196:199], v2, s[52:55], s11 offen offset:2048 sc1
    v_mfma_f32_16x16x32_bf16 v[72:75], v[212:215], a[216:219], v[72:75]
    s_waitcnt lgkmcnt(0)
    v_lshlrev_b32 v136, 16, v144
    v_and_b32 v137, 0xffff0000, v144
    v_lshlrev_b32 v144, 16, v148
    v_mfma_f32_16x16x32_bf16 v[76:79], v[212:215], a[220:223], v[76:79]
    v_and_b32 v148, 0xffff0000, v148
    v_mul_f32 v136, v136, v144
    v_mfma_f32_16x16x32_bf16 v[64:67], v[216:219], a[224:227], v[64:67]
    v_mul_f32 v137, v137, v148
    v_mul_f32 v136, v136, v158
    v_mul_f32 v137, v137, v158
    v_mfma_f32_16x16x32_bf16 v[68:71], v[216:219], a[228:231], v[68:71]
    buffer_load_dwordx4 v[200:203], v2, s[52:55], s11 offen offset:3072 sc1
    v_lshlrev_b32 v138, 16, v145
    v_and_b32 v139, 0xffff0000, v145
    v_mfma_f32_16x16x32_bf16 v[72:75], v[216:219], a[232:235], v[72:75]
    v_lshlrev_b32 v145, 16, v149
    v_and_b32 v149, 0xffff0000, v149
    v_mul_f32 v138, v138, v145
    v_mfma_f32_16x16x32_bf16 v[76:79], v[216:219], a[236:239], v[76:79]
    v_mul_f32 v139, v139, v149
    v_mul_f32 v138, v138, v158
    s_waitcnt vmcnt(19)
    v_mfma_f32_16x16x32_bf16 v[64:67], v[220:223], a[240:243], v[64:67]
    v_mul_f32 v139, v139, v158
    v_lshlrev_b32 v140, 16, v146
    v_mfma_f32_16x16x32_bf16 v[68:71], v[220:223], a[244:247], v[68:71]
    s_add_u32 s11, s8, 256000
    buffer_load_dwordx4 v[104:107], v2, s[52:55], s11 offen offset:0 sc1
    v_and_b32 v141, 0xffff0000, v146
    v_mfma_f32_16x16x32_bf16 v[72:75], v[220:223], a[248:251], v[72:75]
    v_lshlrev_b32 v146, 16, v150
    v_and_b32 v150, 0xffff0000, v150
    v_mul_f32 v140, v140, v146
    v_mfma_f32_16x16x32_bf16 v[76:79], v[220:223], a[252:255], v[76:79]
    v_mul_f32 v141, v141, v150
    v_mul_f32 v140, v140, v152
    v_mul_f32 v141, v141, v152
    v_mfma_f32_16x16x32_bf16 v[64:67], v[160:163], v[224:227], v[64:67]
    v_lshlrev_b32 v142, 16, v147
    v_and_b32 v143, 0xffff0000, v147
    v_mfma_f32_16x16x32_bf16 v[68:71], v[160:163], v[228:231], v[68:71]
    buffer_load_dwordx4 v[204:207], v2, s[52:55], s11 offen offset:1024 sc1
    v_lshlrev_b32 v147, 16, v151
    v_and_b32 v151, 0xffff0000, v151
    v_mfma_f32_16x16x32_bf16 v[72:75], v[160:163], v[232:235], v[72:75]
    v_mul_f32 v142, v142, v147
    v_mul_f32 v143, v143, v151
    v_mul_f32 v142, v142, v152
    v_mfma_f32_16x16x32_bf16 v[76:79], v[160:163], v[236:239], v[76:79]
    v_mul_f32 v143, v143, v152
    v_sub_f32 v153, 1.0, v158
    v_sub_f32 v154, 1.0, v152
    v_mfma_f32_16x16x32_bf16 v[64:67], v[164:167], v[240:243], v[64:67]
    v_sub_f32 v44, 1.0, v44
    v_sub_f32 v45, 1.0, v45
    v_sub_f32 v46, 1.0, v46
    v_mfma_f32_16x16x32_bf16 v[68:71], v[164:167], v[244:247], v[68:71]
    s_add_u32 s11, s8, 258048
    buffer_load_dwordx4 v[208:211], v2, s[52:55], s11 offen offset:0 sc1
    v_mfma_f32_16x16x32_bf16 v[72:75], v[164:167], v[248:251], v[72:75]
    v_sub_f32 v47, 1.0, v47
    v_add_u32 v155, s14, v2
    s_mov_b32 s6, 0x3f80
    v_mfma_f32_16x16x32_bf16 v[76:79], v[164:167], v[252:255], v[76:79]
    s_mov_b32 s7, 0x3f800000
    s_lshl_b32 s9, s4, 13
    s_add_u32 s9, s9, s19
    s_waitcnt vmcnt(18)
    v_mfma_f32_16x16x32_bf16 v[80:83], v[168:171], a[0:3], 0
    v_cvt_pk_bf16_f32 v64, v64, v65
    v_cvt_pk_bf16_f32 v65, v66, v67
    v_mfma_f32_16x16x32_bf16 v[84:87], v[168:171], a[4:7], 0
    buffer_load_dwordx4 v[212:215], v2, s[52:55], s11 offen offset:1024 sc1
    v_cvt_pk_bf16_f32 v66, v68, v69
    v_cvt_pk_bf16_f32 v67, v70, v71
    v_mfma_f32_16x16x32_bf16 v[88:91], v[168:171], a[8:11], 0
    buffer_store_dwordx4 v[64:67], v2, s[56:59], s35 offen offset:0 sc1
    v_cvt_pk_bf16_f32 v72, v72, v73
    v_mfma_f32_16x16x32_bf16 v[92:95], v[168:171], a[12:15], 0
    buffer_load_dwordx4 v[216:219], v2, s[52:55], s11 offen offset:2048 sc1
    v_cvt_pk_bf16_f32 v73, v74, v75
    v_cvt_pk_bf16_f32 v74, v76, v77
    v_mfma_f32_16x16x32_bf16 v[80:83], v[172:175], a[16:19], v[80:83]
    v_cvt_pk_bf16_f32 v75, v78, v79
    v_mfma_f32_16x16x32_bf16 v[84:87], v[172:175], a[20:23], v[84:87]
    buffer_load_dwordx4 v[220:223], v2, s[52:55], s11 offen offset:3072 sc1
    v_mfma_f32_16x16x32_bf16 v[88:91], v[172:175], a[24:27], v[88:91]
    v_mfma_f32_16x16x32_bf16 v[92:95], v[172:175], a[28:31], v[92:95]
    s_add_u32 s11, s8, 262144
    buffer_load_dwordx4 v[160:163], v2, s[52:55], s11 offen offset:0 sc1
    v_mfma_f32_16x16x32_bf16 v[80:83], v[176:179], a[32:35], v[80:83]
    buffer_store_dwordx4 v[72:75], v2, s[56:59], s35 offen offset:1024 sc1
    v_mfma_f32_16x16x32_bf16 v[84:87], v[176:179], a[36:39], v[84:87]
    buffer_load_dwordx4 v[144:147], v2, s[52:55], s11 offen offset:1024 sc1
    v_mfma_f32_16x16x32_bf16 v[88:91], v[176:179], a[40:43], v[88:91]
    v_mfma_f32_16x16x32_bf16 v[92:95], v[176:179], a[44:47], v[92:95]
    s_waitcnt vmcnt(20)
    v_mfma_f32_16x16x32_bf16 v[80:83], v[112:115], a[48:51], v[80:83]
    s_add_u32 s91, s90, 3
    v_mov_b32 v156, s91
    buffer_store_dword v156, v9, s[68:71], s43 offen sc1
    v_mfma_f32_16x16x32_bf16 v[84:87], v[112:115], a[52:55], v[84:87]
    buffer_load_dwordx4 v[148:151], v2, s[52:55], s11 offen offset:2048 sc1
    v_mfma_f32_16x16x32_bf16 v[88:91], v[112:115], a[56:59], v[88:91]
    v_mfma_f32_16x16x32_bf16 v[92:95], v[112:115], a[60:63], v[92:95]
    v_mfma_f32_16x16x32_bf16 v[80:83], v[116:119], a[64:67], v[80:83]
    v_mfma_f32_16x16x32_bf16 v[84:87], v[116:119], a[68:71], v[84:87]
    buffer_load_dwordx4 v[164:167], v2, s[52:55], s11 offen offset:3072 sc1
    v_mfma_f32_16x16x32_bf16 v[88:91], v[116:119], a[72:75], v[88:91]
    v_mfma_f32_16x16x32_bf16 v[92:95], v[116:119], a[76:79], v[92:95]
    v_mfma_f32_16x16x32_bf16 v[80:83], v[120:123], a[80:83], v[80:83]
    v_mfma_f32_16x16x32_bf16 v[84:87], v[120:123], a[84:87], v[84:87]
    s_add_u32 s11, s8, 266240
    buffer_load_dwordx4 v[168:171], v2, s[52:55], s11 offen offset:0 sc1
    v_mfma_f32_16x16x32_bf16 v[88:91], v[120:123], a[88:91], v[88:91]
    v_mfma_f32_16x16x32_bf16 v[92:95], v[120:123], a[92:95], v[92:95]
    s_waitcnt vmcnt(21)
    v_mfma_f32_16x16x32_bf16 v[80:83], v[124:127], a[96:99], v[80:83]
    v_mfma_f32_16x16x32_bf16 v[84:87], v[124:127], a[100:103], v[84:87]
    buffer_load_dwordx4 v[172:175], v2, s[52:55], s11 offen offset:1024 sc1
    v_mfma_f32_16x16x32_bf16 v[88:91], v[124:127], a[104:107], v[88:91]
    v_mfma_f32_16x16x32_bf16 v[92:95], v[124:127], a[108:111], v[92:95]
    v_mfma_f32_16x16x32_bf16 v[80:83], v[180:183], a[112:115], v[80:83]
    v_mfma_f32_16x16x32_bf16 v[84:87], v[180:183], a[116:119], v[84:87]
    buffer_load_dwordx4 v[176:179], v2, s[52:55], s11 offen offset:2048 sc1
    v_mfma_f32_16x16x32_bf16 v[88:91], v[180:183], a[120:123], v[88:91]
    v_mfma_f32_16x16x32_bf16 v[92:95], v[180:183], a[124:127], v[92:95]
    v_mfma_f32_16x16x32_bf16 v[80:83], v[184:187], a[128:131], v[80:83]
    v_mfma_f32_16x16x32_bf16 v[84:87], v[184:187], a[132:135], v[84:87]
    buffer_load_dwordx4 v[112:115], v2, s[52:55], s11 offen offset:3072 sc1
    v_mfma_f32_16x16x32_bf16 v[88:91], v[184:187], a[136:139], v[88:91]
    v_mfma_f32_16x16x32_bf16 v[92:95], v[184:187], a[140:143], v[92:95]
    s_waitcnt vmcnt(21)
    v_mfma_f32_16x16x32_bf16 v[80:83], v[100:103], a[144:147], v[80:83]
    v_mfma_f32_16x16x32_bf16 v[84:87], v[100:103], a[148:151], v[84:87]
    s_add_u32 s11, s8, 270336
    buffer_load_dwordx4 v[116:119], v2, s[52:55], s11 offen offset:0 sc1
    v_mfma_f32_16x16x32_bf16 v[88:91], v[100:103], a[152:155], v[88:91]
    v_mfma_f32_16x16x32_bf16 v[92:95], v[100:103], a[156:159], v[92:95]
    v_mfma_f32_16x16x32_bf16 v[80:83], v[108:111], a[160:163], v[80:83]
    v_mfma_f32_16x16x32_bf16 v[84:87], v[108:111], a[164:167], v[84:87]
    buffer_load_dwordx4 v[120:123], v2, s[52:55], s11 offen offset:1024 sc1
    v_mfma_f32_16x16x32_bf16 v[88:91], v[108:111], a[168:171], v[88:91]
    v_mfma_f32_16x16x32_bf16 v[92:95], v[108:111], a[172:175], v[92:95]
    v_mfma_f32_16x16x32_bf16 v[80:83], v[188:191], a[176:179], v[80:83]
    v_mfma_f32_16x16x32_bf16 v[84:87], v[188:191], a[180:183], v[84:87]
    buffer_load_dwordx4 v[124:127], v2, s[52:55], s11 offen offset:2048 sc1
    v_mfma_f32_16x16x32_bf16 v[88:91], v[188:191], a[184:187], v[88:91]
    v_mfma_f32_16x16x32_bf16 v[92:95], v[188:191], a[188:191], v[92:95]
    s_waitcnt vmcnt(21)
    v_mfma_f32_16x16x32_bf16 v[80:83], v[192:195], a[192:195], v[80:83]
    v_mfma_f32_16x16x32_bf16 v[84:87], v[192:195], a[196:199], v[84:87]
    buffer_load_dwordx4 v[180:183], v2, s[52:55], s11 offen offset:3072 sc1
    v_mfma_f32_16x16x32_bf16 v[88:91], v[192:195], a[200:203], v[88:91]
    v_mfma_f32_16x16x32_bf16 v[92:95], v[192:195], a[204:207], v[92:95]
    v_mfma_f32_16x16x32_bf16 v[80:83], v[96:99], a[208:211], v[80:83]
    v_mfma_f32_16x16x32_bf16 v[84:87], v[96:99], a[212:215], v[84:87]
    s_add_u32 s11, s8, 274432
    buffer_load_dwordx4 v[184:187], v2, s[52:55], s11 offen offset:0 sc1
    v_mfma_f32_16x16x32_bf16 v[88:91], v[96:99], a[216:219], v[88:91]
    v_mfma_f32_16x16x32_bf16 v[92:95], v[96:99], a[220:223], v[92:95]
    v_mfma_f32_16x16x32_bf16 v[80:83], v[196:199], a[224:227], v[80:83]
    v_mfma_f32_16x16x32_bf16 v[84:87], v[196:199], a[228:231], v[84:87]
    buffer_load_dwordx4 v[100:103], v2, s[52:55], s11 offen offset:1024 sc1
    v_mfma_f32_16x16x32_bf16 v[88:91], v[196:199], a[232:235], v[88:91]
    v_mfma_f32_16x16x32_bf16 v[92:95], v[196:199], a[236:239], v[92:95]
    s_waitcnt vmcnt(21)
    v_mfma_f32_16x16x32_bf16 v[80:83], v[200:203], a[240:243], v[80:83]
    v_mfma_f32_16x16x32_bf16 v[84:87], v[200:203], a[244:247], v[84:87]
    s_add_u32 s11, s8, 276480
    buffer_load_dwordx4 v[108:111], v2, s[52:55], s11 offen offset:0 sc1
    v_mfma_f32_16x16x32_bf16 v[88:91], v[200:203], a[248:251], v[88:91]
    v_mfma_f32_16x16x32_bf16 v[92:95], v[200:203], a[252:255], v[92:95]
    v_mfma_f32_16x16x32_bf16 v[80:83], v[104:107], v[224:227], v[80:83]
    v_mfma_f32_16x16x32_bf16 v[84:87], v[104:107], v[228:231], v[84:87]
    buffer_load_dwordx4 v[188:191], v2, s[52:55], s11 offen offset:1024 sc1
    v_mfma_f32_16x16x32_bf16 v[88:91], v[104:107], v[232:235], v[88:91]
    v_mfma_f32_16x16x32_bf16 v[92:95], v[104:107], v[236:239], v[92:95]
    v_mfma_f32_16x16x32_bf16 v[80:83], v[204:207], v[240:243], v[80:83]
    v_mfma_f32_16x16x32_bf16 v[84:87], v[204:207], v[244:247], v[84:87]
    buffer_load_dwordx4 v[192:195], v2, s[52:55], s11 offen offset:2048 sc1
    v_mfma_f32_16x16x32_bf16 v[88:91], v[204:207], v[248:251], v[88:91]
    v_mfma_f32_16x16x32_bf16 v[92:95], v[204:207], v[252:255], v[92:95]
    s_waitcnt vmcnt(20)
    v_mfma_f32_16x16x32_bf16 v[48:51], v[208:211], a[0:3], 0
    s_nop 1
    v_cvt_pk_bf16_f32 v80, v80, v81
    v_cvt_pk_bf16_f32 v81, v82, v83
    v_cvt_pk_bf16_f32 v82, v84, v85
    v_cvt_pk_bf16_f32 v83, v86, v87
    v_mfma_f32_16x16x32_bf16 v[52:55], v[208:211], a[4:7], 0
    buffer_load_dwordx4 v[96:99], v2, s[52:55], s11 offen offset:3072 sc1
    buffer_store_dwordx4 v[80:83], v2, s[56:59], s36 offen offset:0 sc1
    v_mfma_f32_16x16x32_bf16 v[56:59], v[208:211], a[8:11], 0
    v_cvt_pk_bf16_f32 v88, v88, v89
    v_cvt_pk_bf16_f32 v89, v90, v91
    v_cvt_pk_bf16_f32 v90, v92, v93
    v_mfma_f32_16x16x32_bf16 v[60:63], v[208:211], a[12:15], 0
    v_cvt_pk_bf16_f32 v91, v94, v95
    v_mfma_f32_16x16x32_bf16 v[48:51], v[212:215], a[16:19], v[48:51]
    v_mfma_f32_16x16x32_bf16 v[52:55], v[212:215], a[20:23], v[52:55]
    s_add_u32 s11, s8, 280576
    buffer_load_dwordx4 v[196:199], v2, s[52:55], s11 offen offset:0 sc1
    v_mfma_f32_16x16x32_bf16 v[56:59], v[212:215], a[24:27], v[56:59]
    v_mfma_f32_16x16x32_bf16 v[60:63], v[212:215], a[28:31], v[60:63]
    buffer_store_dwordx4 v[88:91], v2, s[56:59], s36 offen offset:1024 sc1
    v_mfma_f32_16x16x32_bf16 v[48:51], v[216:219], a[32:35], v[48:51]
    v_mfma_f32_16x16x32_bf16 v[52:55], v[216:219], a[36:39], v[52:55]
    buffer_load_dwordx4 v[200:203], v2, s[52:55], s11 offen offset:1024 sc1
    v_mfma_f32_16x16x32_bf16 v[56:59], v[216:219], a[40:43], v[56:59]
    v_mfma_f32_16x16x32_bf16 v[60:63], v[216:219], a[44:47], v[60:63]
    s_waitcnt vmcnt(21)
    v_mfma_f32_16x16x32_bf16 v[48:51], v[220:223], a[48:51], v[48:51]
    s_add_u32 s91, s90, 4
    v_mov_b32 v156, s91
    buffer_store_dword v156, v9, s[68:71], s43 offen sc1
    v_mfma_f32_16x16x32_bf16 v[52:55], v[220:223], a[52:55], v[52:55]
    buffer_load_dwordx4 v[104:107], v2, s[52:55], s11 offen offset:2048 sc1
    v_mfma_f32_16x16x32_bf16 v[56:59], v[220:223], a[56:59], v[56:59]
    v_mfma_f32_16x16x32_bf16 v[60:63], v[220:223], a[60:63], v[60:63]
    v_mfma_f32_16x16x32_bf16 v[48:51], v[160:163], a[64:67], v[48:51]
    v_mfma_f32_16x16x32_bf16 v[52:55], v[160:163], a[68:71], v[52:55]
    buffer_load_dwordx4 v[204:207], v2, s[52:55], s11 offen offset:3072 sc1
    v_mfma_f32_16x16x32_bf16 v[56:59], v[160:163], a[72:75], v[56:59]
    v_mfma_f32_16x16x32_bf16 v[60:63], v[160:163], a[76:79], v[60:63]
    v_mfma_f32_16x16x32_bf16 v[48:51], v[144:147], a[80:83], v[48:51]
    v_mfma_f32_16x16x32_bf16 v[52:55], v[144:147], a[84:87], v[52:55]
    s_add_u32 s11, s8, 284672
    buffer_load_dwordx4 v[208:211], v2, s[52:55], s11 offen offset:0 sc1
    v_mfma_f32_16x16x32_bf16 v[56:59], v[144:147], a[88:91], v[56:59]
    v_mfma_f32_16x16x32_bf16 v[60:63], v[144:147], a[92:95], v[60:63]
    s_waitcnt vmcnt(21)
    v_mfma_f32_16x16x32_bf16 v[48:51], v[148:151], a[96:99], v[48:51]
    v_mfma_f32_16x16x32_bf16 v[52:55], v[148:151], a[100:103], v[52:55]
    buffer_load_dwordx4 v[212:215], v2, s[52:55], s11 offen offset:1024 sc1
    v_mfma_f32_16x16x32_bf16 v[56:59], v[148:151], a[104:107], v[56:59]
    v_mfma_f32_16x16x32_bf16 v[60:63], v[148:151], a[108:111], v[60:63]
    v_mfma_f32_16x16x32_bf16 v[48:51], v[164:167], a[112:115], v[48:51]
    v_mfma_f32_16x16x32_bf16 v[52:55], v[164:167], a[116:119], v[52:55]
    buffer_load_dwordx4 v[216:219], v2, s[52:55], s11 offen offset:2048 sc1
    v_mfma_f32_16x16x32_bf16 v[56:59], v[164:167], a[120:123], v[56:59]
    v_mfma_f32_16x16x32_bf16 v[60:63], v[164:167], a[124:127], v[60:63]
    v_mfma_f32_16x16x32_bf16 v[48:51], v[168:171], a[128:131], v[48:51]
    v_mfma_f32_16x16x32_bf16 v[52:55], v[168:171], a[132:135], v[52:55]
    buffer_load_dwordx4 v[220:223], v2, s[52:55], s11 offen offset:3072 sc1
    v_mfma_f32_16x16x32_bf16 v[56:59], v[168:171], a[136:139], v[56:59]
    v_mfma_f32_16x16x32_bf16 v[60:63], v[168:171], a[140:143], v[60:63]
    buffer_load_dword v157, v10, s[68:71], s42 offen sc1
    s_waitcnt vmcnt(22)
    v_mfma_f32_16x16x32_bf16 v[48:51], v[172:175], a[144:147], v[48:51]
    v_mfma_f32_16x16x32_bf16 v[52:55], v[172:175], a[148:151], v[52:55]
    v_mfma_f32_16x16x32_bf16 v[56:59], v[172:175], a[152:155], v[56:59]
    v_mfma_f32_16x16x32_bf16 v[60:63], v[172:175], a[156:159], v[60:63]
    v_mfma_f32_16x16x32_bf16 v[48:51], v[176:179], a[160:163], v[48:51]
    v_mfma_f32_16x16x32_bf16 v[52:55], v[176:179], a[164:167], v[52:55]
    v_mfma_f32_16x16x32_bf16 v[56:59], v[176:179], a[168:171], v[56:59]
    v_mfma_f32_16x16x32_bf16 v[60:63], v[176:179], a[172:175], v[60:63]
    v_mfma_f32_16x16x32_bf16 v[48:51], v[112:115], a[176:179], v[48:51]
    v_mfma_f32_16x16x32_bf16 v[52:55], v[112:115], a[180:183], v[52:55]
    v_mfma_f32_16x16x32_bf16 v[56:59], v[112:115], a[184:187], v[56:59]
    v_mfma_f32_16x16x32_bf16 v[60:63], v[112:115], a[188:191], v[60:63]
    s_waitcnt vmcnt(19)
    v_mfma_f32_16x16x32_bf16 v[48:51], v[116:119], a[192:195], v[48:51]
    v_mfma_f32_16x16x32_bf16 v[52:55], v[116:119], a[196:199], v[52:55]
    v_mfma_f32_16x16x32_bf16 v[56:59], v[116:119], a[200:203], v[56:59]
    v_mfma_f32_16x16x32_bf16 v[60:63], v[116:119], a[204:207], v[60:63]
    v_mfma_f32_16x16x32_bf16 v[48:51], v[120:123], a[208:211], v[48:51]
    v_mfma_f32_16x16x32_bf16 v[52:55], v[120:123], a[212:215], v[52:55]
    v_mfma_f32_16x16x32_bf16 v[56:59], v[120:123], a[216:219], v[56:59]
    v_mfma_f32_16x16x32_bf16 v[60:63], v[120:123], a[220:223], v[60:63]
    v_mfma_f32_16x16x32_bf16 v[48:51], v[124:127], a[224:227], v[48:51]
    v_mfma_f32_16x16x32_bf16 v[52:55], v[124:127], a[228:231], v[52:55]
    v_mfma_f32_16x16x32_bf16 v[56:59], v[124:127], a[232:235], v[56:59]
    v_mfma_f32_16x16x32_bf16 v[60:63], v[124:127], a[236:239], v[60:63]
    s_waitcnt vmcnt(16)
    v_mfma_f32_16x16x32_bf16 v[48:51], v[180:183], a[240:243], v[48:51]
    v_mfma_f32_16x16x32_bf16 v[52:55], v[180:183], a[244:247], v[52:55]
    v_mfma_f32_16x16x32_bf16 v[56:59], v[180:183], a[248:251], v[56:59]
    v_mfma_f32_16x16x32_bf16 v[60:63], v[180:183], a[252:255], v[60:63]
    v_mfma_f32_16x16x32_bf16 v[48:51], v[184:187], v[224:227], v[48:51]
    v_mfma_f32_16x16x32_bf16 v[52:55], v[184:187], v[228:231], v[52:55]
    v_mfma_f32_16x16x32_bf16 v[56:59], v[184:187], v[232:235], v[56:59]
    v_mfma_f32_16x16x32_bf16 v[60:63], v[184:187], v[236:239], v[60:63]
    v_mfma_f32_16x16x32_bf16 v[48:51], v[100:103], v[240:243], v[48:51]
    v_mfma_f32_16x16x32_bf16 v[52:55], v[100:103], v[244:247], v[52:55]
    v_mfma_f32_16x16x32_bf16 v[56:59], v[100:103], v[248:251], v[56:59]
    v_mfma_f32_16x16x32_bf16 v[60:63], v[100:103], v[252:255], v[60:63]
    s_waitcnt vmcnt(13)
    v_mfma_f32_16x16x32_bf16 v[64:67], v[108:111], a[0:3], 0
    s_nop 2
    v_cvt_pk_bf16_f32 v48, v48, v49
    v_cvt_pk_bf16_f32 v49, v50, v51
    v_cvt_pk_bf16_f32 v50, v52, v53
    v_cvt_pk_bf16_f32 v51, v54, v55
    v_mfma_f32_16x16x32_bf16 v[68:71], v[108:111], a[4:7], 0
    buffer_store_dwordx4 v[48:51], v2, s[56:59], s37 offen offset:0 sc1
    v_cvt_pk_bf16_f32 v56, v56, v57
    v_mfma_f32_16x16x32_bf16 v[72:75], v[108:111], a[8:11], 0
    v_cvt_pk_bf16_f32 v57, v58, v59
    v_cvt_pk_bf16_f32 v58, v60, v61
    v_cvt_pk_bf16_f32 v59, v62, v63
    v_mfma_f32_16x16x32_bf16 v[76:79], v[108:111], a[12:15], 0
    v_mfma_f32_16x16x32_bf16 v[64:67], v[188:191], a[16:19], v[64:67]
    v_mfma_f32_16x16x32_bf16 v[68:71], v[188:191], a[20:23], v[68:71]
    s_add_u32 s11, s8, 288768
    buffer_load_dwordx4 v[160:163], v2, s[52:55], s11 offen offset:0 sc1
    v_mfma_f32_16x16x32_bf16 v[72:75], v[188:191], a[24:27], v[72:75]
    v_mfma_f32_16x16x32_bf16 v[76:79], v[188:191], a[28:31], v[76:79]
    buffer_store_dwordx4 v[56:59], v2, s[56:59], s37 offen offset:1024 sc1
    v_mfma_f32_16x16x32_bf16 v[64:67], v[192:195], a[32:35], v[64:67]
    v_mfma_f32_16x16x32_bf16 v[68:71], v[192:195], a[36:39], v[68:71]
    buffer_load_dwordx4 v[144:147], v2, s[52:55], s11 offen offset:1024 sc1
    v_mfma_f32_16x16x32_bf16 v[72:75], v[192:195], a[40:43], v[72:75]
    v_mfma_f32_16x16x32_bf16 v[76:79], v[192:195], a[44:47], v[76:79]
    s_waitcnt vmcnt(12)
    v_mfma_f32_16x16x32_bf16 v[64:67], v[96:99], a[48:51], v[64:67]
    s_add_u32 s91, s90, 5
    v_mov_b32 v156, s91
    buffer_store_dword v156, v9, s[68:71], s43 offen sc1
    v_mfma_f32_16x16x32_bf16 v[68:71], v[96:99], a[52:55], v[68:71]
    buffer_load_dwordx4 v[148:151], v2, s[52:55], s11 offen offset:2048 sc1
    v_mfma_f32_16x16x32_bf16 v[72:75], v[96:99], a[56:59], v[72:75]
    v_mfma_f32_16x16x32_bf16 v[76:79], v[96:99], a[60:63], v[76:79]
    v_mfma_f32_16x16x32_bf16 v[64:67], v[196:199], a[64:67], v[64:67]
    v_mfma_f32_16x16x32_bf16 v[68:71], v[196:199], a[68:71], v[68:71]
    buffer_load_dwordx4 v[164:167], v2, s[52:55], s11 offen offset:3072 sc1
    v_mfma_f32_16x16x32_bf16 v[72:75], v[196:199], a[72:75], v[72:75]
    v_mfma_f32_16x16x32_bf16 v[76:79], v[196:199], a[76:79], v[76:79]
    v_mfma_f32_16x16x32_bf16 v[64:67], v[200:203], a[80:83], v[64:67]
    v_mfma_f32_16x16x32_bf16 v[68:71], v[200:203], a[84:87], v[68:71]
    s_add_u32 s11, s8, 292864
    buffer_load_dwordx4 v[168:171], v2, s[52:55], s11 offen offset:0 sc1
    v_mfma_f32_16x16x32_bf16 v[72:75], v[200:203], a[88:91], v[72:75]
    v_mfma_f32_16x16x32_bf16 v[76:79], v[200:203], a[92:95], v[76:79]
    s_waitcnt vmcnt(12)
    v_mfma_f32_16x16x32_bf16 v[64:67], v[104:107], a[96:99], v[64:67]
    v_mfma_f32_16x16x32_bf16 v[68:71], v[104:107], a[100:103], v[68:71]
    buffer_load_dwordx4 v[172:175], v2, s[52:55], s11 offen offset:1024 sc1
    v_mfma_f32_16x16x32_bf16 v[72:75], v[104:107], a[104:107], v[72:75]
    v_mfma_f32_16x16x32_bf16 v[76:79], v[104:107], a[108:111], v[76:79]
    v_mfma_f32_16x16x32_bf16 v[64:67], v[204:207], a[112:115], v[64:67]
    v_mfma_f32_16x16x32_bf16 v[68:71], v[204:207], a[116:119], v[68:71]
    s_add_u32 s11, s8, 294912
    buffer_load_dwordx4 v[176:179], v2, s[52:55], s11 offen offset:0 sc1
    v_mfma_f32_16x16x32_bf16 v[72:75], v[204:207], a[120:123], v[72:75]
    v_mfma_f32_16x16x32_bf16 v[76:79], v[204:207], a[124:127], v[76:79]
    v_mfma_f32_16x16x32_bf16 v[64:67], v[208:211], a[128:131], v[64:67]
    v_mfma_f32_16x16x32_bf16 v[68:71], v[208:211], a[132:135], v[68:71]
    buffer_load_dwordx4 v[112:115], v2, s[52:55], s11 offen offset:1024 sc1
    v_mfma_f32_16x16x32_bf16 v[72:75], v[208:211], a[136:139], v[72:75]
    v_mfma_f32_16x16x32_bf16 v[76:79], v[208:211], a[140:143], v[76:79]
    v_mov_b32 v158, 0x22222222
    v_lshrrev_b32 v158, v11, v158
    v_and_b32 v158, 15, v158
    v_add_u32 v158, s90, v158
    s_waitcnt vmcnt(11)
    v_subrev_u32 v157, v158, v157
    v_cmp_lt_u32 vcc, 7, v157
    s_mov_b32 s91, 20000
    s_nop 0
    s_cbranch_vccz ck9
cr9:
    buffer_load_dword v157, v10, s[68:71], s42 offen sc1
    s_sub_u32 s91, s91, 1
    s_waitcnt vmcnt(0)
    v_subrev_u32 v157, v158, v157
    v_cmp_lt_u32 vcc, 7, v157
    s_cbranch_scc1 ck9
    s_nop 0
    s_cbranch_vccnz cr9
ck9:
    v_mfma_f32_16x16x32_bf16 v[64:67], v[212:215], a[144:147], v[64:67]
    s_sub_u32 s10, s4, 1
    s_and_b32 s10, s10, 7
    s_mul_i32 s10, s10, 2359296
    s_add_u32 s10, s10, s9
    buffer_load_dwordx4 v[116:119], v2, s[56:59], s10 offen offset:0 sc1
    buffer_load_dwordx4 v[120:123], v2, s[56:59], s10 offen offset:1024 sc1
    v_mfma_f32_16x16x32_bf16 v[68:71], v[212:215], a[148:151], v[68:71]
    s_lshl_b32 s10, s41, 10
    s_add_u32 s12, s19, s10
    s_add_u32 s12, s12, 0x10000
    buffer_load_dwordx4 v[124:127], v155, s[56:59], s12 offen sc1
    v_mfma_f32_16x16x32_bf16 v[72:75], v[212:215], a[152:155], v[72:75]
    s_add_u32 s12, s12, 2359296
    buffer_load_dwordx4 v[180:183], v155, s[56:59], s12 offen sc1
    v_mfma_f32_16x16x32_bf16 v[76:79], v[212:215], a[156:159], v[76:79]
    s_add_u32 s12, s12, 2359296
    buffer_load_dwordx4 v[184:187], v155, s[56:59], s12 offen sc1
    v_mfma_f32_16x16x32_bf16 v[64:67], v[216:219], a[160:163], v[64:67]
    s_add_u32 s12, s12, 2359296
    buffer_load_dwordx4 v[100:103], v155, s[56:59], s12 offen sc1
    v_mfma_f32_16x16x32_bf16 v[68:71], v[216:219], a[164:167], v[68:71]
    s_add_u32 s12, s12, 2359296
    buffer_load_dwordx4 v[108:111], v155, s[56:59], s12 offen sc1
    v_mfma_f32_16x16x32_bf16 v[72:75], v[216:219], a[168:171], v[72:75]
    s_add_u32 s12, s12, 2359296
    buffer_load_dwordx4 v[188:191], v155, s[56:59], s12 offen sc1
    v_mfma_f32_16x16x32_bf16 v[76:79], v[216:219], a[172:175], v[76:79]
    s_add_u32 s12, s12, 2359296
    buffer_load_dwordx4 v[192:195], v155, s[56:59], s12 offen sc1
    v_mfma_f32_16x16x32_bf16 v[64:67], v[220:223], a[176:179], v[64:67]
    s_add_u32 s12, s12, 2359296
    buffer_load_dwordx4 v[96:99], v155, s[56:59], s12 offen sc1
    v_mfma_f32_16x16x32_bf16 v[68:71], v[220:223], a[180:183], v[68:71]
    buffer_load_dwordx4 v[196:199], v2, s[52:55], s11 offen offset:2048 sc1
    v_mfma_f32_16x16x32_bf16 v[72:75], v[220:223], a[184:187], v[72:75]
    v_mfma_f32_16x16x32_bf16 v[76:79], v[220:223], a[188:191], v[76:79]
    buffer_load_dwordx4 v[200:203], v2, s[52:55], s11 offen offset:3072 sc1
    s_waitcnt vmcnt(17)
    v_mfma_f32_16x16x32_bf16 v[64:67], v[160:163], a[192:195], v[64:67]
    s_add_u32 s91, s90, 6
    v_mov_b32 v156, s91
    buffer_store_dword v156, v9, s[68:71], s43 offen sc1
    v_mfma_f32_16x16x32_bf16 v[68:71], v[160:163], a[196:199], v[68:71]
    s_add_u32 s11, s8, 299008
    buffer_load_dwordx4 v[104:107], v2, s[52:55], s11 offen offset:0 sc1
    v_mfma_f32_16x16x32_bf16 v[72:75], v[160:163], a[200:203], v[72:75]
    v_mfma_f32_16x16x32_bf16 v[76:79], v[160:163], a[204:207], v[76:79]
    buffer_load_dwordx4 v[204:207], v2, s[52:55], s11 offen offset:1024 sc1
    v_mfma_f32_16x16x32_bf16 v[64:67], v[144:147], a[208:211], v[64:67]
    v_mfma_f32_16x16x32_bf16 v[68:71], v[144:147], a[212:215], v[68:71]
    buffer_load_dwordx4 v[208:211], v2, s[52:55], s11 offen offset:2048 sc1
    v_mfma_f32_16x16x32_bf16 v[72:75], v[144:147], a[216:219], v[72:75]
    v_mfma_f32_16x16x32_bf16 v[76:79], v[144:147], a[220:223], v[76:79]
    v_mfma_f32_16x16x32_bf16 v[64:67], v[148:151], a[224:227], v[64:67]
    v_mfma_f32_16x16x32_bf16 v[68:71], v[148:151], a[228:231], v[68:71]
    buffer_load_dwordx4 v[212:215], v2, s[52:55], s11 offen offset:3072 sc1
    v_mfma_f32_16x16x32_bf16 v[72:75], v[148:151], a[232:235], v[72:75]
    v_mfma_f32_16x16x32_bf16 v[76:79], v[148:151], a[236:239], v[76:79]
    s_waitcnt vmcnt(19)
    v_mfma_f32_16x16x32_bf16 v[64:67], v[164:167], a[240:243], v[64:67]
    v_mfma_f32_16x16x32_bf16 v[68:71], v[164:167], a[244:247], v[68:71]
    s_add_u32 s11, s8, 303104
    buffer_load_dwordx4 v[216:219], v2, s[52:55], s11 offen offset:0 sc1
    v_mfma_f32_16x16x32_bf16 v[72:75], v[164:167], a[248:251], v[72:75]
    v_mfma_f32_16x16x32_bf16 v[76:79], v[164:167], a[252:255], v[76:79]
    v_mfma_f32_16x16x32_bf16 v[64:67], v[168:171], v[224:227], v[64:67]
    v_mfma_f32_16x16x32_bf16 v[68:71], v[168:171], v[228:231], v[68:71]
    buffer_load_dwordx4 v[220:223], v2, s[52:55], s11 offen offset:1024 sc1
    v_mfma_f32_16x16x32_bf16 v[72:75], v[168:171], v[232:235], v[72:75]
    v_mfma_f32_16x16x32_bf16 v[76:79], v[168:171], v[236:239], v[76:79]
    v_mfma_f32_16x16x32_bf16 v[64:67], v[172:175], v[240:243], v[64:67]
    v_mfma_f32_16x16x32_bf16 v[68:71], v[172:175], v[244:247], v[68:71]
    buffer_load_dwordx4 v[160:163], v2, s[52:55], s11 offen offset:2048 sc1
    v_mfma_f32_16x16x32_bf16 v[72:75], v[172:175], v[248:251], v[72:75]
    v_mfma_f32_16x16x32_bf16 v[76:79], v[172:175], v[252:255], v[76:79]
    buffer_load_dword v157, v10, s[68:71], s42 offen sc1
    s_waitcnt vmcnt(10)
    v_mfma_f32_16x16x32_bf16 v[80:83], v[176:179], a[0:3], 0
    s_nop 0
    v_cvt_pk_bf16_f32 v64, v64, v65
    v_cvt_pk_bf16_f32 v65, v66, v67
    v_cvt_pk_bf16_f32 v66, v68, v69
    v_cvt_pk_bf16_f32 v67, v70, v71
    v_mfma_f32_16x16x32_bf16 v[84:87], v[176:179], a[4:7], 0
    buffer_store_dwordx4 v[64:67], v2, s[56:59], s38 offen offset:0 sc1
    v_cvt_pk_bf16_f32 v72, v72, v73
    v_mfma_f32_16x16x32_bf16 v[88:91], v[176:179], a[8:11], 0
    v_cvt_pk_bf16_f32 v73, v74, v75
    v_cvt_pk_bf16_f32 v74, v76, v77
    v_cvt_pk_bf16_f32 v75, v78, v79
    v_mfma_f32_16x16x32_bf16 v[92:95], v[176:179], a[12:15], 0
    v_mfma_f32_16x16x32_bf16 v[80:83], v[112:115], a[16:19], v[80:83]
    v_mfma_f32_16x16x32_bf16 v[84:87], v[112:115], a[20:23], v[84:87]
    v_mfma_f32_16x16x32_bf16 v[88:91], v[112:115], a[24:27], v[88:91]
    v_mfma_f32_16x16x32_bf16 v[92:95], v[112:115], a[28:31], v[92:95]
    buffer_store_dwordx4 v[72:75], v2, s[56:59], s38 offen offset:1024 sc1
    v_mfma_f32_16x16x32_bf16 v[80:83], v[196:199], a[32:35], v[80:83]
    v_mfma_f32_16x16x32_bf16 v[84:87], v[196:199], a[36:39], v[84:87]
    v_mfma_f32_16x16x32_bf16 v[88:91], v[196:199], a[40:43], v[88:91]
    v_mfma_f32_16x16x32_bf16 v[92:95], v[196:199], a[44:47], v[92:95]
    s_waitcnt vmcnt(8)
    v_mfma_f32_16x16x32_bf16 v[80:83], v[200:203], a[48:51], v[80:83]
    v_mfma_f32_16x16x32_bf16 v[84:87], v[200:203], a[52:55], v[84:87]
    v_mfma_f32_16x16x32_bf16 v[88:91], v[200:203], a[56:59], v[88:91]
    v_mfma_f32_16x16x32_bf16 v[92:95], v[200:203], a[60:63], v[92:95]
    v_mfma_f32_16x16x32_bf16 v[80:83], v[104:107], a[64:67], v[80:83]
    v_mfma_f32_16x16x32_bf16 v[84:87], v[104:107], a[68:71], v[84:87]
    buffer_load_dwordx4 v[144:147], v2, s[52:55], s11 offen offset:3072 sc1
    v_mfma_f32_16x16x32_bf16 v[88:91], v[104:107], a[72:75], v[88:91]
    v_mfma_f32_16x16x32_bf16 v[92:95], v[104:107], a[76:79], v[92:95]
    v_mfma_f32_16x16x32_bf16 v[80:83], v[204:207], a[80:83], v[80:83]
    v_mfma_f32_16x16x32_bf16 v[84:87], v[204:207], a[84:87], v[84:87]
    s_add_u32 s11, s8, 307200
    buffer_load_dwordx4 v[148:151], v2, s[52:55], s11 offen offset:0 sc1
    v_mfma_f32_16x16x32_bf16 v[88:91], v[204:207], a[88:91], v[88:91]
    v_mfma_f32_16x16x32_bf16 v[92:95], v[204:207], a[92:95], v[92:95]
    s_waitcnt vmcnt(7)
    v_mfma_f32_16x16x32_bf16 v[80:83], v[208:211], a[96:99], v[80:83]
    v_mfma_f32_16x16x32_bf16 v[84:87], v[208:211], a[100:103], v[84:87]
    buffer_load_dwordx4 v[164:167], v2, s[52:55], s11 offen offset:1024 sc1
    v_mfma_f32_16x16x32_bf16 v[88:91], v[208:211], a[104:107], v[88:91]
    v_mfma_f32_16x16x32_bf16 v[92:95], v[208:211], a[108:111], v[92:95]
    v_mfma_f32_16x16x32_bf16 v[80:83], v[212:215], a[112:115], v[80:83]
    v_mfma_f32_16x16x32_bf16 v[84:87], v[212:215], a[116:119], v[84:87]
    buffer_load_dwordx4 v[168:171], v2, s[52:55], s11 offen offset:2048 sc1
    v_mfma_f32_16x16x32_bf16 v[88:91], v[212:215], a[120:123], v[88:91]
    v_mfma_f32_16x16x32_bf16 v[92:95], v[212:215], a[124:127], v[92:95]
    v_mfma_f32_16x16x32_bf16 v[80:83], v[216:219], a[128:131], v[80:83]
    v_mfma_f32_16x16x32_bf16 v[84:87], v[216:219], a[132:135], v[84:87]
    buffer_load_dwordx4 v[172:175], v2, s[52:55], s11 offen offset:3072 sc1
    v_mfma_f32_16x16x32_bf16 v[88:91], v[216:219], a[136:139], v[88:91]
    v_mfma_f32_16x16x32_bf16 v[92:95], v[216:219], a[140:143], v[92:95]
    s_waitcnt vmcnt(4)
    v_mfma_f32_16x16x32_bf16 v[80:83], v[220:223], a[144:147], v[80:83]
    s_add_u32 s91, s90, 7
    v_mov_b32 v156, s91
    buffer_store_dword v156, v9, s[68:71], s43 offen sc1
    v_mfma_f32_16x16x32_bf16 v[84:87], v[220:223], a[148:151], v[84:87]
    s_add_u32 s11, s8, 311296
    buffer_load_dwordx4 v[176:179], v2, s[52:55], s11 offen offset:0 sc1
    v_mfma_f32_16x16x32_bf16 v[88:91], v[220:223], a[152:155], v[88:91]
    v_mfma_f32_16x16x32_bf16 v[92:95], v[220:223], a[156:159], v[92:95]
    v_mfma_f32_16x16x32_bf16 v[80:83], v[160:163], a[160:163], v[80:83]
    v_mfma_f32_16x16x32_bf16 v[84:87], v[160:163], a[164:167], v[84:87]
    buffer_load_dwordx4 v[112:115], v2, s[52:55], s11 offen offset:1024 sc1
    v_mfma_f32_16x16x32_bf16 v[88:91], v[160:163], a[168:171], v[88:91]
    v_dot2c_f32_bf16 v12, s6, v116
    v_dot2c_f32_bf16 v13, s7, v116
    v_dot2c_f32_bf16 v14, s6, v117
    v_dot2c_f32_bf16 v15, s7, v117
    v_mfma_f32_16x16x32_bf16 v[92:95], v[160:163], a[172:175], v[92:95]
    v_dot2c_f32_bf16 v16, s6, v118
    v_dot2c_f32_bf16 v17, s7, v118
    v_mfma_f32_16x16x32_bf16 v[80:83], v[144:147], a[176:179], v[80:83]
    v_dot2c_f32_bf16 v18, s6, v119
    v_dot2c_f32_bf16 v19, s7, v119
    v_dot2c_f32_bf16 v20, s6, v120
    v_mfma_f32_16x16x32_bf16 v[84:87], v[144:147], a[180:183], v[84:87]
    s_add_u32 s11, s8, 313344
    buffer_load_dwordx4 v[196:199], v2, s[52:55], s11 offen offset:0 sc1
    v_dot2c_f32_bf16 v21, s7, v120
    v_mfma_f32_16x16x32_bf16 v[88:91], v[144:147], a[184:187], v[88:91]
    v_dot2c_f32_bf16 v22, s6, v121
    v_dot2c_f32_bf16 v23, s7, v121
    v_dot2c_f32_bf16 v24, s6, v122
    v_mfma_f32_16x16x32_bf16 v[92:95], v[144:147], a[188:191], v[92:95]
    buffer_load_dwordx4 v[200:203], v2, s[52:55], s11 offen offset:1024 sc1
    v_dot2c_f32_bf16 v25, s7, v122
    s_waitcnt vmcnt(6)
    v_mfma_f32_16x16x32_bf16 v[80:83], v[148:151], a[192:195], v[80:83]
    v_dot2c_f32_bf16 v26, s6, v123
    v_dot2c_f32_bf16 v27, s7, v123
    v_mfma_f32_16x16x32_bf16 v[84:87], v[148:151], a[196:199], v[84:87]
    buffer_load_dwordx4 v[104:107], v2, s[52:55], s11 offen offset:2048 sc1
    v_dot2c_f32_bf16 v128, s6, v124
    v_dot2c_f32_bf16 v129, s7, v124
    v_mfma_f32_16x16x32_bf16 v[88:91], v[148:151], a[200:203], v[88:91]
    v_dot2c_f32_bf16 v130, s6, v125
    v_dot2c_f32_bf16 v131, s7, v125
    v_dot2c_f32_bf16 v132, s6, v126
    v_mfma_f32_16x16x32_bf16 v[92:95], v[148:151], a[204:207], v[92:95]
    buffer_load_dwordx4 v[204:207], v2, s[52:55], s11 offen offset:3072 sc1
    v_dot2c_f32_bf16 v133, s7, v126
    v_dot2c_f32_bf16 v134, s6, v127
    v_mfma_f32_16x16x32_bf16 v[80:83], v[164:167], a[208:211], v[80:83]
    v_dot2c_f32_bf16 v135, s7, v127
    v_dot2c_f32_bf16 v128, s6, v180
    v_mfma_f32_16x16x32_bf16 v[84:87], v[164:167], a[212:215], v[84:87]
    s_add_u32 s11, s8, 317440
    buffer_load_dwordx4 v[208:211], v2, s[52:55], s11 offen offset:0 sc1
    v_dot2c_f32_bf16 v129, s7, v180
    v_mfma_f32_16x16x32_bf16 v[88:91], v[164:167], a[216:219], v[88:91]
    v_dot2c_f32_bf16 v130, s6, v181
    v_dot2c_f32_bf16 v131, s7, v181
    v_dot2c_f32_bf16 v132, s6, v182
    v_mfma_f32_16x16x32_bf16 v[92:95], v[164:167], a[220:223], v[92:95]
    buffer_load_dwordx4 v[212:215], v2, s[52:55], s11 offen offset:1024 sc1
    v_dot2c_f32_bf16 v133, s7, v182
    v_dot2c_f32_bf16 v134, s6, v183
    v_mfma_f32_16x16x32_bf16 v[80:83], v[168:171], a[224:227], v[80:83]
    v_dot2c_f32_bf16 v135, s7, v183
    v_dot2c_f32_bf16 v128, s6, v184
    v_dot2c_f32_bf16 v129, s7, v184
    v_mfma_f32_16x16x32_bf16 v[84:87], v[168:171], a[228:231], v[84:87]
    buffer_load_dwordx4 v[216:219], v2, s[52:55], s11 offen offset:2048 sc1
    v_dot2c_f32_bf16 v130, s6, v185
    v_mfma_f32_16x16x32_bf16 v[88:91], v[168:171], a[232:235], v[88:91]
    v_dot2c_f32_bf16 v131, s7, v185
    v_dot2c_f32_bf16 v132, s6, v186
    v_dot2c_f32_bf16 v133, s7, v186
    v_mfma_f32_16x16x32_bf16 v[92:95], v[168:171], a[236:239], v[92:95]
    buffer_load_dwordx4 v[220:223], v2, s[52:55], s11 offen offset:3072 sc1
    v_dot2c_f32_bf16 v134, s6, v187
    v_dot2c_f32_bf16 v135, s7, v187
    s_waitcnt vmcnt(8)
    v_mfma_f32_16x16x32_bf16 v[80:83], v[172:175], a[240:243], v[80:83]
    v_dot2c_f32_bf16 v128, s6, v100
    v_dot2c_f32_bf16 v129, s7, v100
    v_mfma_f32_16x16x32_bf16 v[84:87], v[172:175], a[244:247], v[84:87]
    s_add_u32 s11, s8, 321536
    buffer_load_dwordx4 v[160:163], v2, s[52:55], s11 offen offset:0 sc1
    v_dot2c_f32_bf16 v130, s6, v101
    v_mfma_f32_16x16x32_bf16 v[88:91], v[172:175], a[248:251], v[88:91]
    v_dot2c_f32_bf16 v131, s7, v101
    v_dot2c_f32_bf16 v132, s6, v102
    v_mfma_f32_16x16x32_bf16 v[92:95], v[172:175], a[252:255], v[92:95]
    buffer_load_dwordx4 v[116:119], v2, s[52:55], s11 offen offset:1024 sc1
    v_dot2c_f32_bf16 v133, s7, v102
    v_dot2c_f32_bf16 v134, s6, v103
    v_mfma_f32_16x16x32_bf16 v[80:83], v[176:179], v[224:227], v[80:83]
    v_dot2c_f32_bf16 v135, s7, v103
    v_dot2c_f32_bf16 v128, s6, v108
    v_dot2c_f32_bf16 v129, s7, v108
    v_mfma_f32_16x16x32_bf16 v[84:87], v[176:179], v[228:231], v[84:87]
    buffer_load_dwordx4 v[144:147], v2, s[52:55], s11 offen offset:2048 sc1
    v_dot2c_f32_bf16 v130, s6, v109
    v_dot2c_f32_bf16 v131, s7, v109
    v_mfma_f32_16x16x32_bf16 v[88:91], v[176:179], v[232:235], v[88:91]
    v_dot2c_f32_bf16 v132, s6, v110
    v_dot2c_f32_bf16 v133, s7, v110
    v_dot2c_f32_bf16 v134, s6, v111
    v_mfma_f32_16x16x32_bf16 v[92:95], v[176:179], v[236:239], v[92:95]
    buffer_load_dwordx4 v[120:123], v2, s[52:55], s11 offen offset:3072 sc1
    v_dot2c_f32_bf16 v135, s7, v111
    v_mfma_f32_16x16x32_bf16 v[80:83], v[112:115], v[240:243], v[80:83]
    v_dot2c_f32_bf16 v128, s6, v188
    v_dot2c_f32_bf16 v129, s7, v188
    v_dot2c_f32_bf16 v130, s6, v189
    v_mfma_f32_16x16x32_bf16 v[84:87], v[112:115], v[244:247], v[84:87]
    s_add_u32 s11, s8, 325632
    buffer_load_dwordx4 v[148:151], v2, s[52:55], s11 offen offset:0 sc1
    v_dot2c_f32_bf16 v131, s7, v189
    v_mfma_f32_16x16x32_bf16 v[88:91], v[112:115], v[248:251], v[88:91]
    v_dot2c_f32_bf16 v132, s6, v190
    v_dot2c_f32_bf16 v133, s7, v190
    v_dot2c_f32_bf16 v134, s6, v191
    v_mfma_f32_16x16x32_bf16 v[92:95], v[112:115], v[252:255], v[92:95]
    buffer_load_dwordx4 v[124:127], v2, s[52:55], s11 offen offset:1024 sc1
    v_mov_b32 v158, 0x22224322
    v_lshrrev_b32 v158, v11, v158
    v_and_b32 v158, 15, v158
    v_add_u32 v158, s90, v158
    v_subrev_u32 v157, v158, v157
    v_cmp_lt_u32 vcc, 7, v157
    s_mov_b32 s91, 20000
    s_nop 0
    s_cbranch_vccz ck10
cr10:
    buffer_load_dword v157, v10, s[68:71], s42 offen sc1
    s_sub_u32 s91, s91, 1
    s_waitcnt vmcnt(0)
    v_subrev_u32 v157, v158, v157
    v_cmp_lt_u32 vcc, 7, v157
    s_cbranch_scc1 ck10
    s_nop 0
    s_cbranch_vccnz cr10
ck10:
    s_waitcnt vmcnt(11)
    v_mfma_f32_16x16x32_bf16 v[48:51], v[196:199], a[0:3], 0
    s_sub_u32 s10, s4, 2
    s_and_b32 s10, s10, 7
    s_mul_i32 s10, s10, 2359296
    s_add_u32 s10, s10, s9
    buffer_load_dwordx4 v[164:167], v2, s[56:59], s10 offen offset:0 sc1
    buffer_load_dwordx4 v[180:183], v2, s[56:59], s10 offen offset:1024 sc1
    v_mfma_f32_16x16x32_bf16 v[52:55], v[196:199], a[4:7], 0
    s_sub_u32 s10, s4, 3
    s_and_b32 s10, s10, 7
    s_mul_i32 s10, s10, 2359296
    s_add_u32 s10, s10, s9
    buffer_load_dwordx4 v[184:187], v2, s[56:59], s10 offen offset:0 sc1
    buffer_load_dwordx4 v[168:171], v2, s[56:59], s10 offen offset:1024 sc1
    v_mfma_f32_16x16x32_bf16 v[56:59], v[196:199], a[8:11], 0
    v_cvt_pk_bf16_f32 v80, v80, v81
    v_cvt_pk_bf16_f32 v81, v82, v83
    v_mfma_f32_16x16x32_bf16 v[60:63], v[196:199], a[12:15], 0
    buffer_load_dwordx4 v[172:175], v2, s[52:55], s11 offen offset:2048 sc1
    v_cvt_pk_bf16_f32 v82, v84, v85
    v_mfma_f32_16x16x32_bf16 v[48:51], v[200:203], a[16:19], v[48:51]
    v_cvt_pk_bf16_f32 v83, v86, v87
    v_cvt_pk_bf16_f32 v88, v88, v89
    v_mfma_f32_16x16x32_bf16 v[52:55], v[200:203], a[20:23], v[52:55]
    buffer_load_dwordx4 v[100:103], v2, s[52:55], s11 offen offset:3072 sc1
    buffer_store_dwordx4 v[80:83], v2, s[56:59], s39 offen offset:0 sc1
    v_mfma_f32_16x16x32_bf16 v[56:59], v[200:203], a[24:27], v[56:59]
    v_cvt_pk_bf16_f32 v89, v90, v91
    v_cvt_pk_bf16_f32 v90, v92, v93
    v_mfma_f32_16x16x32_bf16 v[60:63], v[200:203], a[28:31], v[60:63]
    v_cvt_pk_bf16_f32 v91, v94, v95
    v_dot2c_f32_bf16 v135, s7, v191
    v_mfma_f32_16x16x32_bf16 v[48:51], v[104:107], a[32:35], v[48:51]
    v_dot2c_f32_bf16 v128, s6, v192
    v_dot2c_f32_bf16 v129, s7, v192
    v_mfma_f32_16x16x32_bf16 v[52:55], v[104:107], a[36:39], v[52:55]
    s_add_u32 s11, s8, 329728
    buffer_load_dwordx4 v[108:111], v2, s[52:55], s11 offen offset:0 sc1
    v_mfma_f32_16x16x32_bf16 v[56:59], v[104:107], a[40:43], v[56:59]
    v_dot2c_f32_bf16 v130, s6, v193
    v_dot2c_f32_bf16 v131, s7, v193
    v_mfma_f32_16x16x32_bf16 v[60:63], v[104:107], a[44:47], v[60:63]
    buffer_load_dwordx4 v[176:179], v2, s[52:55], s11 offen offset:1024 sc1
    buffer_store_dwordx4 v[88:91], v2, s[56:59], s39 offen offset:1024 sc1
    s_waitcnt vmcnt(18)
    v_mfma_f32_16x16x32_bf16 v[48:51], v[204:207], a[48:51], v[48:51]
    v_dot2c_f32_bf16 v132, s6, v194
    v_dot2c_f32_bf16 v133, s7, v194
    v_mfma_f32_16x16x32_bf16 v[52:55], v[204:207], a[52:55], v[52:55]
    v_dot2c_f32_bf16 v134, s6, v195
    v_dot2c_f32_bf16 v135, s7, v195
    v_mfma_f32_16x16x32_bf16 v[56:59], v[204:207], a[56:59], v[56:59]
    v_dot2c_f32_bf16 v128, s6, v96
    v_dot2c_f32_bf16 v129, s7, v96
    v_mfma_f32_16x16x32_bf16 v[60:63], v[204:207], a[60:63], v[60:63]
    v_dot2c_f32_bf16 v130, s6, v97
    v_dot2c_f32_bf16 v131, s7, v97
    v_mfma_f32_16x16x32_bf16 v[48:51], v[208:211], a[64:67], v[48:51]
    v_dot2c_f32_bf16 v132, s6, v98
    v_dot2c_f32_bf16 v133, s7, v98
    v_mfma_f32_16x16x32_bf16 v[52:55], v[208:211], a[68:71], v[52:55]
    v_dot2c_f32_bf16 v134, s6, v99
    v_dot2c_f32_bf16 v135, s7, v99
    v_mfma_f32_16x16x32_bf16 v[56:59], v[208:211], a[72:75], v[56:59]
    v_fma_f32 v128, v128, v153, v136
    v_fma_f32 v129, v129, v153, v137
    v_mfma_f32_16x16x32_bf16 v[60:63], v[208:211], a[76:79], v[60:63]
    v_fma_f32 v130, v130, v153, v138
    v_fma_f32 v131, v131, v153, v139
    v_mfma_f32_16x16x32_bf16 v[48:51], v[212:215], a[80:83], v[48:51]
    v_fma_f32 v132, v132, v154, v140
    v_fma_f32 v133, v133, v154, v141
    v_mfma_f32_16x16x32_bf16 v[52:55], v[212:215], a[84:87], v[52:55]
    v_fma_f32 v134, v134, v154, v142
    v_fma_f32 v135, v135, v154, v143
    v_mfma_f32_16x16x32_bf16 v[56:59], v[212:215], a[88:91], v[56:59]
    v_cvt_pk_bf16_f32 v136, v128, v129
    v_cvt_pk_bf16_f32 v137, v130, v131
    v_mfma_f32_16x16x32_bf16 v[60:63], v[212:215], a[92:95], v[60:63]
    v_cvt_pk_bf16_f32 v138, v132, v133
    v_cvt_pk_bf16_f32 v139, v134, v135
    s_waitcnt vmcnt(15)
    v_mfma_f32_16x16x32_bf16 v[48:51], v[216:219], a[96:99], v[48:51]
    v_mfma_f32_16x16x32_bf16 v[52:55], v[216:219], a[100:103], v[52:55]
    buffer_store_dwordx2 v[136:137], v159, s[28:31], s46 offen sc1
    buffer_store_dwordx2 v[138:139], v159, s[28:31], s47 offen sc1
    v_mfma_f32_16x16x32_bf16 v[56:59], v[216:219], a[104:107], v[56:59]
    v_mfma_f32_16x16x32_bf16 v[60:63], v[216:219], a[108:111], v[60:63]
    v_mfma_f32_16x16x32_bf16 v[48:51], v[220:223], a[112:115], v[48:51]
    v_mfma_f32_16x16x32_bf16 v[52:55], v[220:223], a[116:119], v[52:55]
    v_mfma_f32_16x16x32_bf16 v[56:59], v[220:223], a[120:123], v[56:59]
    v_mfma_f32_16x16x32_bf16 v[60:63], v[220:223], a[124:127], v[60:63]
    v_mfma_f32_16x16x32_bf16 v[48:51], v[160:163], a[128:131], v[48:51]
    v_mfma_f32_16x16x32_bf16 v[52:55], v[160:163], a[132:135], v[52:55]
    v_mfma_f32_16x16x32_bf16 v[56:59], v[160:163], a[136:139], v[56:59]
    v_mfma_f32_16x16x32_bf16 v[60:63], v[160:163], a[140:143], v[60:63]
    s_waitcnt vmcnt(14)
    v_mfma_f32_16x16x32_bf16 v[48:51], v[116:119], a[144:147], v[48:51]
    v_mfma_f32_16x16x32_bf16 v[52:55], v[116:119], a[148:151], v[52:55]
    v_mfma_f32_16x16x32_bf16 v[56:59], v[116:119], a[152:155], v[56:59]
    v_mfma_f32_16x16x32_bf16 v[60:63], v[116:119], a[156:159], v[60:63]
    v_mfma_f32_16x16x32_bf16 v[48:51], v[144:147], a[160:163], v[48:51]
    v_mfma_f32_16x16x32_bf16 v[52:55], v[144:147], a[164:167], v[52:55]
    v_mfma_f32_16x16x32_bf16 v[56:59], v[144:147], a[168:171], v[56:59]
    v_mfma_f32_16x16x32_bf16 v[60:63], v[144:147], a[172:175], v[60:63]
    v_mfma_f32_16x16x32_bf16 v[48:51], v[120:123], a[176:179], v[48:51]
    v_mfma_f32_16x16x32_bf16 v[52:55], v[120:123], a[180:183], v[52:55]
    v_mfma_f32_16x16x32_bf16 v[56:59], v[120:123], a[184:187], v[56:59]
    v_mfma_f32_16x16x32_bf16 v[60:63], v[120:123], a[188:191], v[60:63]
    s_waitcnt vmcnt(7)
    v_mfma_f32_16x16x32_bf16 v[48:51], v[148:151], a[192:195], v[48:51]
    v_mfma_f32_16x16x32_bf16 v[52:55], v[148:151], a[196:199], v[52:55]
    v_mfma_f32_16x16x32_bf16 v[56:59], v[148:151], a[200:203], v[56:59]
    v_mfma_f32_16x16x32_bf16 v[60:63], v[148:151], a[204:207], v[60:63]
    v_mfma_f32_16x16x32_bf16 v[48:51], v[124:127], a[208:211], v[48:51]
    v_mfma_f32_16x16x32_bf16 v[52:55], v[124:127], a[212:215], v[52:55]
    v_mfma_f32_16x16x32_bf16 v[56:59], v[124:127], a[216:219], v[56:59]
    v_mfma_f32_16x16x32_bf16 v[60:63], v[124:127], a[220:223], v[60:63]
    v_mfma_f32_16x16x32_bf16 v[48:51], v[172:175], a[224:227], v[48:51]
    v_mfma_f32_16x16x32_bf16 v[52:55], v[172:175], a[228:231], v[52:55]
    v_mfma_f32_16x16x32_bf16 v[56:59], v[172:175], a[232:235], v[56:59]
    v_mfma_f32_16x16x32_bf16 v[60:63], v[172:175], a[236:239], v[60:63]
    s_waitcnt vmcnt(3)
    v_mfma_f32_16x16x32_bf16 v[48:51], v[100:103], a[240:243], v[48:51]
    v_mfma_f32_16x16x32_bf16 v[52:55], v[100:103], a[244:247], v[52:55]
    v_mfma_f32_16x16x32_bf16 v[56:59], v[100:103], a[248:251], v[56:59]
    v_mfma_f32_16x16x32_bf16 v[60:63], v[100:103], a[252:255], v[60:63]
    v_mfma_f32_16x16x32_bf16 v[48:51], v[108:111], v[224:227], v[48:51]
    v_mfma_f32_16x16x32_bf16 v[52:55], v[108:111], v[228:231], v[52:55]
    v_mfma_f32_16x16x32_bf16 v[56:59], v[108:111], v[232:235], v[56:59]
    s_waitcnt vmcnt(2)
    s_add_u32 s91, s90, 8
    v_mov_b32 v156, s91
    buffer_store_dword v156, v9, s[68:71], s43 offen sc1
    v_mfma_f32_16x16x32_bf16 v[60:63], v[108:111], v[236:239], v[60:63]
    v_mfma_f32_16x16x32_bf16 v[48:51], v[176:179], v[240:243], v[48:51]
    v_mfma_f32_16x16x32_bf16 v[52:55], v[176:179], v[244:247], v[52:55]
    v_mfma_f32_16x16x32_bf16 v[56:59], v[176:179], v[248:251], v[56:59]
    v_mfma_f32_16x16x32_bf16 v[60:63], v[176:179], v[252:255], v[60:63]
    buffer_load_dword v157, v10, s[68:71], s42 offen sc1
    v_mov_b32 v158, 0x87652222
    v_lshrrev_b32 v158, v11, v158
    v_and_b32 v158, 15, v158
    v_add_u32 v158, s90, v158
    s_waitcnt vmcnt(0)
    v_subrev_u32 v157, v158, v157
    v_cmp_lt_u32 vcc, 7, v157
    s_mov_b32 s91, 20000
    s_nop 0
    s_cbranch_vccz ck11
cr11:
    buffer_load_dword v157, v10, s[68:71], s42 offen sc1
    s_sub_u32 s91, s91, 1
    s_waitcnt vmcnt(0)
    v_subrev_u32 v157, v158, v157
    v_cmp_lt_u32 vcc, 7, v157
    s_cbranch_scc1 ck11
    s_nop 0
    s_cbranch_vccnz cr11
ck11:
    s_sub_u32 s10, s4, 4
    s_and_b32 s10, s10, 7
    s_mul_i32 s10, s10, 2359296
    s_add_u32 s10, s10, s9
    buffer_load_dwordx4 v[112:115], v2, s[56:59], s10 offen offset:0 sc1
    buffer_load_dwordx4 v[196:199], v2, s[56:59], s10 offen offset:1024 sc1
    s_sub_u32 s10, s4, 5
    s_and_b32 s10, s10, 7
    s_mul_i32 s10, s10, 2359296
    s_add_u32 s10, s10, s9
    buffer_load_dwordx4 v[200:203], v2, s[56:59], s10 offen offset:0 sc1
    buffer_load_dwordx4 v[188:191], v2, s[56:59], s10 offen offset:1024 sc1
    s_sub_u32 s10, s4, 6
    s_and_b32 s10, s10, 7
    s_mul_i32 s10, s10, 2359296
    s_add_u32 s10, s10, s9
    buffer_load_dwordx4 v[104:107], v2, s[56:59], s10 offen offset:0 sc1
    buffer_load_dwordx4 v[192:195], v2, s[56:59], s10 offen offset:1024 sc1
    s_sub_u32 s10, s4, 7
    s_and_b32 s10, s10, 7
    s_mul_i32 s10, s10, 2359296
    s_add_u32 s10, s10, s9
    buffer_load_dwordx4 v[204:207], v2, s[56:59], s10 offen offset:0 sc1
    buffer_load_dwordx4 v[96:99], v2, s[56:59], s10 offen offset:1024 sc1
    v_dot2c_f32_bf16 v12, s6, v164
    v_dot2c_f32_bf16 v13, s7, v164
    v_dot2c_f32_bf16 v14, s6, v165
    v_dot2c_f32_bf16 v15, s7, v165
    v_dot2c_f32_bf16 v16, s6, v166
    v_dot2c_f32_bf16 v17, s7, v166
    v_dot2c_f32_bf16 v18, s6, v167
    v_dot2c_f32_bf16 v19, s7, v167
    v_dot2c_f32_bf16 v20, s6, v180
    v_dot2c_f32_bf16 v21, s7, v180
    v_dot2c_f32_bf16 v22, s6, v181
    v_dot2c_f32_bf16 v23, s7, v181
    v_dot2c_f32_bf16 v24, s6, v182
    v_dot2c_f32_bf16 v25, s7, v182
    v_dot2c_f32_bf16 v26, s6, v183
    v_dot2c_f32_bf16 v27, s7, v183
    v_dot2c_f32_bf16 v12, s6, v184
    v_dot2c_f32_bf16 v13, s7, v184
    v_dot2c_f32_bf16 v14, s6, v185
    v_dot2c_f32_bf16 v15, s7, v185
    v_dot2c_f32_bf16 v16, s6, v186
    v_dot2c_f32_bf16 v17, s7, v186
    v_dot2c_f32_bf16 v18, s6, v187
    v_dot2c_f32_bf16 v19, s7, v187
    v_dot2c_f32_bf16 v20, s6, v168
    v_dot2c_f32_bf16 v21, s7, v168
    v_dot2c_f32_bf16 v22, s6, v169
    v_dot2c_f32_bf16 v23, s7, v169
    v_dot2c_f32_bf16 v24, s6, v170
    v_dot2c_f32_bf16 v25, s7, v170
    v_dot2c_f32_bf16 v26, s6, v171
    v_dot2c_f32_bf16 v27, s7, v171
    v_add_f32 v12, v12, v48
    v_add_f32 v13, v13, v49
    v_add_f32 v14, v14, v50
    v_add_f32 v15, v15, v51
    v_add_f32 v16, v16, v52
    v_add_f32 v17, v17, v53
    v_add_f32 v18, v18, v54
    v_add_f32 v19, v19, v55
    v_add_f32 v20, v20, v56
    v_add_f32 v21, v21, v57
    v_add_f32 v22, v22, v58
    v_add_f32 v23, v23, v59
    v_add_f32 v24, v24, v60
    v_add_f32 v25, v25, v61
    v_add_f32 v26, v26, v62
    v_add_f32 v27, v27, v63
    v_and_b32 v3, 15, v1
    v_lshlrev_b32 v3, 7, v3
    v_lshrrev_b32 v4, 4, v1
    v_lshl_add_u32 v3, v4, 3, v3
    s_lshr_b32 s12, s4, 2
    s_xor_b32 s12, s12, 1
    s_lshl_b32 s12, s12, 15
    s_add_u32 s12, s12, 20480
    s_lshl_b32 s13, s3, 5
    s_add_u32 s13, s13, s12
    v_add_u32 v3, s13, v3
    s_lshl_b32 s13, s3, 11
    s_add_u32 s13, s13, s12
    v_add_u32 v4, s13, v2
    v_lshrrev_b32 v5, 3, v1
    v_mul_u32_u24 v5, 1152, v5
    v_and_b32 v6, 7, v1
    v_lshl_add_u32 v5, v6, 4, v5
    s_mul_i32 s13, s3, 18432
    s_add_u32 s40, s40, s13
    s_add_u32 s13, s40, 9216
    s_waitcnt vmcnt(6)
    v_dot2c_f32_bf16 v12, s6, v112
    v_dot2c_f32_bf16 v13, s7, v112
    v_dot2c_f32_bf16 v14, s6, v113
    v_dot2c_f32_bf16 v15, s7, v113
    v_dot2c_f32_bf16 v16, s6, v114
    v_dot2c_f32_bf16 v17, s7, v114
    v_dot2c_f32_bf16 v18, s6, v115
    v_dot2c_f32_bf16 v19, s7, v115
    v_dot2c_f32_bf16 v20, s6, v196
    v_dot2c_f32_bf16 v21, s7, v196
    v_dot2c_f32_bf16 v22, s6, v197
    v_dot2c_f32_bf16 v23, s7, v197
    v_dot2c_f32_bf16 v24, s6, v198
    v_dot2c_f32_bf16 v25, s7, v198
    v_dot2c_f32_bf16 v26, s6, v199
    v_dot2c_f32_bf16 v27, s7, v199
    s_waitcnt vmcnt(4)
    v_dot2c_f32_bf16 v12, s6, v200
    v_dot2c_f32_bf16 v13, s7, v200
    v_dot2c_f32_bf16 v14, s6, v201
    v_dot2c_f32_bf16 v15, s7, v201
    v_dot2c_f32_bf16 v16, s6, v202
    v_dot2c_f32_bf16 v17, s7, v202
    v_dot2c_f32_bf16 v18, s6, v203
    v_dot2c_f32_bf16 v19, s7, v203
    v_dot2c_f32_bf16 v20, s6, v188
    v_dot2c_f32_bf16 v21, s7, v188
    v_dot2c_f32_bf16 v22, s6, v189
    v_dot2c_f32_bf16 v23, s7, v189
    v_dot2c_f32_bf16 v24, s6, v190
    v_dot2c_f32_bf16 v25, s7, v190
    v_dot2c_f32_bf16 v26, s6, v191
    v_dot2c_f32_bf16 v27, s7, v191
    s_waitcnt vmcnt(2)
    v_dot2c_f32_bf16 v12, s6, v104
    v_dot2c_f32_bf16 v13, s7, v104
    v_dot2c_f32_bf16 v14, s6, v105
    v_dot2c_f32_bf16 v15, s7, v105
    v_dot2c_f32_bf16 v16, s6, v106
    v_dot2c_f32_bf16 v17, s7, v106
    v_dot2c_f32_bf16 v18, s6, v107
    v_dot2c_f32_bf16 v19, s7, v107
    v_dot2c_f32_bf16 v20, s6, v192
    v_dot2c_f32_bf16 v21, s7, v192
    v_dot2c_f32_bf16 v22, s6, v193
    v_dot2c_f32_bf16 v23, s7, v193
    v_dot2c_f32_bf16 v24, s6, v194
    v_dot2c_f32_bf16 v25, s7, v194
    v_dot2c_f32_bf16 v26, s6, v195
    v_dot2c_f32_bf16 v27, s7, v195
    s_waitcnt vmcnt(0)
    v_dot2c_f32_bf16 v12, s6, v204
    v_dot2c_f32_bf16 v13, s7, v204
    v_dot2c_f32_bf16 v14, s6, v205
    v_dot2c_f32_bf16 v15, s7, v205
    v_dot2c_f32_bf16 v16, s6, v206
    v_dot2c_f32_bf16 v17, s7, v206
    v_dot2c_f32_bf16 v18, s6, v207
    v_dot2c_f32_bf16 v19, s7, v207
    v_dot2c_f32_bf16 v20, s6, v96
    v_dot2c_f32_bf16 v21, s7, v96
    v_dot2c_f32_bf16 v22, s6, v97
    v_dot2c_f32_bf16 v23, s7, v97
    v_dot2c_f32_bf16 v24, s6, v98
    v_dot2c_f32_bf16 v25, s7, v98
    v_dot2c_f32_bf16 v26, s6, v99
    v_dot2c_f32_bf16 v27, s7, v99
    v_fma_f32 v12, v12, v44, v28
    v_fma_f32 v13, v13, v44, v29
    v_fma_f32 v14, v14, v44, v30
    v_fma_f32 v15, v15, v44, v31
    v_cvt_pk_bf16_f32 v48, v12, v13
    v_cvt_pk_bf16_f32 v49, v14, v15
    ds_write_b64 v3, v[48:49] offset:0
    v_fma_f32 v16, v16, v45, v32
    v_fma_f32 v17, v17, v45, v33
    v_fma_f32 v18, v18, v45, v34
    v_fma_f32 v19, v19, v45, v35
    v_cvt_pk_bf16_f32 v50, v16, v17
    v_cvt_pk_bf16_f32 v51, v18, v19
    ds_write_b64 v3, v[50:51] offset:2048
    v_fma_f32 v20, v20, v46, v36
    v_fma_f32 v21, v21, v46, v37
    v_fma_f32 v22, v22, v46, v38
    v_fma_f32 v23, v23, v46, v39
    v_cvt_pk_bf16_f32 v52, v20, v21
    v_cvt_pk_bf16_f32 v53, v22, v23
    ds_write_b64 v3, v[52:53] offset:4096
    v_fma_f32 v24, v24, v47, v40
    v_fma_f32 v25, v25, v47, v41
    v_fma_f32 v26, v26, v47, v42
    v_fma_f32 v27, v27, v47, v43
    v_cvt_pk_bf16_f32 v54, v24, v25
    v_cvt_pk_bf16_f32 v55, v26, v27
    ds_write_b64 v3, v[54:55] offset:6144
    s_waitcnt lgkmcnt(0)
    s_barrier
    ds_read_b128 v[56:59], v4
    ds_read_b128 v[60:63], v4 offset:1024
    s_waitcnt lgkmcnt(1)
    buffer_store_dwordx4 v[56:59], v5, s[28:31], s40 offen sc1
    s_waitcnt lgkmcnt(0)
    buffer_store_dwordx4 v[60:63], v5, s[28:31], s13 offen sc1
gated_mix__ssm_conv_h3__mixer_s_mlp__prompt_kernel_exit:
    s_endpgm
code_end:
.section .rodata,"a"
.p2align 6
.amdhsa_kernel gated_mix__ssm_conv_h3__mixer_s_mlp__prompt_kernel
  .amdhsa_next_free_vgpr 512
  .amdhsa_next_free_sgpr 102
  .amdhsa_accum_offset 256
  .amdhsa_group_segment_fixed_size 0
  .amdhsa_kernarg_size 120
  .amdhsa_user_sgpr_count 2
  .amdhsa_user_sgpr_kernarg_segment_ptr 1
  .amdhsa_system_sgpr_workgroup_id_x 1
.end_amdhsa_kernel
```
